```python
import torch

def _softmax(x, axis=-1):
    return torch.softmax(x, dim=axis)

def _gelu(x):
    return torch.nn.functional.gelu(x, approximate='tanh')

def _silu(x):
    return torch.nn.functional.silu(x)

def _sigmoid(x):
    return torch.sigmoid(x)

def _layernorm(x, axis=-1, eps=1e-05):
    m = x.mean(dim=axis, keepdim=True)
    v = x.var(dim=axis, keepdim=True, unbiased=False)
    return (x - m) / torch.sqrt(v + eps)

def _scatter_add(tgt, idx, src, axis=0):
    return tgt.clone().index_add_(axis, idx, src)

def _segment_sum(src, seg, n):
    out = torch.zeros((n,) + src.shape[1:], dtype=src.dtype)
    return out.index_add_(0, seg, src)

def _pad(x, pw):
    flat = tuple((v for pair in reversed(pw) for v in pair))
    return torch.nn.functional.pad(x, flat)
kernel_name = 'parallel_sum__memory_aug_recurrent_mem_tr__dense_activation_relu__prompt'

def setup_inputs():

    _w = lambda a: (lambda t: t.to(torch.bfloat16) if t.is_floating_point() else t)(torch.as_tensor(a))

    def _A_setup():
        B, S, Dm = (1, 2048, 640)
        H, Dh = (32, 192)
        M, seg = (8, 32)
        seg = min(seg, S)
        S = S // seg * seg
        return {'x': _w((lambda *s: torch.randn(*s, dtype=torch.bfloat16) * 0.05)(B, S, Dm)), 'mem0': _w((lambda *s: torch.randn(*s, dtype=torch.bfloat16) * 1.6)(B, M, Dm)), 'Wq': _w((lambda *s: torch.randn(*s, dtype=torch.bfloat16) * 0.8)(Dm, H, Dh) * Dm ** (-0.5)), 'Wk': _w((lambda *s: torch.randn(*s, dtype=torch.bfloat16) * 0.8)(Dm, H, Dh) * Dm ** (-0.5)), 'Wv': _w((lambda *s: torch.randn(*s, dtype=torch.bfloat16) * 1.6)(Dm, H, Dh) * Dm ** (-0.5)), 'Wo': _w((lambda *s: torch.randn(*s, dtype=torch.bfloat16) * 1.6)(H, Dh, Dm) * (H * Dh) ** (-0.5)), 'seg_len': seg}
    _A_in = _A_setup()

    def _B_setup():
        B, S, D, Dff = (1, 2048, 640, 1536)
        return {'x': _w((lambda *s: torch.randn(*s, dtype=torch.bfloat16) * 0.05)(B, S, D)), 'w1': _w((lambda *s: torch.randn(*s, dtype=torch.bfloat16) * 0.05)(D, Dff)), 'w2': _w((lambda *s: torch.randn(*s, dtype=torch.bfloat16) * 0.05)(Dff, D))}
    _B_in = _B_setup()
    return {'A_x': _A_in['x'], 'A_mem0': _A_in['mem0'], 'A_Wq': _A_in['Wq'], 'A_Wk': _A_in['Wk'], 'A_Wv': _A_in['Wv'], 'A_Wo': _A_in['Wo'], 'A_seg_len': _A_in['seg_len'], 'B_x': _B_in['x'], 'B_w1': _B_in['w1'], 'B_w2': _B_in['w2']}

def reference(A_x, A_mem0, A_Wq, A_Wk, A_Wv, A_Wo, A_seg_len, B_x, B_w1, B_w2):

    def _A_ref(x, mem0, Wq, Wk, Wv, Wo, seg_len):
        B, S, Dm = x.shape
        H, Dh = (Wq.shape[1], Wq.shape[2])
        M = mem0.shape[1]
        scale = Dh ** (-0.5)
        n_seg = S // seg_len
        L = M + seg_len
        idx = torch.arange(L)
        mask = (idx[:, None] < M) | (idx[:, None] >= idx[None, :])
        mem = mem0
        outs = []
        for s in range(n_seg):
            xs = x[:, s * seg_len:(s + 1) * seg_len, :].clone()
            h = torch.concatenate([mem, xs], axis=1)
            q = torch.einsum('btd,dhe->bhte', h, Wq)
            k = torch.einsum('btd,dhe->bhte', h, Wk)
            v = torch.einsum('btd,dhe->bhte', h, Wv)
            scores = torch.einsum('bhqe,bhke->bhqk', q, k) * scale
            scores = torch.where(mask[None, None], scores, -1000000000.0)
            p = _softmax(scores, axis=-1)
            o = torch.einsum('bhqk,bhke->bhqe', p, v)
            o = torch.einsum('bhte,hed->btd', o, Wo)
            mem = o[:, :M, :].clone()
            outs.append(o[:, M:, :])
        return torch.concatenate(outs, axis=1)

    def _B_ref(x, w1, w2):
        h = torch.einsum('bsd,df->bsf', x, w1)
        zero = torch.zeros_like(h)
        h = torch.maximum(h, zero)
        return torch.einsum('bsf,fd->bsd', h, w2)
    x = A_x
    xn = _layernorm(x, axis=-1)
    return x + _A_ref(xn, A_mem0, A_Wq, A_Wk, A_Wv, A_Wo, A_seg_len) + _B_ref(xn, B_w1, B_w2)
```

```asm
; @launch grid=(256,1,1) block=(256,1,1) lds=163840
.amdgcn_target "amdgcn-amd-amdhsa--gfx950"
.text
.globl parallel_sum__memory_aug_recurrent_mem_tr__dense_activation_relu__prompt_kernel
.p2align 8
.type parallel_sum__memory_aug_recurrent_mem_tr__dense_activation_relu__prompt_kernel,@function
parallel_sum__memory_aug_recurrent_mem_tr__dense_activation_relu__prompt_kernel:
    s_load_dwordx16 s[36:51], s[0:1], 0
    s_load_dwordx8 s[52:59], s[0:1], 64
    s_load_dwordx2 s[60:61], s[0:1], 96
    s_cmp_ge_u32 s2, 256
    s_cbranch_scc1 L_exit
    s_getpc_b64 s[96:97]
L_pc:
    s_bfe_u32 s28, s2, 0x20003
    s_lshl_b32 s28, s28, 15
    v_lshl_add_u32 v2, v0, 7, s28
    v_min_u32 v2, L_end-L_pc-4, v2
    global_load_dword v255, v2, s[96:97]
    s_and_b32 s28, s2, 0xfe
    s_lshl_b32 s28, s28, 1
    s_add_u32 s28, s28, L_tab-L_pc
    s_load_dword s29, s[96:97], s28
    v_and_b32 v1, 63, v0
    v_lshrrev_b32 v2, 6, v0
    s_nop 0
    v_readfirstlane_b32 s24, v2
    s_and_b32 s28, s2, 1
    s_lshl_b32 s28, s28, 4
    s_waitcnt lgkmcnt(0)
    s_mov_b32 s4, s60
    s_mov_b32 s5, s61
    s_mov_b32 s6, 268435456
    s_mov_b32 s7, 0x20000
    s_mov_b32 s16, s58
    s_mov_b32 s17, s59
    s_mov_b32 s18, 256
    s_mov_b32 s19, 0x20000
    s_sub_u32 s33, 0, s60
    s_and_b32 s33, s33, 0x1fffff
    s_add_u32 s33, s33, 167772160
    s_lshr_b32 s29, s29, s28
    s_and_b32 s25, s29, 63
    s_bfe_u32 s29, s29, 0x40008
    s_cmp_eq_u32 s29, 0
    s_cbranch_scc1 W_S
    s_cmp_eq_u32 s29, 1
    s_cbranch_scc1 W_Z
    s_cmp_eq_u32 s29, 2
    s_cbranch_scc1 W_C
    s_cmp_eq_u32 s29, 3
    s_cbranch_scc1 W_K
    s_cmp_eq_u32 s29, 4
    s_cbranch_scc1 W_V
    s_cmp_eq_u32 s29, 5
    s_cbranch_scc1 W_U
    s_cmp_eq_u32 s29, 6
    s_cbranch_scc1 W_Q
    s_cmp_eq_u32 s29, 7
    s_cbranch_scc1 W_H
    s_cmp_eq_u32 s29, 8
    s_cbranch_scc1 W_O
    s_cmp_eq_u32 s29, 9
    s_cbranch_scc1 W_L
L_exit:
    s_endpgm
.p2align 6
.type L_tab,@object
L_tab:
.long 0x200, 0x100214, 0x7000316, 0x7040702
.long 0x10201, 0x110215, 0x7010317, 0x7050703
.long 0x20202, 0x120216, 0x4060400, 0x412040c
.long 0x30203, 0x130217, 0x4070401, 0x413040d
.long 0x40204, 0x140218, 0x4080402, 0x414040e
.long 0x50205, 0x150219, 0x4090403, 0x415040f
.long 0x60206, 0x16021a, 0x40a0404, 0x4160410
.long 0x70207, 0x17021b, 0x40b0405, 0x4170411
.long 0x80208, 0x18021c, 0x5080500, 0x5180510
.long 0x90209, 0x19021d, 0x5090501, 0x5190511
.long 0xa020a, 0x1a021e, 0x50a0502, 0x51a0512
.long 0xb020b, 0x1b021f, 0x50b0503, 0x51b0513
.long 0xc020c, 0x1c0220, 0x50c0504, 0x51c0514
.long 0xd020d, 0x1d0221, 0x50d0505, 0x51d0515
.long 0xe020e, 0x1e0222, 0x50e0506, 0x51e0516
.long 0xf020f, 0x1f0223, 0x50f0507, 0x51f0517
.long 0x1000210, 0x1100224, 0x6080600, 0x6180610
.long 0x1010211, 0x1110225, 0x6090601, 0x6190611
.long 0x1020212, 0x1120226, 0x60a0602, 0x61a0612
.long 0x1030213, 0x1130227, 0x60b0603, 0x61b0613
.long 0x1040300, 0x114030b, 0x60c0604, 0x61c0614
.long 0x1050301, 0x115030c, 0x60d0605, 0x61d0615
.long 0x1060302, 0x116030d, 0x60e0606, 0x61e0616
.long 0x1070303, 0x117030e, 0x60f0607, 0x61f0617
.long 0x1080304, 0x118030f, 0x8080800, 0x8180810
.long 0x1090305, 0x1190310, 0x8090801, 0x8190811
.long 0x10a0306, 0x11a0311, 0x80a0802, 0x81a0812
.long 0x10b0307, 0x11b0312, 0x80b0803, 0x81b0813
.long 0x10c0308, 0x11c0313, 0x80c0804, 0x81c0814
.long 0x10d0309, 0x11d0314, 0x80d0805, 0x81d0815
.long 0x10e030a, 0x11e0315, 0x80e0806, 0x81e0816
.long 0x10f0900, 0x11f0901, 0x80f0807, 0x81f0817
.size L_tab, 512
.p2align 6
W_S:
R_S:
    v_bfe_u32 v24, v1, 3, 1
    v_lshrrev_b32 v2, 4, v1
    v_lshl_add_u32 v24, v2, 2, v24
    v_and_b32 v2, 1, v1
    v_lshl_add_u32 v23, v2, 1, v24
    v_bfe_u32 v2, v1, 2, 1
    v_lshl_add_u32 v23, v2, 4, v23
    v_lshlrev_b32 v23, 4, v23
    v_bfe_u32 v3, v1, 1, 1
    v_lshl_add_u32 v23, v3, 3, v23
    s_lshr_b32 s28, s25, 4
    s_lshl_b32 s28, s28, 15
    s_and_b32 s29, s25, 15
    s_lshl_b32 s29, s29, 9
    s_add_u32 s28, s28, s29
    v_add_u32 v23, s28, v23
    v_lshlrev_b32 v24, 1, v1
    v_and_b32 v2, 1, v1
    v_lshl_add_u32 v24, v2, 30, v24
    s_lshl_b32 s28, s25, 7
    s_add_u32 s28, s28, 100352
    v_add_u32 v24, s28, v24
    v_and_b32 v26, 7, v1
    v_lshlrev_b32 v26, 3, v26
    v_lshrrev_b32 v2, 4, v1
    v_lshl_add_u32 v26, v2, 6, v26
    v_bfe_u32 v2, v1, 3, 1
    v_lshl_add_u32 v26, v2, 30, v26
    s_mul_i32 s65, s25, 3072
    s_mul_i32 s28, s24, 768
    s_add_u32 s65, s65, s28
    s_add_u32 s65, s65, 2818048
    s_add_u32 s65, s65, s33
    v_mov_b32 v2, -1
    v_mov_b32 v3, -1
    s_lshl_b32 s28, s24, 13
    s_add_u32 s28, s28, s33
    buffer_store_dwordx2 v[2:3], v23, s[4:7], s28 offen sc1
    buffer_store_dword v2, v24, s[4:7], s28 offen sc1
    s_add_u32 s28, s28, 131072
    buffer_store_dwordx2 v[2:3], v23, s[4:7], s28 offen sc1
    buffer_store_dword v2, v24, s[4:7], s28 offen sc1
    s_add_u32 s28, s65, 0
    buffer_store_dwordx2 v[2:3], v26, s[4:7], s28 offen offset:0 sc1
    buffer_store_dwordx2 v[2:3], v26, s[4:7], s28 offen offset:256 sc1
    buffer_store_dwordx2 v[2:3], v26, s[4:7], s28 offen offset:512 sc1
    s_add_u32 s28, s65, 1048576
    buffer_store_dwordx2 v[2:3], v26, s[4:7], s28 offen offset:0 sc1
    buffer_store_dwordx2 v[2:3], v26, s[4:7], s28 offen offset:256 sc1
    buffer_store_dwordx2 v[2:3], v26, s[4:7], s28 offen offset:512 sc1
    v_xor_b32 v0, 0, v0
    v_or_b32 v0, s25, v0
    v_min_u32 v0, 1, v0
    v_lshlrev_b32 v0, 30, v0
    v_mov_b32 v4, 0
    s_add_u32 s28, s33, 104448
    buffer_store_dword v4, v0, s[4:7], s28 offen sc1
    s_add_u32 s28, s33, 112640
    buffer_store_dword v4, v0, s[4:7], s28 offen sc1
    s_add_u32 s28, s33, 120832
    buffer_store_dword v4, v0, s[4:7], s28 offen sc1
    s_add_u32 s28, s33, 129024
    buffer_store_dword v4, v0, s[4:7], s28 offen sc1
    s_mov_b32 s8, s40
    s_mov_b32 s9, s41
    s_mov_b32 s10, 7864320
    s_mov_b32 s11, 0x20000
    s_mov_b32 s12, s42
    s_mov_b32 s13, s43
    s_mov_b32 s14, 7864320
    s_mov_b32 s15, 0x20000
    v_add_u32 v4, 0, v1
    v_mul_u32_u24 v5, 2731, v4
    v_lshrrev_b32 v5, 16, v5
    v_mul_u32_u24 v6, 24, v5
    v_sub_u32 v4, v4, v6
    v_mul_u32_u24 v5, 12288, v5
    v_lshl_add_u32 v6, v4, 4, v5
    v_add_u32 v4, 64, v1
    v_mul_u32_u24 v5, 2731, v4
    v_lshrrev_b32 v5, 16, v5
    v_mul_u32_u24 v7, 24, v5
    v_sub_u32 v4, v4, v7
    v_mul_u32_u24 v5, 12288, v5
    v_lshl_add_u32 v7, v4, 4, v5
    v_add_u32 v4, 128, v1
    v_mul_u32_u24 v5, 2731, v4
    v_lshrrev_b32 v5, 16, v5
    v_mul_u32_u24 v8, 24, v5
    v_sub_u32 v4, v4, v8
    v_mul_u32_u24 v5, 12288, v5
    v_lshl_add_u32 v8, v4, 4, v5
    v_and_b32 v10, 3, v1
    v_lshlrev_b32 v10, 3, v10
    v_bfe_u32 v11, v1, 5, 1
    v_mul_u32_u24 v11, 6144, v11
    v_add_u32 v10, v10, v11
    v_bfe_u32 v11, v1, 4, 1
    v_mul_u32_u24 v11, 1536, v11
    v_add_u32 v10, v10, v11
    v_bfe_u32 v11, v1, 3, 1
    v_mul_u32_u24 v11, 3072, v11
    v_add_u32 v10, v10, v11
    v_bfe_u32 v11, v1, 2, 1
    v_mul_u32_u24 v11, 384, v11
    v_add_u32 v10, v10, v11
    s_mul_i32 s28, s24, 96
    v_add_u32 v10, s28, v10
    v_add_u32 v11, 49152, v10
    v_add_u32 v12, 98304, v10
    s_mul_i32 s64, s24, 196608
    s_mul_i32 s28, s25, 384
    s_add_u32 s64, s64, s28
    s_mul_i32 s29, s24, 6144
    s_add_u32 s28, s64, 0
    s_add_u32 m0, s29, 0
    s_nop 0
    buffer_load_dwordx4 v6, s[8:11], s28 offen lds
    s_add_u32 m0, s29, 1024
    s_nop 0
    buffer_load_dwordx4 v7, s[8:11], s28 offen lds
    s_add_u32 m0, s29, 2048
    s_nop 0
    buffer_load_dwordx4 v8, s[8:11], s28 offen lds
    s_add_u32 s28, s64, 98304
    s_add_u32 m0, s29, 3072
    s_nop 0
    buffer_load_dwordx4 v6, s[8:11], s28 offen lds
    s_add_u32 m0, s29, 4096
    s_nop 0
    buffer_load_dwordx4 v7, s[8:11], s28 offen lds
    s_add_u32 m0, s29, 5120
    s_nop 0
    buffer_load_dwordx4 v8, s[8:11], s28 offen lds
    s_mul_i32 s29, s24, 6144
    s_add_u32 s28, s64, 786432
    s_add_u32 m0, s29, 24576
    s_nop 0
    buffer_load_dwordx4 v6, s[8:11], s28 offen lds
    s_add_u32 m0, s29, 25600
    s_nop 0
    buffer_load_dwordx4 v7, s[8:11], s28 offen lds
    s_add_u32 m0, s29, 26624
    s_nop 0
    buffer_load_dwordx4 v8, s[8:11], s28 offen lds
    s_add_u32 s28, s64, 884736
    s_add_u32 m0, s29, 27648
    s_nop 0
    buffer_load_dwordx4 v6, s[8:11], s28 offen lds
    s_add_u32 m0, s29, 28672
    s_nop 0
    buffer_load_dwordx4 v7, s[8:11], s28 offen lds
    s_add_u32 m0, s29, 29696
    s_nop 0
    buffer_load_dwordx4 v8, s[8:11], s28 offen lds
    s_waitcnt vmcnt(12)
    s_barrier
    s_cmp_lg_u32 s24, 0
    s_cbranch_scc1 Larr_1
    s_and_b32 s28, s2, 1
    s_lshl_b32 s28, s28, 6
    v_mov_b32 v4, 1
    s_mov_b64 exec, 1
    buffer_atomic_add v4, off, s[16:19], s28 sc1
    s_mov_b64 exec, -1
Larr_1:
    s_mul_i32 s29, s24, 6144
    s_add_u32 s28, s64, 1572864
    s_add_u32 m0, s29, 49152
    s_nop 0
    buffer_load_dwordx4 v6, s[8:11], s28 offen lds
    s_add_u32 m0, s29, 50176
    s_nop 0
    buffer_load_dwordx4 v7, s[8:11], s28 offen lds
    s_add_u32 m0, s29, 51200
    s_nop 0
    buffer_load_dwordx4 v8, s[8:11], s28 offen lds
    s_add_u32 s28, s64, 1671168
    s_add_u32 m0, s29, 52224
    s_nop 0
    buffer_load_dwordx4 v6, s[8:11], s28 offen lds
    s_add_u32 m0, s29, 53248
    s_nop 0
    buffer_load_dwordx4 v7, s[8:11], s28 offen lds
    s_add_u32 m0, s29, 54272
    s_nop 0
    buffer_load_dwordx4 v8, s[8:11], s28 offen lds
    s_mul_i32 s29, s24, 6144
    s_add_u32 s28, s64, 2359296
    s_add_u32 m0, s29, 73728
    s_nop 0
    buffer_load_dwordx4 v6, s[8:11], s28 offen lds
    s_add_u32 m0, s29, 74752
    s_nop 0
    buffer_load_dwordx4 v7, s[8:11], s28 offen lds
    s_add_u32 m0, s29, 75776
    s_nop 0
    buffer_load_dwordx4 v8, s[8:11], s28 offen lds
    s_add_u32 s28, s64, 2457600
    s_add_u32 m0, s29, 76800
    s_nop 0
    buffer_load_dwordx4 v6, s[8:11], s28 offen lds
    s_add_u32 m0, s29, 77824
    s_nop 0
    buffer_load_dwordx4 v7, s[8:11], s28 offen lds
    s_add_u32 m0, s29, 78848
    s_nop 0
    buffer_load_dwordx4 v8, s[8:11], s28 offen lds
    s_mul_i32 s29, s24, 6144
    s_add_u32 s28, s64, 3145728
    s_add_u32 m0, s29, 98304
    s_nop 0
    buffer_load_dwordx4 v6, s[8:11], s28 offen lds
    s_add_u32 m0, s29, 99328
    s_nop 0
    buffer_load_dwordx4 v7, s[8:11], s28 offen lds
    s_add_u32 m0, s29, 100352
    s_nop 0
    buffer_load_dwordx4 v8, s[8:11], s28 offen lds
    s_add_u32 s28, s64, 3244032
    s_add_u32 m0, s29, 101376
    s_nop 0
    buffer_load_dwordx4 v6, s[8:11], s28 offen lds
    s_add_u32 m0, s29, 102400
    s_nop 0
    buffer_load_dwordx4 v7, s[8:11], s28 offen lds
    s_add_u32 m0, s29, 103424
    s_nop 0
    buffer_load_dwordx4 v8, s[8:11], s28 offen lds
    s_mul_i32 s29, s24, 6144
    s_add_u32 s28, s64, 3932160
    s_add_u32 m0, s29, 122880
    s_nop 0
    buffer_load_dwordx4 v6, s[8:11], s28 offen lds
    s_add_u32 m0, s29, 123904
    s_nop 0
    buffer_load_dwordx4 v7, s[8:11], s28 offen lds
    s_add_u32 m0, s29, 124928
    s_nop 0
    buffer_load_dwordx4 v8, s[8:11], s28 offen lds
    s_add_u32 s28, s64, 4030464
    s_add_u32 m0, s29, 125952
    s_nop 0
    buffer_load_dwordx4 v6, s[8:11], s28 offen lds
    s_add_u32 m0, s29, 126976
    s_nop 0
    buffer_load_dwordx4 v7, s[8:11], s28 offen lds
    s_add_u32 m0, s29, 128000
    s_nop 0
    buffer_load_dwordx4 v8, s[8:11], s28 offen lds
    s_waitcnt vmcnt(30)
    s_waitcnt lgkmcnt(0)
    s_barrier
    ds_read_b64_tr_b16 a[0:1], v10 offset:0
    ds_read_b64_tr_b16 a[2:3], v10 offset:768
    ds_read_b64_tr_b16 a[8:9], v10 offset:32
    ds_read_b64_tr_b16 a[10:11], v10 offset:800
    ds_read_b64_tr_b16 a[16:17], v10 offset:64
    ds_read_b64_tr_b16 a[18:19], v10 offset:832
    ds_read_b64_tr_b16 a[4:5], v10 offset:12288
    ds_read_b64_tr_b16 a[6:7], v10 offset:13056
    ds_read_b64_tr_b16 a[12:13], v10 offset:12320
    ds_read_b64_tr_b16 a[14:15], v10 offset:13088
    ds_read_b64_tr_b16 a[20:21], v10 offset:12352
    ds_read_b64_tr_b16 a[22:23], v10 offset:13120
    s_waitcnt vmcnt(24)
    s_waitcnt lgkmcnt(0)
    s_barrier
    ds_read_b64_tr_b16 a[24:25], v10 offset:24576
    ds_read_b64_tr_b16 a[26:27], v10 offset:25344
    ds_read_b64_tr_b16 a[32:33], v10 offset:24608
    ds_read_b64_tr_b16 a[34:35], v10 offset:25376
    ds_read_b64_tr_b16 a[40:41], v10 offset:24640
    ds_read_b64_tr_b16 a[42:43], v10 offset:25408
    ds_read_b64_tr_b16 a[28:29], v10 offset:36864
    ds_read_b64_tr_b16 a[30:31], v10 offset:37632
    ds_read_b64_tr_b16 a[36:37], v10 offset:36896
    ds_read_b64_tr_b16 a[38:39], v10 offset:37664
    ds_read_b64_tr_b16 a[44:45], v10 offset:36928
    ds_read_b64_tr_b16 a[46:47], v10 offset:37696
    s_mul_i32 s29, s24, 6144
    s_add_u32 s28, s64, 4718592
    s_add_u32 m0, s29, 0
    s_nop 0
    buffer_load_dwordx4 v6, s[8:11], s28 offen lds
    s_add_u32 m0, s29, 1024
    s_nop 0
    buffer_load_dwordx4 v7, s[8:11], s28 offen lds
    s_add_u32 m0, s29, 2048
    s_nop 0
    buffer_load_dwordx4 v8, s[8:11], s28 offen lds
    s_add_u32 s28, s64, 4816896
    s_add_u32 m0, s29, 3072
    s_nop 0
    buffer_load_dwordx4 v6, s[8:11], s28 offen lds
    s_add_u32 m0, s29, 4096
    s_nop 0
    buffer_load_dwordx4 v7, s[8:11], s28 offen lds
    s_add_u32 m0, s29, 5120
    s_nop 0
    buffer_load_dwordx4 v8, s[8:11], s28 offen lds
    s_waitcnt vmcnt(24)
    s_waitcnt lgkmcnt(0)
    s_barrier
    ds_read_b64_tr_b16 a[48:49], v11 offset:0
    ds_read_b64_tr_b16 a[50:51], v11 offset:768
    ds_read_b64_tr_b16 a[56:57], v11 offset:32
    ds_read_b64_tr_b16 a[58:59], v11 offset:800
    ds_read_b64_tr_b16 a[64:65], v11 offset:64
    ds_read_b64_tr_b16 a[66:67], v11 offset:832
    ds_read_b64_tr_b16 a[52:53], v11 offset:12288
    ds_read_b64_tr_b16 a[54:55], v11 offset:13056
    ds_read_b64_tr_b16 a[60:61], v11 offset:12320
    ds_read_b64_tr_b16 a[62:63], v11 offset:13088
    ds_read_b64_tr_b16 a[68:69], v11 offset:12352
    ds_read_b64_tr_b16 a[70:71], v11 offset:13120
    s_mul_i32 s29, s24, 6144
    s_add_u32 s28, s64, 5505024
    s_add_u32 m0, s29, 24576
    s_nop 0
    buffer_load_dwordx4 v6, s[8:11], s28 offen lds
    s_add_u32 m0, s29, 25600
    s_nop 0
    buffer_load_dwordx4 v7, s[8:11], s28 offen lds
    s_add_u32 m0, s29, 26624
    s_nop 0
    buffer_load_dwordx4 v8, s[8:11], s28 offen lds
    s_add_u32 s28, s64, 5603328
    s_add_u32 m0, s29, 27648
    s_nop 0
    buffer_load_dwordx4 v6, s[8:11], s28 offen lds
    s_add_u32 m0, s29, 28672
    s_nop 0
    buffer_load_dwordx4 v7, s[8:11], s28 offen lds
    s_add_u32 m0, s29, 29696
    s_nop 0
    buffer_load_dwordx4 v8, s[8:11], s28 offen lds
    s_waitcnt vmcnt(24)
    s_waitcnt lgkmcnt(0)
    s_barrier
    ds_read_b64_tr_b16 a[72:73], v11 offset:24576
    ds_read_b64_tr_b16 a[74:75], v11 offset:25344
    ds_read_b64_tr_b16 a[104:105], v11 offset:24608
    ds_read_b64_tr_b16 a[106:107], v11 offset:25376
    ds_read_b64_tr_b16 v[64:65], v11 offset:24640
    ds_read_b64_tr_b16 v[66:67], v11 offset:25408
    ds_read_b64_tr_b16 a[76:77], v11 offset:36864
    ds_read_b64_tr_b16 a[78:79], v11 offset:37632
    ds_read_b64_tr_b16 a[108:109], v11 offset:36896
    ds_read_b64_tr_b16 a[110:111], v11 offset:37664
    ds_read_b64_tr_b16 v[68:69], v11 offset:36928
    ds_read_b64_tr_b16 v[70:71], v11 offset:37696
    s_mul_i32 s29, s24, 6144
    s_add_u32 s28, s64, 6291456
    s_add_u32 m0, s29, 49152
    s_nop 0
    buffer_load_dwordx4 v6, s[8:11], s28 offen lds
    s_add_u32 m0, s29, 50176
    s_nop 0
    buffer_load_dwordx4 v7, s[8:11], s28 offen lds
    s_add_u32 m0, s29, 51200
    s_nop 0
    buffer_load_dwordx4 v8, s[8:11], s28 offen lds
    s_add_u32 s28, s64, 6389760
    s_add_u32 m0, s29, 52224
    s_nop 0
    buffer_load_dwordx4 v6, s[8:11], s28 offen lds
    s_add_u32 m0, s29, 53248
    s_nop 0
    buffer_load_dwordx4 v7, s[8:11], s28 offen lds
    s_add_u32 m0, s29, 54272
    s_nop 0
    buffer_load_dwordx4 v8, s[8:11], s28 offen lds
    s_waitcnt vmcnt(24)
    s_waitcnt lgkmcnt(0)
    s_barrier
    ds_read_b64_tr_b16 a[80:81], v12 offset:0
    ds_read_b64_tr_b16 a[82:83], v12 offset:768
    ds_read_b64_tr_b16 v[56:57], v12 offset:32
    ds_read_b64_tr_b16 v[58:59], v12 offset:800
    ds_read_b64_tr_b16 a[152:153], v12 offset:64
    ds_read_b64_tr_b16 a[154:155], v12 offset:832
    ds_read_b64_tr_b16 a[84:85], v12 offset:12288
    ds_read_b64_tr_b16 a[86:87], v12 offset:13056
    ds_read_b64_tr_b16 v[60:61], v12 offset:12320
    ds_read_b64_tr_b16 v[62:63], v12 offset:13088
    ds_read_b64_tr_b16 a[156:157], v12 offset:12352
    ds_read_b64_tr_b16 a[158:159], v12 offset:13120
    s_mul_i32 s29, s24, 6144
    s_add_u32 s28, s64, 7077888
    s_add_u32 m0, s29, 73728
    s_nop 0
    buffer_load_dwordx4 v6, s[8:11], s28 offen lds
    s_add_u32 m0, s29, 74752
    s_nop 0
    buffer_load_dwordx4 v7, s[8:11], s28 offen lds
    s_add_u32 m0, s29, 75776
    s_nop 0
    buffer_load_dwordx4 v8, s[8:11], s28 offen lds
    s_add_u32 s28, s64, 7176192
    s_add_u32 m0, s29, 76800
    s_nop 0
    buffer_load_dwordx4 v6, s[8:11], s28 offen lds
    s_add_u32 m0, s29, 77824
    s_nop 0
    buffer_load_dwordx4 v7, s[8:11], s28 offen lds
    s_add_u32 m0, s29, 78848
    s_nop 0
    buffer_load_dwordx4 v8, s[8:11], s28 offen lds
    s_waitcnt vmcnt(24)
    s_waitcnt lgkmcnt(0)
    s_barrier
    ds_read_b64_tr_b16 a[88:89], v12 offset:24576
    ds_read_b64_tr_b16 a[90:91], v12 offset:25344
    ds_read_b64_tr_b16 a[112:113], v12 offset:24608
    ds_read_b64_tr_b16 a[114:115], v12 offset:25376
    ds_read_b64_tr_b16 v[72:73], v12 offset:24640
    ds_read_b64_tr_b16 v[74:75], v12 offset:25408
    ds_read_b64_tr_b16 a[92:93], v12 offset:36864
    ds_read_b64_tr_b16 a[94:95], v12 offset:37632
    ds_read_b64_tr_b16 a[116:117], v12 offset:36896
    ds_read_b64_tr_b16 a[118:119], v12 offset:37664
    ds_read_b64_tr_b16 v[76:77], v12 offset:36928
    ds_read_b64_tr_b16 v[78:79], v12 offset:37696
    s_mul_i32 s29, s24, 6144
    s_add_u32 s28, s64, 0
    s_add_u32 m0, s29, 98304
    s_nop 0
    buffer_load_dwordx4 v6, s[12:15], s28 offen lds
    s_add_u32 m0, s29, 99328
    s_nop 0
    buffer_load_dwordx4 v7, s[12:15], s28 offen lds
    s_add_u32 m0, s29, 100352
    s_nop 0
    buffer_load_dwordx4 v8, s[12:15], s28 offen lds
    s_add_u32 s28, s64, 98304
    s_add_u32 m0, s29, 101376
    s_nop 0
    buffer_load_dwordx4 v6, s[12:15], s28 offen lds
    s_add_u32 m0, s29, 102400
    s_nop 0
    buffer_load_dwordx4 v7, s[12:15], s28 offen lds
    s_add_u32 m0, s29, 103424
    s_nop 0
    buffer_load_dwordx4 v8, s[12:15], s28 offen lds
    s_waitcnt vmcnt(24)
    s_waitcnt lgkmcnt(0)
    s_barrier
    ds_read_b64_tr_b16 v[32:33], v10 offset:0
    ds_read_b64_tr_b16 v[34:35], v10 offset:768
    ds_read_b64_tr_b16 a[120:121], v10 offset:32
    ds_read_b64_tr_b16 a[122:123], v10 offset:800
    ds_read_b64_tr_b16 a[160:161], v10 offset:64
    ds_read_b64_tr_b16 a[162:163], v10 offset:832
    ds_read_b64_tr_b16 v[36:37], v10 offset:12288
    ds_read_b64_tr_b16 v[38:39], v10 offset:13056
    ds_read_b64_tr_b16 a[124:125], v10 offset:12320
    ds_read_b64_tr_b16 a[126:127], v10 offset:13088
    ds_read_b64_tr_b16 a[164:165], v10 offset:12352
    ds_read_b64_tr_b16 a[166:167], v10 offset:13120
    s_mul_i32 s29, s24, 6144
    s_add_u32 s28, s64, 786432
    s_add_u32 m0, s29, 122880
    s_nop 0
    buffer_load_dwordx4 v6, s[12:15], s28 offen lds
    s_add_u32 m0, s29, 123904
    s_nop 0
    buffer_load_dwordx4 v7, s[12:15], s28 offen lds
    s_add_u32 m0, s29, 124928
    s_nop 0
    buffer_load_dwordx4 v8, s[12:15], s28 offen lds
    s_add_u32 s28, s64, 884736
    s_add_u32 m0, s29, 125952
    s_nop 0
    buffer_load_dwordx4 v6, s[12:15], s28 offen lds
    s_add_u32 m0, s29, 126976
    s_nop 0
    buffer_load_dwordx4 v7, s[12:15], s28 offen lds
    s_add_u32 m0, s29, 128000
    s_nop 0
    buffer_load_dwordx4 v8, s[12:15], s28 offen lds
    s_waitcnt vmcnt(24)
    s_waitcnt lgkmcnt(0)
    s_barrier
    ds_read_b64_tr_b16 v[40:41], v10 offset:24576
    ds_read_b64_tr_b16 v[42:43], v10 offset:25344
    ds_read_b64_tr_b16 a[128:129], v10 offset:24608
    ds_read_b64_tr_b16 a[130:131], v10 offset:25376
    ds_read_b64_tr_b16 a[168:169], v10 offset:24640
    ds_read_b64_tr_b16 a[170:171], v10 offset:25408
    ds_read_b64_tr_b16 v[44:45], v10 offset:36864
    ds_read_b64_tr_b16 v[46:47], v10 offset:37632
    ds_read_b64_tr_b16 a[132:133], v10 offset:36896
    ds_read_b64_tr_b16 a[134:135], v10 offset:37664
    ds_read_b64_tr_b16 a[172:173], v10 offset:36928
    ds_read_b64_tr_b16 a[174:175], v10 offset:37696
    s_mul_i32 s29, s24, 6144
    s_add_u32 s28, s64, 1572864
    s_add_u32 m0, s29, 0
    s_nop 0
    buffer_load_dwordx4 v6, s[12:15], s28 offen lds
    s_add_u32 m0, s29, 1024
    s_nop 0
    buffer_load_dwordx4 v7, s[12:15], s28 offen lds
    s_add_u32 m0, s29, 2048
    s_nop 0
    buffer_load_dwordx4 v8, s[12:15], s28 offen lds
    s_add_u32 s28, s64, 1671168
    s_add_u32 m0, s29, 3072
    s_nop 0
    buffer_load_dwordx4 v6, s[12:15], s28 offen lds
    s_add_u32 m0, s29, 4096
    s_nop 0
    buffer_load_dwordx4 v7, s[12:15], s28 offen lds
    s_add_u32 m0, s29, 5120
    s_nop 0
    buffer_load_dwordx4 v8, s[12:15], s28 offen lds
    s_waitcnt vmcnt(24)
    s_waitcnt lgkmcnt(0)
    s_barrier
    ds_read_b64_tr_b16 a[96:97], v11 offset:0
    ds_read_b64_tr_b16 a[98:99], v11 offset:768
    ds_read_b64_tr_b16 a[136:137], v11 offset:32
    ds_read_b64_tr_b16 a[138:139], v11 offset:800
    ds_read_b64_tr_b16 a[176:177], v11 offset:64
    ds_read_b64_tr_b16 a[178:179], v11 offset:832
    ds_read_b64_tr_b16 a[100:101], v11 offset:12288
    ds_read_b64_tr_b16 a[102:103], v11 offset:13056
    ds_read_b64_tr_b16 a[140:141], v11 offset:12320
    ds_read_b64_tr_b16 a[142:143], v11 offset:13088
    ds_read_b64_tr_b16 a[180:181], v11 offset:12352
    ds_read_b64_tr_b16 a[182:183], v11 offset:13120
    s_mul_i32 s29, s24, 6144
    s_add_u32 s28, s64, 2359296
    s_add_u32 m0, s29, 24576
    s_nop 0
    buffer_load_dwordx4 v6, s[12:15], s28 offen lds
    s_add_u32 m0, s29, 25600
    s_nop 0
    buffer_load_dwordx4 v7, s[12:15], s28 offen lds
    s_add_u32 m0, s29, 26624
    s_nop 0
    buffer_load_dwordx4 v8, s[12:15], s28 offen lds
    s_add_u32 s28, s64, 2457600
    s_add_u32 m0, s29, 27648
    s_nop 0
    buffer_load_dwordx4 v6, s[12:15], s28 offen lds
    s_add_u32 m0, s29, 28672
    s_nop 0
    buffer_load_dwordx4 v7, s[12:15], s28 offen lds
    s_add_u32 m0, s29, 29696
    s_nop 0
    buffer_load_dwordx4 v8, s[12:15], s28 offen lds
    s_waitcnt vmcnt(24)
    s_waitcnt lgkmcnt(0)
    s_barrier
    ds_read_b64_tr_b16 v[48:49], v11 offset:24576
    ds_read_b64_tr_b16 v[50:51], v11 offset:25344
    ds_read_b64_tr_b16 a[144:145], v11 offset:24608
    ds_read_b64_tr_b16 a[146:147], v11 offset:25376
    ds_read_b64_tr_b16 v[80:81], v11 offset:24640
    ds_read_b64_tr_b16 v[82:83], v11 offset:25408
    ds_read_b64_tr_b16 v[52:53], v11 offset:36864
    ds_read_b64_tr_b16 v[54:55], v11 offset:37632
    ds_read_b64_tr_b16 a[148:149], v11 offset:36896
    ds_read_b64_tr_b16 a[150:151], v11 offset:37664
    ds_read_b64_tr_b16 v[84:85], v11 offset:36928
    ds_read_b64_tr_b16 v[86:87], v11 offset:37696
    s_mul_i32 s29, s24, 6144
    s_add_u32 s28, s64, 3145728
    s_add_u32 m0, s29, 49152
    s_nop 0
    buffer_load_dwordx4 v6, s[12:15], s28 offen lds
    s_add_u32 m0, s29, 50176
    s_nop 0
    buffer_load_dwordx4 v7, s[12:15], s28 offen lds
    s_add_u32 m0, s29, 51200
    s_nop 0
    buffer_load_dwordx4 v8, s[12:15], s28 offen lds
    s_add_u32 s28, s64, 3244032
    s_add_u32 m0, s29, 52224
    s_nop 0
    buffer_load_dwordx4 v6, s[12:15], s28 offen lds
    s_add_u32 m0, s29, 53248
    s_nop 0
    buffer_load_dwordx4 v7, s[12:15], s28 offen lds
    s_add_u32 m0, s29, 54272
    s_nop 0
    buffer_load_dwordx4 v8, s[12:15], s28 offen lds
    s_waitcnt vmcnt(24)
    s_waitcnt lgkmcnt(0)
    s_barrier
    ds_read_b64_tr_b16 a[184:185], v12 offset:0
    ds_read_b64_tr_b16 a[186:187], v12 offset:768
    ds_read_b64_tr_b16 v[112:113], v12 offset:32
    ds_read_b64_tr_b16 v[114:115], v12 offset:800
    ds_read_b64_tr_b16 v[208:209], v12 offset:64
    ds_read_b64_tr_b16 v[210:211], v12 offset:832
    ds_read_b64_tr_b16 a[188:189], v12 offset:12288
    ds_read_b64_tr_b16 a[190:191], v12 offset:13056
    ds_read_b64_tr_b16 v[116:117], v12 offset:12320
    ds_read_b64_tr_b16 v[118:119], v12 offset:13088
    ds_read_b64_tr_b16 v[212:213], v12 offset:12352
    ds_read_b64_tr_b16 v[214:215], v12 offset:13120
    s_mul_i32 s29, s24, 6144
    s_add_u32 s28, s64, 3932160
    s_add_u32 m0, s29, 73728
    s_nop 0
    buffer_load_dwordx4 v6, s[12:15], s28 offen lds
    s_add_u32 m0, s29, 74752
    s_nop 0
    buffer_load_dwordx4 v7, s[12:15], s28 offen lds
    s_add_u32 m0, s29, 75776
    s_nop 0
    buffer_load_dwordx4 v8, s[12:15], s28 offen lds
    s_add_u32 s28, s64, 4030464
    s_add_u32 m0, s29, 76800
    s_nop 0
    buffer_load_dwordx4 v6, s[12:15], s28 offen lds
    s_add_u32 m0, s29, 77824
    s_nop 0
    buffer_load_dwordx4 v7, s[12:15], s28 offen lds
    s_add_u32 m0, s29, 78848
    s_nop 0
    buffer_load_dwordx4 v8, s[12:15], s28 offen lds
    s_waitcnt vmcnt(24)
    s_waitcnt lgkmcnt(0)
    s_barrier
    ds_read_b64_tr_b16 v[88:89], v12 offset:24576
    ds_read_b64_tr_b16 v[90:91], v12 offset:25344
    ds_read_b64_tr_b16 a[240:241], v12 offset:24608
    ds_read_b64_tr_b16 a[242:243], v12 offset:25376
    ds_read_b64_tr_b16 v[216:217], v12 offset:24640
    ds_read_b64_tr_b16 v[218:219], v12 offset:25408
    ds_read_b64_tr_b16 v[92:93], v12 offset:36864
    ds_read_b64_tr_b16 v[94:95], v12 offset:37632
    ds_read_b64_tr_b16 a[244:245], v12 offset:36896
    ds_read_b64_tr_b16 a[246:247], v12 offset:37664
    ds_read_b64_tr_b16 v[220:221], v12 offset:36928
    ds_read_b64_tr_b16 v[222:223], v12 offset:37696
    s_mul_i32 s29, s24, 6144
    s_add_u32 s28, s64, 4718592
    s_add_u32 m0, s29, 98304
    s_nop 0
    buffer_load_dwordx4 v6, s[12:15], s28 offen lds
    s_add_u32 m0, s29, 99328
    s_nop 0
    buffer_load_dwordx4 v7, s[12:15], s28 offen lds
    s_add_u32 m0, s29, 100352
    s_nop 0
    buffer_load_dwordx4 v8, s[12:15], s28 offen lds
    s_add_u32 s28, s64, 4816896
    s_add_u32 m0, s29, 101376
    s_nop 0
    buffer_load_dwordx4 v6, s[12:15], s28 offen lds
    s_add_u32 m0, s29, 102400
    s_nop 0
    buffer_load_dwordx4 v7, s[12:15], s28 offen lds
    s_add_u32 m0, s29, 103424
    s_nop 0
    buffer_load_dwordx4 v8, s[12:15], s28 offen lds
    s_waitcnt vmcnt(24)
    s_waitcnt lgkmcnt(0)
    s_barrier
    ds_read_b64_tr_b16 a[192:193], v10 offset:0
    ds_read_b64_tr_b16 a[194:195], v10 offset:768
    ds_read_b64_tr_b16 v[120:121], v10 offset:32
    ds_read_b64_tr_b16 v[122:123], v10 offset:800
    ds_read_b64_tr_b16 v[128:129], v10 offset:64
    ds_read_b64_tr_b16 v[130:131], v10 offset:832
    ds_read_b64_tr_b16 a[196:197], v10 offset:12288
    ds_read_b64_tr_b16 a[198:199], v10 offset:13056
    ds_read_b64_tr_b16 v[124:125], v10 offset:12320
    ds_read_b64_tr_b16 v[126:127], v10 offset:13088
    ds_read_b64_tr_b16 v[132:133], v10 offset:12352
    ds_read_b64_tr_b16 v[134:135], v10 offset:13120
    s_mul_i32 s29, s24, 6144
    s_add_u32 s28, s64, 5505024
    s_add_u32 m0, s29, 122880
    s_nop 0
    buffer_load_dwordx4 v6, s[12:15], s28 offen lds
    s_add_u32 m0, s29, 123904
    s_nop 0
    buffer_load_dwordx4 v7, s[12:15], s28 offen lds
    s_add_u32 m0, s29, 124928
    s_nop 0
    buffer_load_dwordx4 v8, s[12:15], s28 offen lds
    s_add_u32 s28, s64, 5603328
    s_add_u32 m0, s29, 125952
    s_nop 0
    buffer_load_dwordx4 v6, s[12:15], s28 offen lds
    s_add_u32 m0, s29, 126976
    s_nop 0
    buffer_load_dwordx4 v7, s[12:15], s28 offen lds
    s_add_u32 m0, s29, 128000
    s_nop 0
    buffer_load_dwordx4 v8, s[12:15], s28 offen lds
    s_waitcnt vmcnt(24)
    s_waitcnt lgkmcnt(0)
    s_barrier
    ds_read_b64_tr_b16 a[200:201], v10 offset:24576
    ds_read_b64_tr_b16 a[202:203], v10 offset:25344
    ds_read_b64_tr_b16 a[248:249], v10 offset:24608
    ds_read_b64_tr_b16 a[250:251], v10 offset:25376
    ds_read_b64_tr_b16 v[224:225], v10 offset:24640
    ds_read_b64_tr_b16 v[226:227], v10 offset:25408
    ds_read_b64_tr_b16 a[204:205], v10 offset:36864
    ds_read_b64_tr_b16 a[206:207], v10 offset:37632
    ds_read_b64_tr_b16 a[252:253], v10 offset:36896
    ds_read_b64_tr_b16 a[254:255], v10 offset:37664
    ds_read_b64_tr_b16 v[228:229], v10 offset:36928
    ds_read_b64_tr_b16 v[230:231], v10 offset:37696
    s_mul_i32 s29, s24, 6144
    s_add_u32 s28, s64, 6291456
    s_add_u32 m0, s29, 0
    s_nop 0
    buffer_load_dwordx4 v6, s[12:15], s28 offen lds
    s_add_u32 m0, s29, 1024
    s_nop 0
    buffer_load_dwordx4 v7, s[12:15], s28 offen lds
    s_add_u32 m0, s29, 2048
    s_nop 0
    buffer_load_dwordx4 v8, s[12:15], s28 offen lds
    s_add_u32 s28, s64, 6389760
    s_add_u32 m0, s29, 3072
    s_nop 0
    buffer_load_dwordx4 v6, s[12:15], s28 offen lds
    s_add_u32 m0, s29, 4096
    s_nop 0
    buffer_load_dwordx4 v7, s[12:15], s28 offen lds
    s_add_u32 m0, s29, 5120
    s_nop 0
    buffer_load_dwordx4 v8, s[12:15], s28 offen lds
    s_waitcnt vmcnt(24)
    s_waitcnt lgkmcnt(0)
    s_barrier
    ds_read_b64_tr_b16 a[208:209], v11 offset:0
    ds_read_b64_tr_b16 a[210:211], v11 offset:768
    ds_read_b64_tr_b16 v[160:161], v11 offset:32
    ds_read_b64_tr_b16 v[162:163], v11 offset:800
    ds_read_b64_tr_b16 v[136:137], v11 offset:64
    ds_read_b64_tr_b16 v[138:139], v11 offset:832
    ds_read_b64_tr_b16 a[212:213], v11 offset:12288
    ds_read_b64_tr_b16 a[214:215], v11 offset:13056
    ds_read_b64_tr_b16 v[164:165], v11 offset:12320
    ds_read_b64_tr_b16 v[166:167], v11 offset:13088
    ds_read_b64_tr_b16 v[140:141], v11 offset:12352
    ds_read_b64_tr_b16 v[142:143], v11 offset:13120
    s_mul_i32 s29, s24, 6144
    s_add_u32 s28, s64, 7077888
    s_add_u32 m0, s29, 24576
    s_nop 0
    buffer_load_dwordx4 v6, s[12:15], s28 offen lds
    s_add_u32 m0, s29, 25600
    s_nop 0
    buffer_load_dwordx4 v7, s[12:15], s28 offen lds
    s_add_u32 m0, s29, 26624
    s_nop 0
    buffer_load_dwordx4 v8, s[12:15], s28 offen lds
    s_add_u32 s28, s64, 7176192
    s_add_u32 m0, s29, 27648
    s_nop 0
    buffer_load_dwordx4 v6, s[12:15], s28 offen lds
    s_add_u32 m0, s29, 28672
    s_nop 0
    buffer_load_dwordx4 v7, s[12:15], s28 offen lds
    s_add_u32 m0, s29, 29696
    s_nop 0
    buffer_load_dwordx4 v8, s[12:15], s28 offen lds
    s_waitcnt vmcnt(24)
    s_waitcnt lgkmcnt(0)
    s_barrier
    ds_read_b64_tr_b16 a[216:217], v11 offset:24576
    ds_read_b64_tr_b16 a[218:219], v11 offset:25344
    ds_read_b64_tr_b16 v[168:169], v11 offset:24608
    ds_read_b64_tr_b16 v[170:171], v11 offset:25376
    ds_read_b64_tr_b16 v[232:233], v11 offset:24640
    ds_read_b64_tr_b16 v[234:235], v11 offset:25408
    ds_read_b64_tr_b16 a[220:221], v11 offset:36864
    ds_read_b64_tr_b16 a[222:223], v11 offset:37632
    ds_read_b64_tr_b16 v[172:173], v11 offset:36896
    ds_read_b64_tr_b16 v[174:175], v11 offset:37664
    ds_read_b64_tr_b16 v[236:237], v11 offset:36928
    ds_read_b64_tr_b16 v[238:239], v11 offset:37696
    s_waitcnt vmcnt(18)
    s_waitcnt lgkmcnt(0)
    s_barrier
    ds_read_b64_tr_b16 v[96:97], v12 offset:0
    ds_read_b64_tr_b16 v[98:99], v12 offset:768
    ds_read_b64_tr_b16 v[176:177], v12 offset:32
    ds_read_b64_tr_b16 v[178:179], v12 offset:800
    ds_read_b64_tr_b16 v[144:145], v12 offset:64
    ds_read_b64_tr_b16 v[146:147], v12 offset:832
    ds_read_b64_tr_b16 v[100:101], v12 offset:12288
    ds_read_b64_tr_b16 v[102:103], v12 offset:13056
    ds_read_b64_tr_b16 v[180:181], v12 offset:12320
    ds_read_b64_tr_b16 v[182:183], v12 offset:13088
    ds_read_b64_tr_b16 v[148:149], v12 offset:12352
    ds_read_b64_tr_b16 v[150:151], v12 offset:13120
    s_waitcnt vmcnt(12)
    s_waitcnt lgkmcnt(0)
    s_barrier
    ds_read_b64_tr_b16 a[224:225], v12 offset:24576
    ds_read_b64_tr_b16 a[226:227], v12 offset:25344
    ds_read_b64_tr_b16 v[184:185], v12 offset:24608
    ds_read_b64_tr_b16 v[186:187], v12 offset:25376
    ds_read_b64_tr_b16 v[240:241], v12 offset:24640
    ds_read_b64_tr_b16 v[242:243], v12 offset:25408
    ds_read_b64_tr_b16 a[228:229], v12 offset:36864
    ds_read_b64_tr_b16 a[230:231], v12 offset:37632
    ds_read_b64_tr_b16 v[188:189], v12 offset:36896
    ds_read_b64_tr_b16 v[190:191], v12 offset:37664
    ds_read_b64_tr_b16 v[244:245], v12 offset:36928
    ds_read_b64_tr_b16 v[246:247], v12 offset:37696
    v_lshlrev_b32 v13, 4, v1
    s_mul_i32 s28, s24, 1536
    s_add_u32 s28, s28, 141312
    v_and_b32 v17, 15, v1
    v_lshlrev_b32 v17, 4, v17
    v_lshrrev_b32 v2, 4, v1
    v_lshl_add_u32 v17, v2, 2, v17
    v_add_u32 v17, s28, v17
    v_lshrrev_b32 v2, 2, v1
    v_lshlrev_b32 v2, 4, v2
    v_and_b32 v3, 1, v1
    v_lshl_add_u32 v2, v3, 3, v2
    v_add_u32 v2, s28, v2
    v_and_b32 v3, 2, v1
    v_cmp_eq_u32 vcc, 0, v3
    v_mov_b32 v3, 147456
    s_nop 0
    v_cndmask_b32 v18, v3, v2, vcc
    v_cndmask_b32 v19, v2, v3, vcc
    v_lshrrev_b32 v2, 3, v1
    v_xor_b32 v20, v2, v1
    s_lshl_b32 s28, s24, 10
    s_add_u32 s28, s28, 149504
    v_lshlrev_b32 v20, 4, v20
    v_add_u32 v20, s28, v20
    v_and_b32 v3, 7, v1
    v_xor_b32 v22, v2, v3
    v_lshl_add_u32 v22, v3, 3, v22
    v_lshlrev_b32 v22, 4, v22
    v_add_u32 v22, 149504, v22
    v_lshlrev_b32 v21, 5, v3
    v_and_b32 v3, 16, v1
    v_add_u32 v21, v21, v3
    s_lshl_b32 s28, s24, 8
    s_add_u32 s28, s28, 153600
    v_add_u32 v21, s28, v21
    s_mul_i32 s31, s25, 12
    s_mul_i32 s28, s24, 3
    s_add_u32 s31, s31, s28
    v_min_u32 v25, 2, v1
    v_add_u32 v25, s31, v25
    v_lshrrev_b32 v25, 2, v25
    v_lshlrev_b32 v25, 7, v25
    v_add_u32 v25, 163577856, v25
    s_lshl_b32 s31, s31, 10
    s_add_u32 s31, s31, 4194304
    s_mov_b32 s67, 0x3dd53b95
    s_mov_b32 s70, 0x00ff00ff
    s_mov_b32 s71, 0
    s_mov_b32 s69, 0x42800000
    s_mul_i32 s28, s24, 32768
    v_lshlrev_b32 v16, 4, v1
    v_add_u32 v16, s28, v16
    buffer_load_dwordx2 v[2:3], off, s[16:19], 0 offset:128 sc1
    s_waitcnt vmcnt(7)
    s_waitcnt lgkmcnt(0)
    s_barrier
    ds_read_b64_tr_b16 v[104:105], v10 offset:0
    ds_read_b64_tr_b16 v[106:107], v10 offset:768
    ds_read_b64_tr_b16 v[192:193], v10 offset:32
    ds_read_b64_tr_b16 v[194:195], v10 offset:800
    ds_read_b64_tr_b16 v[152:153], v10 offset:64
    ds_read_b64_tr_b16 v[154:155], v10 offset:832
    ds_read_b64_tr_b16 v[108:109], v10 offset:12288
    ds_read_b64_tr_b16 v[110:111], v10 offset:13056
    ds_read_b64_tr_b16 v[196:197], v10 offset:12320
    ds_read_b64_tr_b16 v[198:199], v10 offset:13088
    ds_read_b64_tr_b16 v[156:157], v10 offset:12352
    ds_read_b64_tr_b16 v[158:159], v10 offset:13120
    s_waitcnt vmcnt(1)
    s_waitcnt lgkmcnt(0)
    s_barrier
    ds_read_b64_tr_b16 a[232:233], v10 offset:24576
    ds_read_b64_tr_b16 a[234:235], v10 offset:25344
    ds_read_b64_tr_b16 v[200:201], v10 offset:24608
    ds_read_b64_tr_b16 v[202:203], v10 offset:25376
    ds_read_b64_tr_b16 v[248:249], v10 offset:24640
    ds_read_b64_tr_b16 v[250:251], v10 offset:25408
    ds_read_b64_tr_b16 a[236:237], v10 offset:36864
    ds_read_b64_tr_b16 a[238:239], v10 offset:37632
    ds_read_b64_tr_b16 v[204:205], v10 offset:36896
    ds_read_b64_tr_b16 v[206:207], v10 offset:37664
    ds_read_b64_tr_b16 v[252:253], v10 offset:36928
    ds_read_b64_tr_b16 v[254:255], v10 offset:37696
    s_waitcnt vmcnt(0) lgkmcnt(0)
    s_barrier
    s_mov_b32 s32, 0
Lws_2:
    v_readfirstlane_b32 s28, v2
    v_readfirstlane_b32 s34, v3
    s_nop 0
    s_min_u32 s28, s28, s34
    s_cmp_eq_u32 s28, 0
    s_cbranch_scc1 Lretry_3
    s_and_b32 s62, s34, 24576
    s_xor_b32 s63, s62, 16384
    s_add_u32 s62, s62, s33
    s_add_u32 s63, s63, s33
    s_and_b32 s34, s34, 8192
    s_add_u32 s33, s33, s34
    buffer_load_dword v12, v25, s[4:7], 0 offen sc1
    v_lshlrev_b32 v14, 4, v1
    s_lshl_b32 s28, s24, 10
    s_add_u32 s28, s28, 65536
    v_add_u32 v6, s28, v14
    v_add_u32 v7, 4096, v6
    s_lshl_b32 s28, s24, 9
    s_add_u32 s28, s28, 98304
    v_add_u32 v8, s28, v14
    s_lshl_b32 s96, s24, 10
    s_add_u32 s96, s96, 131072
    s_add_u32 s97, s96, 4096
    s_lshl_b32 s98, s24, 9
    s_add_u32 s98, s98, 139264
    v_and_b32 v10, 31, v1
    v_lshlrev_b32 v10, 2, v10
    v_lshl_add_u32 v10, v1, 7, v10
    v_add_u32 v10, 131072, v10
    v_add_u32 v14, 131072, v14
    v_bfe_u32 v15, v1, 1, 1
    v_mul_u32_u24 v15, 0xaaaa, v15
    v_add_u32 v15, 0x4444, v15
    s_mov_b32 s20, s38
    s_mov_b32 s21, s39
    s_mov_b32 s22, 10240
    s_mov_b32 s23, 0x20000
    s_sub_u32 s28, s96, 131072
    s_lshr_b32 s28, s28, 4
    v_add_u32 v2, s28, v1
    v_bfe_u32 v3, v2, 2, 2
    v_lshlrev_b32 v3, 1, v3
    v_and_or_b32 v3, v2, 1, v3
    v_bfe_u32 v4, v2, 1, 1
    v_lshrrev_b32 v2, 4, v2
    v_lshl_add_u32 v4, v2, 1, v4
    v_mul_u32_u24 v3, 1280, v3
    v_lshl_add_u32 v2, v4, 4, v3
    s_mov_b32 m0, s96
    s_nop 0
    buffer_load_dwordx4 v2, s[20:23], 0 offen lds
    s_sub_u32 s28, s97, 131072
    s_lshr_b32 s28, s28, 4
    v_add_u32 v2, s28, v1
    v_bfe_u32 v3, v2, 2, 2
    v_lshlrev_b32 v3, 1, v3
    v_and_or_b32 v3, v2, 1, v3
    v_bfe_u32 v4, v2, 1, 1
    v_lshrrev_b32 v2, 4, v2
    v_lshl_add_u32 v4, v2, 1, v4
    v_mul_u32_u24 v3, 1280, v3
    v_lshl_add_u32 v2, v4, 4, v3
    s_mov_b32 m0, s97
    s_nop 0
    buffer_load_dwordx4 v2, s[20:23], 0 offen lds
    s_sub_u32 s28, s98, 131072
    s_lshr_b32 s28, s28, 4
    v_add_u32 v2, s28, v1
    v_bfe_u32 v3, v2, 2, 2
    v_lshlrev_b32 v3, 1, v3
    v_and_or_b32 v3, v2, 1, v3
    v_bfe_u32 v4, v2, 1, 1
    v_lshrrev_b32 v2, 4, v2
    v_lshl_add_u32 v4, v2, 1, v4
    v_mul_u32_u24 v3, 1280, v3
    v_lshl_add_u32 v2, v4, 4, v3
    s_mov_b32 m0, s98
    s_mov_b32 exec_hi, 0
    buffer_load_dwordx4 v2, s[20:23], 0 offen lds
    s_mov_b64 exec, -1
    v_mov_b32 v2, 0
    v_mov_b32 v3, 0
    v_lshlrev_b32 v4, 3, v1
    v_add_u32 v4, 147456, v4
    ds_write_b64 v4, v[2:3] offset:0
    ds_write_b64 v4, v[2:3] offset:512
    ds_write_b64 v4, v[2:3] offset:1024
    ds_write_b64 v4, v[2:3] offset:1536
    v_lshlrev_b32 v11, 2, v1
    v_add_u32 v11, 153600, v11
    s_mov_b32 s64, s31
    s_add_u32 s35, s62, 104448
    s_add_u32 s75, s63, 104576
    s_mov_b32 s26, 0
    ds_write_b128 v16, v[104:107] offset:18432
    ds_write_b128 v16, v[108:111] offset:19456
    ds_write_b128 v16, v[112:115] offset:20480
    ds_write_b128 v16, v[116:119] offset:21504
    ds_write_b128 v16, v[120:123] offset:22528
    ds_write_b128 v16, v[124:127] offset:23552
    ds_write_b128 v16, v[128:131] offset:24576
    ds_write_b128 v16, v[132:135] offset:25600
    ds_write_b128 v16, v[136:139] offset:26624
    ds_write_b128 v16, v[140:143] offset:27648
    ds_write_b128 v16, v[144:147] offset:28672
    ds_write_b128 v16, v[148:151] offset:29696
    ds_write_b128 v16, v[152:155] offset:30720
    ds_write_b128 v16, v[156:159] offset:31744
    s_waitcnt lgkmcnt(0)
    s_waitcnt vmcnt(3)
    s_add_u32 s66, s26, 1
    s_mov_b32 s32, 0
Lcf_4:
    v_cmp_gt_u32 vcc, s66, v12
    s_cbranch_vccnz Lcf1_5
    buffer_load_dwordx4 v[120:123], v13, s[4:7], s64 offen offset:0 sc1
    buffer_load_dwordx4 v[124:127], v13, s[4:7], s64 offen offset:1024 sc1
    buffer_load_dwordx4 v[128:131], v13, s[4:7], s64 offen offset:2048 sc1
    v_cmp_ge_u32 vcc, s66, v12
    s_cbranch_vccz Lff_6
    buffer_load_dword v12, v25, s[4:7], 0 offen sc1
Lff_6:
    v_mov_b32 v5, s66
    ds_write_b128 v16, v[32:35] offset:0
    ds_write_b128 v16, v[36:39] offset:1024
    ds_write_b128 v16, v[40:43] offset:2048
    ds_write_b128 v16, v[44:47] offset:3072
    ds_write_b128 v16, v[48:51] offset:4096
    ds_write_b128 v16, v[52:55] offset:5120
    ds_write_b128 v16, v[56:59] offset:6144
    ds_write_b128 v16, v[60:63] offset:7168
    ds_write_b128 v16, v[64:67] offset:8192
    ds_write_b128 v16, v[68:71] offset:9216
    ds_write_b128 v16, v[72:75] offset:10240
    ds_write_b128 v16, v[76:79] offset:11264
    ds_write_b128 v16, v[80:83] offset:12288
    ds_write_b128 v16, v[84:87] offset:13312
    ds_write_b128 v16, v[88:91] offset:14336
    ds_write_b128 v16, v[92:95] offset:15360
    ds_write_b128 v16, v[96:99] offset:16384
    ds_write_b128 v16, v[100:103] offset:17408
    s_waitcnt lgkmcnt(0)
    v_mov_b64 v[104:105], 0
    v_mov_b64 v[106:107], 0
    v_mov_b64 v[108:109], 0
    v_mov_b64 v[110:111], 0
    v_mov_b64 v[112:113], 0
    v_mov_b64 v[114:115], 0
    v_mov_b64 v[116:117], 0
    v_mov_b64 v[118:119], 0
    s_and_b32 s66, s26, 3
    s_lshl_b32 s66, s66, 17
    s_add_u32 s66, s66, s62
    s_mov_b32 s72, 0
    s_mov_b32 s73, 10
    s_mov_b32 s32, 0
    s_waitcnt vmcnt(0)
    s_branch LS_got
.p2align 6
LS_top:
    s_and_b32 s68, s26, 3
    s_lshl_b32 s68, s68, 17
    s_add_u32 s68, s68, s63
    s_mov_b32 s32, 0
Lhw_7:
    buffer_load_dword v2, off, s[4:7], s75 sc1
    s_waitcnt vmcnt(0)
    v_cmp_gt_u32 vcc, s26, v2
    s_cbranch_vccnz Lretry_8
Lad_9:
    s_sub_u32 s74, s74, 8
    s_cbranch_scc0 Lad_9
    s_mov_b32 s32, 0
LS_poll:
    s_mov_b32 m0, s96
    s_nop 0
    buffer_load_dwordx4 v6, s[4:7], s68 offen sc1 lds
    s_mov_b32 m0, s97
    s_nop 0
    buffer_load_dwordx4 v7, s[4:7], s68 offen sc1 lds
    s_mov_b32 m0, s98
    s_mov_b32 exec_hi, 0
    buffer_load_dwordx4 v8, s[4:7], s68 offen sc1 lds
    s_mov_b64 exec, -1
    s_waitcnt vmcnt(2)
LS_got:
    s_waitcnt lgkmcnt(0)
    s_barrier
    ds_read_b128 v[64:67], v14 offset:0
    ds_read_b128 v[68:71], v14 offset:1024
    s_waitcnt lgkmcnt(1)
    v_smfmac_f32_16x16x64_bf16 v[104:107], v[64:67], a[0:7], v15
    ds_read_b128 v[72:75], v14 offset:2048
    v_smfmac_f32_16x16x64_bf16 v[108:111], v[64:67], a[8:15], v15
    ds_read_b128 v[76:79], v14 offset:3072
    v_smfmac_f32_16x16x64_bf16 v[112:115], v[64:67], a[16:23], v15
    s_waitcnt lgkmcnt(2)
    v_smfmac_f32_16x16x64_bf16 v[104:107], v[68:71], a[24:31], v15
    s_waitcnt vmcnt(0)
    s_barrier
    v_smfmac_f32_16x16x64_bf16 v[108:111], v[68:71], a[32:39], v15
    ds_read2st64_b32 v[2:3], v10 offset0:0 offset1:8
    v_smfmac_f32_16x16x64_bf16 v[112:115], v[68:71], a[40:47], v15
    s_waitcnt lgkmcnt(2)
    ds_read_b128 v[80:83], v14 offset:4096
    v_smfmac_f32_16x16x64_bf16 v[104:107], v[72:75], a[48:55], v15
    ds_read_b128 v[84:87], v14 offset:5120
    v_smfmac_f32_16x16x64_bf16 v[108:111], v[72:75], a[56:63], v15
    ds_read_b128 v[88:91], v14 offset:6144
    v_smfmac_f32_16x16x64_bf16 v[112:115], v[72:75], a[64:71], v15
    s_waitcnt lgkmcnt(3)
    ds_read_b128 v[92:95], v14 offset:7168
    v_max_u32 v2, v2, v3
    v_smfmac_f32_16x16x64_bf16 v[104:107], v[76:79], a[72:79], v15
    s_waitcnt lgkmcnt(3)
    ds_read_b128 v[96:99], v14 offset:8192
    v_cmp_eq_u32 vcc, -1, v2
    v_smfmac_f32_16x16x64_bf16 v[104:107], v[80:83], a[80:87], v15
    s_waitcnt lgkmcnt(3)
    ds_read_b128 v[100:103], v14 offset:9216
    v_smfmac_f32_16x16x64_bf16 v[104:107], v[84:87], a[88:95], v15
    s_waitcnt lgkmcnt(3)
    s_cbranch_vccnz LS_redo0
LS_keep0:
    v_smfmac_f32_16x16x64_bf16 v[104:107], v[88:91], v[32:39], v15
    s_waitcnt lgkmcnt(2)
    ds_read_b128 v[32:35], v16 offset:8192
    v_max_u32 v2, v64, v65
    v_smfmac_f32_16x16x64_bf16 v[104:107], v[92:95], v[40:47], v15
    s_waitcnt lgkmcnt(2)
    ds_read_b128 v[36:39], v16 offset:9216
    v_max3_u32 v2, v2, v66, v67
    v_smfmac_f32_16x16x64_bf16 v[104:107], v[96:99], a[96:103], v15
    s_waitcnt lgkmcnt(2)
    ds_read_b128 v[40:43], v16 offset:10240
    v_max3_u32 v2, v2, v68, v69
    v_smfmac_f32_16x16x64_bf16 v[104:107], v[100:103], v[48:55], v15
    ds_read_b128 v[44:47], v16 offset:11264
    v_max3_u32 v2, v2, v70, v71
    v_smfmac_f32_16x16x64_bf16 v[108:111], v[76:79], a[104:111], v15
    ds_read_b128 v[48:51], v16 offset:12288
    v_max3_u32 v2, v2, v72, v73
    v_smfmac_f32_16x16x64_bf16 v[108:111], v[80:83], v[56:63], v15
    ds_read_b128 v[52:55], v16 offset:13312
    v_max3_u32 v2, v2, v74, v75
    v_smfmac_f32_16x16x64_bf16 v[108:111], v[84:87], a[112:119], v15
    ds_read_b128 v[56:59], v16 offset:14336
    v_add_f32 v104, v104, v106
    v_smfmac_f32_16x16x64_bf16 v[108:111], v[88:91], a[120:127], v15
    ds_read_b128 v[60:63], v16 offset:15360
    v_add_f32 v105, v105, v107
    v_smfmac_f32_16x16x64_bf16 v[108:111], v[92:95], a[128:135], v15
    v_cvt_pk_bf16_f32 v104, v104, v105
    v_smfmac_f32_16x16x64_bf16 v[108:111], v[96:99], a[136:143], v15
    ds_write_b32 v17, v104 offset:0
    v_max3_u32 v2, v2, v76, v77
    v_smfmac_f32_16x16x64_bf16 v[108:111], v[100:103], a[144:151], v15
    s_waitcnt lgkmcnt(7)
    ds_read_b64_tr_b16 v[140:141], v18 offset:0
    v_max3_u32 v2, v2, v78, v79
    v_smfmac_f32_16x16x64_bf16 v[112:115], v[76:79], v[32:39], v15
    ds_read_b64_tr_b16 v[142:143], v19 offset:0
    v_max3_u32 v2, v2, v80, v81
    v_smfmac_f32_16x16x64_bf16 v[112:115], v[80:83], a[152:159], v15
    s_waitcnt lgkmcnt(7)
    ds_read_b128 v[32:35], v16 offset:16384
    v_max3_u32 v2, v2, v82, v83
    v_smfmac_f32_16x16x64_bf16 v[112:115], v[84:87], v[40:47], v15
    ds_read_b128 v[36:39], v16 offset:17408
    v_add_f32 v108, v108, v110
    v_smfmac_f32_16x16x64_bf16 v[112:115], v[88:91], a[160:167], v15
    ds_read_b128 v[40:43], v16 offset:18432
    v_add_f32 v109, v109, v111
    v_smfmac_f32_16x16x64_bf16 v[112:115], v[92:95], a[168:175], v15
    ds_read_b128 v[44:47], v16 offset:19456
    v_cvt_pk_bf16_f32 v108, v108, v109
    v_smfmac_f32_16x16x64_bf16 v[112:115], v[96:99], a[176:183], v15
    s_waitcnt lgkmcnt(9)
    ds_write_b32 v17, v108 offset:256
    v_max3_u32 v2, v2, v84, v85
    v_smfmac_f32_16x16x64_bf16 v[112:115], v[100:103], v[48:55], v15
    s_waitcnt lgkmcnt(5)
    ds_read_b64_tr_b16 v[144:145], v18 offset:256
    v_max3_u32 v2, v2, v86, v87
    v_mfma_f32_16x16x32_bf16 v[132:135], v[120:123], v[140:143], 0
    ds_read_b64_tr_b16 v[146:147], v19 offset:256
    v_max3_u32 v2, v2, v88, v89
    v_smfmac_f32_16x16x64_bf16 v[116:119], v[64:67], a[184:191], v15
    ds_read_b128 v[48:51], v16 offset:20480
    v_max3_u32 v2, v2, v90, v91
    v_smfmac_f32_16x16x64_bf16 v[116:119], v[68:71], v[56:63], v15
    ds_read_b128 v[52:55], v16 offset:21504
    v_add_f32 v112, v112, v114
    v_smfmac_f32_16x16x64_bf16 v[116:119], v[72:75], a[192:199], v15
    ds_read_b128 v[56:59], v16 offset:22528
    v_add_f32 v113, v113, v115
    v_smfmac_f32_16x16x64_bf16 v[116:119], v[76:79], a[200:207], v15
    ds_read_b128 v[60:63], v16 offset:23552
    v_cvt_pk_bf16_f32 v112, v112, v113
    v_smfmac_f32_16x16x64_bf16 v[116:119], v[80:83], a[208:215], v15
    ds_write_b32 v17, v112 offset:512
    v_mov_b64 v[104:105], 0
    v_smfmac_f32_16x16x64_bf16 v[116:119], v[84:87], a[216:223], v15
    s_waitcnt lgkmcnt(5)
    ds_read_b64_tr_b16 v[148:149], v18 offset:512
    v_mov_b64 v[106:107], 0
    v_mfma_f32_16x16x32_bf16 v[132:135], v[124:127], v[144:147], v[132:135]
    ds_read_b64_tr_b16 v[150:151], v19 offset:512
    v_mov_b64 v[108:109], 0
    v_smfmac_f32_16x16x64_bf16 v[116:119], v[88:91], v[32:39], v15
    ds_read_b128 v[32:35], v16 offset:24576
    v_mov_b64 v[110:111], 0
    v_smfmac_f32_16x16x64_bf16 v[116:119], v[92:95], a[224:231], v15
    ds_read_b128 v[36:39], v16 offset:25600
    v_max3_u32 v2, v2, v92, v93
    v_smfmac_f32_16x16x64_bf16 v[116:119], v[96:99], v[40:47], v15
    ds_read_b128 v[40:43], v16 offset:26624
    v_max3_u32 v2, v2, v94, v95
    v_smfmac_f32_16x16x64_bf16 v[116:119], v[100:103], a[232:239], v15
    s_waitcnt lgkmcnt(3)
    ds_read_b128 v[44:47], v16 offset:27648
    v_max3_u32 v2, v2, v96, v97
    v_mfma_f32_16x16x32_bf16 v[132:135], v[128:131], v[148:151], v[132:135]
    v_max3_u32 v2, v2, v98, v99
    v_smfmac_f32_16x16x64_bf16 v[104:107], v[64:67], v[48:55], v15
    ds_read_b128 v[48:51], v16 offset:28672
    v_max3_u32 v2, v2, v100, v101
    v_smfmac_f32_16x16x64_bf16 v[104:107], v[68:71], a[240:247], v15
    ds_read_b128 v[52:55], v16 offset:29696
    v_add_f32 v116, v116, v118
    v_smfmac_f32_16x16x64_bf16 v[104:107], v[72:75], v[56:63], v15
    ds_write_b64 v20, v[132:133] offset:0
    v_add_f32 v117, v117, v119
    v_smfmac_f32_16x16x64_bf16 v[104:107], v[76:79], a[248:255], v15
    ds_write_b64 v20, v[134:135] offset:8
    v_cvt_pk_bf16_f32 v116, v116, v117
    v_smfmac_f32_16x16x64_bf16 v[104:107], v[80:83], v[160:167], v15
    ds_write_b32 v17, v116 offset:768
    v_max3_u32 v2, v2, v102, v103
    v_smfmac_f32_16x16x64_bf16 v[104:107], v[84:87], v[168:175], v15
    ds_read_b64_tr_b16 v[152:153], v18 offset:768
    v_cmp_eq_u32 vcc, -1, v2
    v_smfmac_f32_16x16x64_bf16 v[104:107], v[88:91], v[176:183], v15
    s_cbranch_vccnz LS_redo
LS_keep:
    v_smfmac_f32_16x16x64_bf16 v[104:107], v[92:95], v[184:191], v15
    s_waitcnt lgkmcnt(2)
    s_barrier
    v_smfmac_f32_16x16x64_bf16 v[104:107], v[96:99], v[192:199], v15
    ds_read_b128 v[120:123], v22 offset:0
    v_smfmac_f32_16x16x64_bf16 v[104:107], v[100:103], v[200:207], v15
    ds_read_b128 v[124:127], v22 offset:1024
    v_smfmac_f32_16x16x64_bf16 v[108:111], v[64:67], v[208:215], v15
    ds_read_b128 v[132:135], v22 offset:2048
    v_smfmac_f32_16x16x64_bf16 v[108:111], v[68:71], v[216:223], v15
    ds_read_b128 v[112:115], v22 offset:3072
    v_smfmac_f32_16x16x64_bf16 v[108:111], v[72:75], v[32:39], v15
    s_waitcnt lgkmcnt(4)
    buffer_store_dword v5, v0, s[4:7], s35 offen sc1
    v_add_f32 v104, v104, v106
    v_mfma_f32_16x16x16_bf16 v[136:139], v[152:153], v[140:141], 0
    ds_read_b128 v[56:59], v16 offset:30720
    v_add_f32 v105, v105, v107
    v_smfmac_f32_16x16x64_bf16 v[108:111], v[76:79], v[224:231], v15
    ds_read_b128 v[60:63], v16 offset:31744
    v_cvt_pk_bf16_f32 v104, v104, v105
    v_smfmac_f32_16x16x64_bf16 v[108:111], v[80:83], v[40:47], v15
    s_waitcnt lgkmcnt(4)
    ds_write_b32 v17, v104 offset:1024
    v_add_f32 v120, v120, v124
    v_smfmac_f32_16x16x64_bf16 v[108:111], v[84:87], v[232:239], v15
    ds_read_b64_tr_b16 v[154:155], v18 offset:1024
    v_add_f32 v121, v121, v125
    v_smfmac_f32_16x16x64_bf16 v[108:111], v[88:91], v[48:55], v15
    v_add_f32 v122, v122, v126
    v_smfmac_f32_16x16x64_bf16 v[108:111], v[92:95], v[240:247], v15
    s_waitcnt lgkmcnt(2)
    v_add_f32 v123, v123, v127
    v_smfmac_f32_16x16x64_bf16 v[108:111], v[96:99], v[56:63], v15
    v_add_f32 v132, v132, v112
    v_smfmac_f32_16x16x64_bf16 v[108:111], v[100:103], v[248:255], v15
    v_add_f32 v133, v133, v113
    v_add_f32 v134, v134, v114
    v_add_f32 v135, v135, v115
    v_add_f32 v120, v120, v132
    v_add_f32 v121, v121, v133
    v_add_f32 v122, v122, v134
    v_add_f32 v123, v123, v135
    s_nop 0
    v_add_f32 v108, v108, v110
    v_add_f32 v109, v109, v111
    v_cvt_pk_bf16_f32 v108, v108, v109
    ds_write_b32 v17, v108 offset:1280
    ds_read_b64_tr_b16 v[156:157], v18 offset:1280
    s_waitcnt lgkmcnt(2)
    v_mfma_f32_16x16x16_bf16 v[136:139], v[154:155], v[144:145], v[136:139]
    v_max3_f32 v130, v120, v121, v122
    v_max_f32 v130, v130, v123
    s_nop 1
    v_max_f32_dpp v130, v130, v130 quad_perm:[1,0,3,2] row_mask:0xf bank_mask:0xf
    s_nop 1
    v_max_f32_dpp v130, v130, v130 quad_perm:[2,3,0,1] row_mask:0xf bank_mask:0xf
    s_nop 1
    v_max_f32_dpp v130, v130, v130 row_half_mirror row_mask:0xf bank_mask:0xf
    s_waitcnt lgkmcnt(0)
    v_mfma_f32_16x16x16_bf16 v[136:139], v[156:157], v[148:149], v[136:139]
    v_mul_f32 v130, s67, v130
    v_fma_f32 v120, v120, s67, -v130
    v_fma_f32 v121, v121, s67, -v130
    v_fma_f32 v122, v122, s67, -v130
    v_fma_f32 v123, v123, s67, -v130
    v_exp_f32 v120, v120
    s_mov_b64 exec, s[70:71]
    s_nop 0
    ds_write_b128 v21, v[136:139]
    s_mov_b64 exec, -1
    v_min_u32 v152, -2, v152
    v_min_u32 v154, -2, v154
    v_min_u32 v156, -2, v156
    s_cmp_lg_u32 s24, 0
    s_waitcnt lgkmcnt(0)
    s_barrier
    s_cbranch_scc1 LS_skip
    ds_read2st64_b32 v[132:133], v11 offset0:0 offset1:1
    ds_read2st64_b32 v[134:135], v11 offset0:2 offset1:3
    v_exp_f32 v121, v121
    v_exp_f32 v122, v122
    v_exp_f32 v123, v123
    v_add_f32 v131, v120, v121
    v_add_f32 v125, v122, v123
    v_add_f32 v131, v131, v125
    s_waitcnt lgkmcnt(0)
    v_add_f32 v132, v132, v133
    v_add_f32 v134, v134, v135
    v_add_f32 v132, v132, v134
    v_fma_f32 v132, v132, s67, -v130
    v_exp_f32 v124, v132
    v_cmp_lt_f32 vcc, s69, v132
    v_add_f32 v130, v131, v124
    s_cbranch_vccnz LS_far
LS_near:
    s_nop 0
    v_add_f32_dpp v130, v130, v130 quad_perm:[1,0,3,2] row_mask:0xf bank_mask:0xf
    s_nop 1
    v_add_f32_dpp v130, v130, v130 quad_perm:[2,3,0,1] row_mask:0xf bank_mask:0xf
    s_nop 1
    v_add_f32_dpp v130, v130, v130 row_half_mirror row_mask:0xf bank_mask:0xf
    v_rcp_f32 v130, v130
    s_nop 0
    v_mul_f32 v124, v124, v130
    v_mul_f32 v120, v120, v130
    v_mul_f32 v121, v121, v130
    v_mul_f32 v122, v122, v130
    v_mul_f32 v123, v123, v130
    v_cvt_pk_bf16_f32 v126, v120, v121
    v_cvt_pk_bf16_f32 v127, v122, v123
    v_min_u32 v126, -2, v126
    buffer_store_dwordx2 v[126:127], v23, s[4:7], s66 offen sc1
    v_mov_b32_dpp v125, v124 quad_perm:[1,0,3,2] row_mask:0xf bank_mask:0xf
    v_cvt_pk_bf16_f32 v128, v124, v125
    v_min_u32 v128, -2, v128
    buffer_store_dword v128, v24, s[4:7], s66 offen sc1
LS_skip:
    s_barrier
    s_add_u32 s64, s64, 393216
    s_mov_b32 s31, s32
    s_add_u32 s26, s26, 1
    s_cmp_ge_u32 s26, 64
    s_cbranch_scc1 LS_last
    s_add_u32 s66, s26, 1
    s_mov_b32 s32, 0
Lcf_10:
    v_cmp_gt_u32 vcc, s66, v12
    s_cbranch_vccnz Lcf1_11
    buffer_load_dwordx4 v[120:123], v13, s[4:7], s64 offen offset:0 sc1
    buffer_load_dwordx4 v[124:127], v13, s[4:7], s64 offen offset:1024 sc1
    buffer_load_dwordx4 v[128:131], v13, s[4:7], s64 offen offset:2048 sc1
    v_cmp_ge_u32 vcc, s66, v12
    s_cbranch_vccz Lff_12
    buffer_load_dword v12, v25, s[4:7], 0 offen sc1
Lff_12:
    buffer_store_dwordx2 v[152:153], v26, s[4:7], s65 offen offset:0 sc1
    buffer_store_dwordx2 v[154:155], v26, s[4:7], s65 offen offset:256 sc1
    buffer_store_dwordx2 v[156:157], v26, s[4:7], s65 offen offset:512 sc1
    v_mov_b32 v2, -1
    v_mov_b32 v3, -1
    s_add_u32 s65, s65, 1048576
    s_add_u32 s28, s65, 1048576
    buffer_store_dwordx2 v[2:3], v26, s[4:7], s28 offen offset:0 sc1
    buffer_store_dwordx2 v[2:3], v26, s[4:7], s28 offen offset:256 sc1
    buffer_store_dwordx2 v[2:3], v26, s[4:7], s28 offen offset:512 sc1
    s_add_u32 s28, s26, 1
    s_and_b32 s28, s28, 3
    s_lshl_b32 s28, s28, 17
    s_add_u32 s28, s28, s62
    s_cmp_eq_u32 s24, 0
    s_cselect_b32 s28, s28, 536870912
    buffer_store_dwordx2 v[2:3], v23, s[4:7], s28 offen sc1
    buffer_store_dword v2, v24, s[4:7], s28 offen sc1
    s_mov_b32 s32, s31
    s_min_u32 s29, s32, 1
    s_lshl_b32 s72, s72, 1
    s_or_b32 s72, s72, s29
    s_and_b32 s72, s72, 7
    s_mul_i32 s29, s29, s72
    s_cmp_gt_u32 s29, 1
    s_cselect_b32 s28, 12, -1
    s_add_i32 s73, s73, s28
    s_max_i32 s73, s73, 10
    s_min_i32 s73, s73, 160
    s_mov_b32 s74, s73
    v_mov_b32 v5, s66
    v_mov_b64 v[104:105], 0
    v_mov_b64 v[106:107], 0
    v_mov_b64 v[108:109], 0
    v_mov_b64 v[110:111], 0
    v_mov_b64 v[112:113], 0
    v_mov_b64 v[114:115], 0
    v_mov_b64 v[116:117], 0
    v_mov_b64 v[118:119], 0
    ds_read_b128 v[32:35], v16 offset:0
    ds_read_b128 v[36:39], v16 offset:1024
    ds_read_b128 v[40:43], v16 offset:2048
    ds_read_b128 v[44:47], v16 offset:3072
    ds_read_b128 v[48:51], v16 offset:4096
    ds_read_b128 v[52:55], v16 offset:5120
    ds_read_b128 v[56:59], v16 offset:6144
    ds_read_b128 v[60:63], v16 offset:7168
    s_and_b32 s66, s26, 3
    s_lshl_b32 s66, s66, 17
    s_add_u32 s66, s66, s62
    s_branch LS_top
LS_last:
    buffer_store_dwordx2 v[152:153], v26, s[4:7], s65 offen offset:0 sc1
    buffer_store_dwordx2 v[154:155], v26, s[4:7], s65 offen offset:256 sc1
    buffer_store_dwordx2 v[156:157], v26, s[4:7], s65 offen offset:512 sc1
LS_end:
    s_endpgm
LS_far:
    v_max_f32 v133, 0, v132
    s_nop 1
    v_max_f32_dpp v133, v133, v133 quad_perm:[1,0,3,2] row_mask:0xf bank_mask:0xf
    s_nop 1
    v_max_f32_dpp v133, v133, v133 quad_perm:[2,3,0,1] row_mask:0xf bank_mask:0xf
    s_nop 1
    v_max_f32_dpp v133, v133, v133 row_half_mirror row_mask:0xf bank_mask:0xf
    v_sub_f32 v132, v132, v133
    v_exp_f32 v124, v132
    v_sub_f32 v133, 0, v133
    v_exp_f32 v133, v133
    s_nop 0
    v_mul_f32 v120, v120, v133
    v_mul_f32 v121, v121, v133
    v_mul_f32 v122, v122, v133
    v_mul_f32 v123, v123, v133
    v_fma_f32 v130, v131, v133, v124
    s_nop 1
    s_branch LS_near
LS_redo0:
    s_cmp_eq_u32 s26, 0
    s_cbranch_scc1 LS_keep0
    s_waitcnt lgkmcnt(0)
    s_barrier
    s_mov_b32 m0, s96
    s_nop 0
    buffer_load_dwordx4 v6, s[4:7], s68 offen sc1 lds
    s_mov_b32 m0, s97
    s_nop 0
    buffer_load_dwordx4 v7, s[4:7], s68 offen sc1 lds
    s_mov_b32 m0, s98
    s_mov_b32 exec_hi, 0
    buffer_load_dwordx4 v8, s[4:7], s68 offen sc1 lds
    s_mov_b64 exec, -1
    v_mov_b64 v[104:105], 0
    v_mov_b64 v[106:107], 0
    v_mov_b64 v[108:109], 0
    v_mov_b64 v[110:111], 0
    v_mov_b64 v[112:113], 0
    v_mov_b64 v[114:115], 0
    s_branch LS_care
LS_redo:
    s_cmp_eq_u32 s26, 0
    s_cbranch_scc1 LS_keep
    s_waitcnt lgkmcnt(0)
    s_barrier
    s_nop 7
    buffer_load_dwordx4 v[120:123], v13, s[4:7], s64 offen offset:0 sc1
    buffer_load_dwordx4 v[124:127], v13, s[4:7], s64 offen offset:1024 sc1
    buffer_load_dwordx4 v[128:131], v13, s[4:7], s64 offen offset:2048 sc1
    v_mov_b64 v[104:105], 0
    v_mov_b64 v[106:107], 0
    v_mov_b64 v[108:109], 0
    v_mov_b64 v[110:111], 0
    v_mov_b64 v[112:113], 0
    v_mov_b64 v[114:115], 0
    v_mov_b64 v[116:117], 0
    v_mov_b64 v[118:119], 0
    ds_read_b128 v[32:35], v16 offset:0
    ds_read_b128 v[36:39], v16 offset:1024
    ds_read_b128 v[40:43], v16 offset:2048
    ds_read_b128 v[44:47], v16 offset:3072
    ds_read_b128 v[48:51], v16 offset:4096
    ds_read_b128 v[52:55], v16 offset:5120
    ds_read_b128 v[56:59], v16 offset:6144
    ds_read_b128 v[60:63], v16 offset:7168
LS_again:
    s_mov_b32 m0, s96
    s_nop 0
    buffer_load_dwordx4 v6, s[4:7], s68 offen sc1 lds
    s_mov_b32 m0, s97
    s_nop 0
    buffer_load_dwordx4 v7, s[4:7], s68 offen sc1 lds
    s_mov_b32 m0, s98
    s_mov_b32 exec_hi, 0
    buffer_load_dwordx4 v8, s[4:7], s68 offen sc1 lds
    s_mov_b64 exec, -1
LS_care:
    s_add_u32 s32, s32, 1
    v_mov_b32 v3, s96
    v_mov_b32 v2, s97
    v_cmp_gt_u32 vcc, 8, v1
    s_nop 1
    v_cndmask_b32 v3, v2, v3, vcc
    v_and_b32 v2, 7, v1
    v_lshl_add_u32 v3, v2, 7, v3
    v_and_b32 v2, 3, v1
    v_lshl_add_u32 v2, v2, 7, s98
    v_cmp_gt_u32 vcc, 16, v1
    s_nop 1
    v_cndmask_b32 v3, v2, v3, vcc
    v_and_b32 v2, 31, v1
    v_lshl_add_u32 v3, v2, 2, v3
    s_waitcnt vmcnt(0)
    ds_read_b32 v2, v3
    s_waitcnt lgkmcnt(0)
    v_cmp_eq_u32 vcc, -1, v2
    s_cmp_ge_u32 s32, 200000
    s_cbranch_scc1 LS_giveup
    s_cbranch_vccz LS_got
    s_branch LS_again
LS_giveup:
    v_mov_b32 v2, 13
    v_mov_b32 v3, 4
    buffer_store_dword v2, v3, s[16:19], 0 offen sc1
    s_endpgm
Lretry_3:
    s_sleep 6
    buffer_load_dwordx2 v[2:3], off, s[16:19], 0 offset:128 sc1
    s_waitcnt vmcnt(0)
    s_add_u32 s32, s32, 1
    s_cmp_lt_u32 s32, 200000
    s_cbranch_scc1 Lws_2
    v_mov_b32 v2, 1
    v_mov_b32 v3, 4
    buffer_store_dword v2, v3, s[16:19], 0 offen sc1
    s_endpgm
Lcf1_5:
    s_cmp_eq_u32 s32, 0
    s_cbranch_scc1 Lcf1_5s
    s_sleep 4
Lcf1_5s:
    buffer_load_dword v12, v25, s[4:7], 0 offen sc1
    s_waitcnt vmcnt(0)
    s_add_u32 s32, s32, 1
    s_cmp_lt_u32 s32, 200000
    s_cbranch_scc1 Lcf_4
    v_mov_b32 v2, 11
    v_mov_b32 v3, 4
    buffer_store_dword v2, v3, s[16:19], 0 offen sc1
    s_endpgm
Lretry_8:
    s_add_u32 s32, s32, 1
    s_cmp_lt_u32 s32, 200000
    s_cbranch_scc1 Lhw_7
    v_mov_b32 v2, 12
    v_mov_b32 v3, 4
    buffer_store_dword v2, v3, s[16:19], 0 offen sc1
    s_endpgm
Lcf1_11:
    s_cmp_eq_u32 s32, 0
    s_cbranch_scc1 Lcf1_11s
    s_sleep 4
Lcf1_11s:
    buffer_load_dword v12, v25, s[4:7], 0 offen sc1
    s_waitcnt vmcnt(0)
    s_add_u32 s32, s32, 1
    s_cmp_lt_u32 s32, 200000
    s_cbranch_scc1 Lcf_10
    v_mov_b32 v2, 11
    v_mov_b32 v3, 4
    buffer_store_dword v2, v3, s[16:19], 0 offen sc1
    s_endpgm
E_S:
.p2align 6
W_Z:
R_Z:
    s_lshl_b32 s29, s25, 8
    s_mul_i32 s28, s24, 81920
    s_add_u32 s28, s28, s29
    v_and_b32 v28, 15, v1
    v_lshlrev_b32 v28, 4, v28
    v_add_u32 v28, s28, v28
    v_lshrrev_b32 v2, 5, v1
    v_mul_u32_u24 v2, 327680, v2
    v_add_u32 v29, v28, v2
    v_bfe_u32 v2, v1, 4, 1
    v_lshl_add_u32 v29, v2, 3, v29
    v_add_u32 v29, 65536, v29
    v_lshrrev_b32 v2, 4, v1
    v_lshl_add_u32 v28, v2, 14, v28
    v_mov_b32 v2, -1
    v_mov_b32 v3, -1
    v_mov_b32 v4, -1
    v_mov_b32 v5, -1
    s_add_u32 s28, s33, 2097152
    buffer_store_dwordx4 v[2:5], v28, s[4:7], s28 offen sc1
    buffer_store_dwordx2 v[2:3], v29, s[4:7], s28 offen sc1
    s_add_u32 s28, s28, 327680
    buffer_store_dwordx4 v[2:5], v28, s[4:7], s28 offen sc1
    s_add_u32 s28, s33, 2105344
    buffer_store_dwordx4 v[2:5], v28, s[4:7], s28 offen sc1
    buffer_store_dwordx2 v[2:3], v29, s[4:7], s28 offen sc1
    s_add_u32 s28, s28, 327680
    buffer_store_dwordx4 v[2:5], v28, s[4:7], s28 offen sc1
    s_add_u32 s28, s33, 3145728
    buffer_store_dwordx4 v[2:5], v28, s[4:7], s28 offen sc1
    buffer_store_dwordx2 v[2:3], v29, s[4:7], s28 offen sc1
    s_add_u32 s28, s28, 327680
    buffer_store_dwordx4 v[2:5], v28, s[4:7], s28 offen sc1
    s_add_u32 s28, s33, 3153920
    buffer_store_dwordx4 v[2:5], v28, s[4:7], s28 offen sc1
    buffer_store_dwordx2 v[2:3], v29, s[4:7], s28 offen sc1
    s_add_u32 s28, s28, 327680
    buffer_store_dwordx4 v[2:5], v28, s[4:7], s28 offen sc1
    s_mov_b32 s8, s44
    s_mov_b32 s9, s45
    s_mov_b32 s10, 7864320
    s_mov_b32 s11, 0x20000
    v_add_u32 v23, 0, v1
    v_mul_u32_u24 v24, 2731, v23
    v_lshrrev_b32 v24, 16, v24
    v_mul_u32_u24 v6, 24, v24
    v_sub_u32 v23, v23, v6
    v_mul_u32_u24 v24, 12288, v24
    v_lshl_add_u32 v6, v23, 4, v24
    v_add_u32 v23, 64, v1
    v_mul_u32_u24 v24, 2731, v23
    v_lshrrev_b32 v24, 16, v24
    v_mul_u32_u24 v7, 24, v24
    v_sub_u32 v23, v23, v7
    v_mul_u32_u24 v24, 12288, v24
    v_lshl_add_u32 v7, v23, 4, v24
    v_add_u32 v23, 128, v1
    v_mul_u32_u24 v24, 2731, v23
    v_lshrrev_b32 v24, 16, v24
    v_mul_u32_u24 v8, 24, v24
    v_sub_u32 v23, v23, v8
    v_mul_u32_u24 v24, 12288, v24
    v_lshl_add_u32 v8, v23, 4, v24
    v_and_b32 v10, 3, v1
    v_lshlrev_b32 v10, 3, v10
    v_bfe_u32 v11, v1, 5, 1
    v_mul_u32_u24 v11, 6144, v11
    v_add_u32 v10, v10, v11
    v_bfe_u32 v11, v1, 4, 1
    v_mul_u32_u24 v11, 1536, v11
    v_add_u32 v10, v10, v11
    v_bfe_u32 v11, v1, 3, 1
    v_mul_u32_u24 v11, 3072, v11
    v_add_u32 v10, v10, v11
    v_bfe_u32 v11, v1, 2, 1
    v_mul_u32_u24 v11, 384, v11
    v_add_u32 v10, v10, v11
    s_mul_i32 s28, s24, 96
    v_add_u32 v10, s28, v10
    v_add_u32 v11, 49152, v10
    v_add_u32 v12, 98304, v10
    s_mul_i32 s64, s24, 196608
    s_mul_i32 s28, s25, 384
    s_add_u32 s64, s64, s28
    s_mov_b32 s12, s46
    s_mov_b32 s13, s47
    s_mov_b32 s14, 7864320
    s_mov_b32 s15, 0x20000
    v_add_u32 v23, 0, v1
    v_mul_u32_u24 v24, 1639, v23
    v_lshrrev_b32 v24, 16, v24
    v_mul_u32_u24 v14, 40, v24
    v_sub_u32 v23, v23, v14
    v_mul_u32_u24 v24, 1280, v24
    v_lshl_add_u32 v14, v23, 4, v24
    v_add_u32 v23, 64, v1
    v_mul_u32_u24 v24, 1639, v23
    v_lshrrev_b32 v24, 16, v24
    v_mul_u32_u24 v15, 40, v24
    v_sub_u32 v23, v23, v15
    v_mul_u32_u24 v24, 1280, v24
    v_lshl_add_u32 v15, v23, 4, v24
    v_add_u32 v23, 128, v1
    v_mul_u32_u24 v24, 1639, v23
    v_lshrrev_b32 v24, 16, v24
    v_mul_u32_u24 v16, 40, v24
    v_sub_u32 v23, v23, v16
    v_mul_u32_u24 v24, 1280, v24
    v_lshl_add_u32 v16, v23, 4, v24
    v_add_u32 v23, 192, v1
    v_mul_u32_u24 v24, 1639, v23
    v_lshrrev_b32 v24, 16, v24
    v_mul_u32_u24 v17, 40, v24
    v_sub_u32 v23, v23, v17
    v_mul_u32_u24 v24, 1280, v24
    v_lshl_add_u32 v17, v23, 4, v24
    v_add_u32 v23, 256, v1
    v_mul_u32_u24 v24, 1639, v23
    v_lshrrev_b32 v24, 16, v24
    v_mul_u32_u24 v18, 40, v24
    v_sub_u32 v23, v23, v18
    v_mul_u32_u24 v24, 1280, v24
    v_lshl_add_u32 v18, v23, 4, v24
    v_and_b32 v20, 3, v1
    v_lshlrev_b32 v20, 3, v20
    v_bfe_u32 v21, v1, 5, 1
    v_mul_u32_u24 v21, 10240, v21
    v_add_u32 v20, v20, v21
    v_bfe_u32 v21, v1, 4, 1
    v_mul_u32_u24 v21, 2560, v21
    v_add_u32 v20, v20, v21
    v_bfe_u32 v21, v1, 3, 1
    v_mul_u32_u24 v21, 5120, v21
    v_add_u32 v20, v20, v21
    v_bfe_u32 v21, v1, 2, 1
    v_mul_u32_u24 v21, 640, v21
    v_add_u32 v20, v20, v21
    s_mul_i32 s28, s24, 160
    v_add_u32 v20, s28, v20
    v_add_u32 v21, 49152, v20
    v_add_u32 v22, 98304, v20
    s_mul_i32 s67, s24, 10240
    s_mul_i32 s28, s25, 245760
    s_add_u32 s67, s67, s28
    s_lshr_b32 s28, s24, 1
    s_mul_i32 s28, s28, 40960
    s_add_u32 s67, s67, s28
    s_mul_i32 s29, s24, 6144
    s_add_u32 s28, s64, 7077888
    s_add_u32 m0, s29, 0
    s_nop 0
    buffer_load_dwordx4 v6, s[8:11], s28 offen lds
    s_add_u32 m0, s29, 1024
    s_nop 0
    buffer_load_dwordx4 v7, s[8:11], s28 offen lds
    s_add_u32 m0, s29, 2048
    s_nop 0
    buffer_load_dwordx4 v8, s[8:11], s28 offen lds
    s_add_u32 s28, s64, 7176192
    s_add_u32 m0, s29, 3072
    s_nop 0
    buffer_load_dwordx4 v6, s[8:11], s28 offen lds
    s_add_u32 m0, s29, 4096
    s_nop 0
    buffer_load_dwordx4 v7, s[8:11], s28 offen lds
    s_add_u32 m0, s29, 5120
    s_nop 0
    buffer_load_dwordx4 v8, s[8:11], s28 offen lds
    s_mul_i32 s29, s24, 6144
    s_add_u32 s28, s64, 6291456
    s_add_u32 m0, s29, 24576
    s_nop 0
    buffer_load_dwordx4 v6, s[8:11], s28 offen lds
    s_add_u32 m0, s29, 25600
    s_nop 0
    buffer_load_dwordx4 v7, s[8:11], s28 offen lds
    s_add_u32 m0, s29, 26624
    s_nop 0
    buffer_load_dwordx4 v8, s[8:11], s28 offen lds
    s_add_u32 s28, s64, 6389760
    s_add_u32 m0, s29, 27648
    s_nop 0
    buffer_load_dwordx4 v6, s[8:11], s28 offen lds
    s_add_u32 m0, s29, 28672
    s_nop 0
    buffer_load_dwordx4 v7, s[8:11], s28 offen lds
    s_add_u32 m0, s29, 29696
    s_nop 0
    buffer_load_dwordx4 v8, s[8:11], s28 offen lds
    s_waitcnt vmcnt(12)
    s_barrier
    s_cmp_lg_u32 s24, 0
    s_cbranch_scc1 Larr_13
    s_and_b32 s28, s2, 1
    s_lshl_b32 s28, s28, 6
    v_mov_b32 v23, 1
    s_mov_b64 exec, 1
    buffer_atomic_add v23, off, s[16:19], s28 sc1
    s_mov_b64 exec, -1
Larr_13:
    s_mul_i32 s29, s24, 6144
    s_add_u32 s28, s64, 5505024
    s_add_u32 m0, s29, 49152
    s_nop 0
    buffer_load_dwordx4 v6, s[8:11], s28 offen lds
    s_add_u32 m0, s29, 50176
    s_nop 0
    buffer_load_dwordx4 v7, s[8:11], s28 offen lds
    s_add_u32 m0, s29, 51200
    s_nop 0
    buffer_load_dwordx4 v8, s[8:11], s28 offen lds
    s_add_u32 s28, s64, 5603328
    s_add_u32 m0, s29, 52224
    s_nop 0
    buffer_load_dwordx4 v6, s[8:11], s28 offen lds
    s_add_u32 m0, s29, 53248
    s_nop 0
    buffer_load_dwordx4 v7, s[8:11], s28 offen lds
    s_add_u32 m0, s29, 54272
    s_nop 0
    buffer_load_dwordx4 v8, s[8:11], s28 offen lds
    s_mul_i32 s29, s24, 6144
    s_add_u32 s28, s64, 4718592
    s_add_u32 m0, s29, 73728
    s_nop 0
    buffer_load_dwordx4 v6, s[8:11], s28 offen lds
    s_add_u32 m0, s29, 74752
    s_nop 0
    buffer_load_dwordx4 v7, s[8:11], s28 offen lds
    s_add_u32 m0, s29, 75776
    s_nop 0
    buffer_load_dwordx4 v8, s[8:11], s28 offen lds
    s_add_u32 s28, s64, 4816896
    s_add_u32 m0, s29, 76800
    s_nop 0
    buffer_load_dwordx4 v6, s[8:11], s28 offen lds
    s_add_u32 m0, s29, 77824
    s_nop 0
    buffer_load_dwordx4 v7, s[8:11], s28 offen lds
    s_add_u32 m0, s29, 78848
    s_nop 0
    buffer_load_dwordx4 v8, s[8:11], s28 offen lds
    s_mul_i32 s29, s24, 6144
    s_add_u32 s28, s64, 3932160
    s_add_u32 m0, s29, 98304
    s_nop 0
    buffer_load_dwordx4 v6, s[8:11], s28 offen lds
    s_add_u32 m0, s29, 99328
    s_nop 0
    buffer_load_dwordx4 v7, s[8:11], s28 offen lds
    s_add_u32 m0, s29, 100352
    s_nop 0
    buffer_load_dwordx4 v8, s[8:11], s28 offen lds
    s_add_u32 s28, s64, 4030464
    s_add_u32 m0, s29, 101376
    s_nop 0
    buffer_load_dwordx4 v6, s[8:11], s28 offen lds
    s_add_u32 m0, s29, 102400
    s_nop 0
    buffer_load_dwordx4 v7, s[8:11], s28 offen lds
    s_add_u32 m0, s29, 103424
    s_nop 0
    buffer_load_dwordx4 v8, s[8:11], s28 offen lds
    s_mul_i32 s29, s24, 6144
    s_add_u32 s28, s64, 3145728
    s_add_u32 m0, s29, 122880
    s_nop 0
    buffer_load_dwordx4 v6, s[8:11], s28 offen lds
    s_add_u32 m0, s29, 123904
    s_nop 0
    buffer_load_dwordx4 v7, s[8:11], s28 offen lds
    s_add_u32 m0, s29, 124928
    s_nop 0
    buffer_load_dwordx4 v8, s[8:11], s28 offen lds
    s_add_u32 s28, s64, 3244032
    s_add_u32 m0, s29, 125952
    s_nop 0
    buffer_load_dwordx4 v6, s[8:11], s28 offen lds
    s_add_u32 m0, s29, 126976
    s_nop 0
    buffer_load_dwordx4 v7, s[8:11], s28 offen lds
    s_add_u32 m0, s29, 128000
    s_nop 0
    buffer_load_dwordx4 v8, s[8:11], s28 offen lds
    s_waitcnt vmcnt(30)
    s_waitcnt lgkmcnt(0)
    s_barrier
    ds_read_b64_tr_b16 v[48:49], v10 offset:0
    ds_read_b64_tr_b16 v[50:51], v10 offset:768
    ds_read_b64_tr_b16 v[64:65], v10 offset:32
    ds_read_b64_tr_b16 v[66:67], v10 offset:800
    ds_read_b64_tr_b16 v[80:81], v10 offset:64
    ds_read_b64_tr_b16 v[82:83], v10 offset:832
    ds_read_b64_tr_b16 v[52:53], v10 offset:12288
    ds_read_b64_tr_b16 v[54:55], v10 offset:13056
    ds_read_b64_tr_b16 v[68:69], v10 offset:12320
    ds_read_b64_tr_b16 v[70:71], v10 offset:13088
    ds_read_b64_tr_b16 v[84:85], v10 offset:12352
    ds_read_b64_tr_b16 v[86:87], v10 offset:13120
    s_waitcnt vmcnt(24)
    s_waitcnt lgkmcnt(0)
    s_barrier
    ds_read_b64_tr_b16 a[96:97], v10 offset:24576
    ds_read_b64_tr_b16 a[98:99], v10 offset:25344
    ds_read_b64_tr_b16 a[136:137], v10 offset:24608
    ds_read_b64_tr_b16 a[138:139], v10 offset:25376
    ds_read_b64_tr_b16 a[176:177], v10 offset:24640
    ds_read_b64_tr_b16 a[178:179], v10 offset:25408
    ds_read_b64_tr_b16 a[100:101], v10 offset:36864
    ds_read_b64_tr_b16 a[102:103], v10 offset:37632
    ds_read_b64_tr_b16 a[140:141], v10 offset:36896
    ds_read_b64_tr_b16 a[142:143], v10 offset:37664
    ds_read_b64_tr_b16 a[180:181], v10 offset:36928
    ds_read_b64_tr_b16 a[182:183], v10 offset:37696
    s_mul_i32 s29, s24, 6144
    s_add_u32 s28, s64, 2359296
    s_add_u32 m0, s29, 0
    s_nop 0
    buffer_load_dwordx4 v6, s[8:11], s28 offen lds
    s_add_u32 m0, s29, 1024
    s_nop 0
    buffer_load_dwordx4 v7, s[8:11], s28 offen lds
    s_add_u32 m0, s29, 2048
    s_nop 0
    buffer_load_dwordx4 v8, s[8:11], s28 offen lds
    s_add_u32 s28, s64, 2457600
    s_add_u32 m0, s29, 3072
    s_nop 0
    buffer_load_dwordx4 v6, s[8:11], s28 offen lds
    s_add_u32 m0, s29, 4096
    s_nop 0
    buffer_load_dwordx4 v7, s[8:11], s28 offen lds
    s_add_u32 m0, s29, 5120
    s_nop 0
    buffer_load_dwordx4 v8, s[8:11], s28 offen lds
    s_waitcnt vmcnt(24)
    s_waitcnt lgkmcnt(0)
    s_barrier
    ds_read_b64_tr_b16 v[40:41], v11 offset:0
    ds_read_b64_tr_b16 v[42:43], v11 offset:768
    ds_read_b64_tr_b16 a[128:129], v11 offset:32
    ds_read_b64_tr_b16 a[130:131], v11 offset:800
    ds_read_b64_tr_b16 a[168:169], v11 offset:64
    ds_read_b64_tr_b16 a[170:171], v11 offset:832
    ds_read_b64_tr_b16 v[44:45], v11 offset:12288
    ds_read_b64_tr_b16 v[46:47], v11 offset:13056
    ds_read_b64_tr_b16 a[132:133], v11 offset:12320
    ds_read_b64_tr_b16 a[134:135], v11 offset:13088
    ds_read_b64_tr_b16 a[172:173], v11 offset:12352
    ds_read_b64_tr_b16 a[174:175], v11 offset:13120
    s_mul_i32 s29, s24, 6144
    s_add_u32 s28, s64, 1572864
    s_add_u32 m0, s29, 24576
    s_nop 0
    buffer_load_dwordx4 v6, s[8:11], s28 offen lds
    s_add_u32 m0, s29, 25600
    s_nop 0
    buffer_load_dwordx4 v7, s[8:11], s28 offen lds
    s_add_u32 m0, s29, 26624
    s_nop 0
    buffer_load_dwordx4 v8, s[8:11], s28 offen lds
    s_add_u32 s28, s64, 1671168
    s_add_u32 m0, s29, 27648
    s_nop 0
    buffer_load_dwordx4 v6, s[8:11], s28 offen lds
    s_add_u32 m0, s29, 28672
    s_nop 0
    buffer_load_dwordx4 v7, s[8:11], s28 offen lds
    s_add_u32 m0, s29, 29696
    s_nop 0
    buffer_load_dwordx4 v8, s[8:11], s28 offen lds
    s_waitcnt vmcnt(24)
    s_waitcnt lgkmcnt(0)
    s_barrier
    ds_read_b64_tr_b16 v[32:33], v11 offset:24576
    ds_read_b64_tr_b16 v[34:35], v11 offset:25344
    ds_read_b64_tr_b16 a[120:121], v11 offset:24608
    ds_read_b64_tr_b16 a[122:123], v11 offset:25376
    ds_read_b64_tr_b16 v[72:73], v11 offset:24640
    ds_read_b64_tr_b16 v[74:75], v11 offset:25408
    ds_read_b64_tr_b16 v[36:37], v11 offset:36864
    ds_read_b64_tr_b16 v[38:39], v11 offset:37632
    ds_read_b64_tr_b16 a[124:125], v11 offset:36896
    ds_read_b64_tr_b16 a[126:127], v11 offset:37664
    ds_read_b64_tr_b16 v[76:77], v11 offset:36928
    ds_read_b64_tr_b16 v[78:79], v11 offset:37696
    s_mul_i32 s29, s24, 6144
    s_add_u32 s28, s64, 786432
    s_add_u32 m0, s29, 49152
    s_nop 0
    buffer_load_dwordx4 v6, s[8:11], s28 offen lds
    s_add_u32 m0, s29, 50176
    s_nop 0
    buffer_load_dwordx4 v7, s[8:11], s28 offen lds
    s_add_u32 m0, s29, 51200
    s_nop 0
    buffer_load_dwordx4 v8, s[8:11], s28 offen lds
    s_add_u32 s28, s64, 884736
    s_add_u32 m0, s29, 52224
    s_nop 0
    buffer_load_dwordx4 v6, s[8:11], s28 offen lds
    s_add_u32 m0, s29, 53248
    s_nop 0
    buffer_load_dwordx4 v7, s[8:11], s28 offen lds
    s_add_u32 m0, s29, 54272
    s_nop 0
    buffer_load_dwordx4 v8, s[8:11], s28 offen lds
    s_waitcnt vmcnt(24)
    s_waitcnt lgkmcnt(0)
    s_barrier
    ds_read_b64_tr_b16 a[88:89], v12 offset:0
    ds_read_b64_tr_b16 a[90:91], v12 offset:768
    ds_read_b64_tr_b16 a[112:113], v12 offset:32
    ds_read_b64_tr_b16 a[114:115], v12 offset:800
    ds_read_b64_tr_b16 a[160:161], v12 offset:64
    ds_read_b64_tr_b16 a[162:163], v12 offset:832
    ds_read_b64_tr_b16 a[92:93], v12 offset:12288
    ds_read_b64_tr_b16 a[94:95], v12 offset:13056
    ds_read_b64_tr_b16 a[116:117], v12 offset:12320
    ds_read_b64_tr_b16 a[118:119], v12 offset:13088
    ds_read_b64_tr_b16 a[164:165], v12 offset:12352
    ds_read_b64_tr_b16 a[166:167], v12 offset:13120
    s_mul_i32 s29, s24, 6144
    s_add_u32 s28, s64, 0
    s_add_u32 m0, s29, 73728
    s_nop 0
    buffer_load_dwordx4 v6, s[8:11], s28 offen lds
    s_add_u32 m0, s29, 74752
    s_nop 0
    buffer_load_dwordx4 v7, s[8:11], s28 offen lds
    s_add_u32 m0, s29, 75776
    s_nop 0
    buffer_load_dwordx4 v8, s[8:11], s28 offen lds
    s_add_u32 s28, s64, 98304
    s_add_u32 m0, s29, 76800
    s_nop 0
    buffer_load_dwordx4 v6, s[8:11], s28 offen lds
    s_add_u32 m0, s29, 77824
    s_nop 0
    buffer_load_dwordx4 v7, s[8:11], s28 offen lds
    s_add_u32 m0, s29, 78848
    s_nop 0
    buffer_load_dwordx4 v8, s[8:11], s28 offen lds
    s_waitcnt vmcnt(24)
    s_waitcnt lgkmcnt(0)
    s_barrier
    ds_read_b64_tr_b16 a[80:81], v12 offset:24576
    ds_read_b64_tr_b16 a[82:83], v12 offset:25344
    ds_read_b64_tr_b16 v[56:57], v12 offset:24608
    ds_read_b64_tr_b16 v[58:59], v12 offset:25376
    ds_read_b64_tr_b16 a[152:153], v12 offset:24640
    ds_read_b64_tr_b16 a[154:155], v12 offset:25408
    ds_read_b64_tr_b16 a[84:85], v12 offset:36864
    ds_read_b64_tr_b16 a[86:87], v12 offset:37632
    ds_read_b64_tr_b16 v[60:61], v12 offset:36896
    ds_read_b64_tr_b16 v[62:63], v12 offset:37664
    ds_read_b64_tr_b16 a[156:157], v12 offset:36928
    ds_read_b64_tr_b16 a[158:159], v12 offset:37696
    s_mul_i32 s29, s24, 5120
    s_add_u32 s28, s67, 164480
    s_add_u32 m0, s29, 98304
    s_nop 0
    buffer_load_dwordx4 v14, s[12:15], s28 offen lds
    s_add_u32 m0, s29, 99328
    s_nop 0
    buffer_load_dwordx4 v15, s[12:15], s28 offen lds
    s_add_u32 m0, s29, 100352
    s_nop 0
    buffer_load_dwordx4 v16, s[12:15], s28 offen lds
    s_add_u32 m0, s29, 101376
    s_nop 0
    buffer_load_dwordx4 v17, s[12:15], s28 offen lds
    s_add_u32 m0, s29, 102400
    s_nop 0
    buffer_load_dwordx4 v18, s[12:15], s28 offen lds
    s_waitcnt vmcnt(23)
    s_waitcnt lgkmcnt(0)
    s_barrier
    ds_read_b64_tr_b16 a[72:73], v10 offset:0
    ds_read_b64_tr_b16 a[74:75], v10 offset:768
    ds_read_b64_tr_b16 a[104:105], v10 offset:32
    ds_read_b64_tr_b16 a[106:107], v10 offset:800
    ds_read_b64_tr_b16 a[144:145], v10 offset:64
    ds_read_b64_tr_b16 a[146:147], v10 offset:832
    ds_read_b64_tr_b16 a[76:77], v10 offset:12288
    ds_read_b64_tr_b16 a[78:79], v10 offset:13056
    ds_read_b64_tr_b16 a[108:109], v10 offset:12320
    ds_read_b64_tr_b16 a[110:111], v10 offset:13088
    ds_read_b64_tr_b16 a[148:149], v10 offset:12352
    ds_read_b64_tr_b16 a[150:151], v10 offset:13120
    s_mul_i32 s29, s24, 5120
    s_add_u32 s28, s67, 163840
    s_add_u32 m0, s29, 122880
    s_nop 0
    buffer_load_dwordx4 v14, s[12:15], s28 offen lds
    s_add_u32 m0, s29, 123904
    s_nop 0
    buffer_load_dwordx4 v15, s[12:15], s28 offen lds
    s_add_u32 m0, s29, 124928
    s_nop 0
    buffer_load_dwordx4 v16, s[12:15], s28 offen lds
    s_add_u32 m0, s29, 125952
    s_nop 0
    buffer_load_dwordx4 v17, s[12:15], s28 offen lds
    s_add_u32 m0, s29, 126976
    s_nop 0
    buffer_load_dwordx4 v18, s[12:15], s28 offen lds
    s_waitcnt vmcnt(22)
    s_waitcnt lgkmcnt(0)
    s_barrier
    ds_read_b64_tr_b16 a[48:49], v10 offset:24576
    ds_read_b64_tr_b16 a[50:51], v10 offset:25344
    ds_read_b64_tr_b16 a[56:57], v10 offset:24608
    ds_read_b64_tr_b16 a[58:59], v10 offset:25376
    ds_read_b64_tr_b16 a[64:65], v10 offset:24640
    ds_read_b64_tr_b16 a[66:67], v10 offset:25408
    ds_read_b64_tr_b16 a[52:53], v10 offset:36864
    ds_read_b64_tr_b16 a[54:55], v10 offset:37632
    ds_read_b64_tr_b16 a[60:61], v10 offset:36896
    ds_read_b64_tr_b16 a[62:63], v10 offset:37664
    ds_read_b64_tr_b16 a[68:69], v10 offset:36928
    ds_read_b64_tr_b16 a[70:71], v10 offset:37696
    s_mul_i32 s29, s24, 5120
    s_add_u32 s28, s67, 144000
    s_add_u32 m0, s29, 0
    s_nop 0
    buffer_load_dwordx4 v14, s[12:15], s28 offen lds
    s_add_u32 m0, s29, 1024
    s_nop 0
    buffer_load_dwordx4 v15, s[12:15], s28 offen lds
    s_add_u32 m0, s29, 2048
    s_nop 0
    buffer_load_dwordx4 v16, s[12:15], s28 offen lds
    s_add_u32 m0, s29, 3072
    s_nop 0
    buffer_load_dwordx4 v17, s[12:15], s28 offen lds
    s_add_u32 m0, s29, 4096
    s_nop 0
    buffer_load_dwordx4 v18, s[12:15], s28 offen lds
    s_waitcnt vmcnt(21)
    s_waitcnt lgkmcnt(0)
    s_barrier
    ds_read_b64_tr_b16 a[24:25], v11 offset:0
    ds_read_b64_tr_b16 a[26:27], v11 offset:768
    ds_read_b64_tr_b16 a[32:33], v11 offset:32
    ds_read_b64_tr_b16 a[34:35], v11 offset:800
    ds_read_b64_tr_b16 a[40:41], v11 offset:64
    ds_read_b64_tr_b16 a[42:43], v11 offset:832
    ds_read_b64_tr_b16 a[28:29], v11 offset:12288
    ds_read_b64_tr_b16 a[30:31], v11 offset:13056
    ds_read_b64_tr_b16 a[36:37], v11 offset:12320
    ds_read_b64_tr_b16 a[38:39], v11 offset:13088
    ds_read_b64_tr_b16 a[44:45], v11 offset:12352
    ds_read_b64_tr_b16 a[46:47], v11 offset:13120
    s_mul_i32 s29, s24, 5120
    s_add_u32 s28, s67, 143360
    s_add_u32 m0, s29, 24576
    s_nop 0
    buffer_load_dwordx4 v14, s[12:15], s28 offen lds
    s_add_u32 m0, s29, 25600
    s_nop 0
    buffer_load_dwordx4 v15, s[12:15], s28 offen lds
    s_add_u32 m0, s29, 26624
    s_nop 0
    buffer_load_dwordx4 v16, s[12:15], s28 offen lds
    s_add_u32 m0, s29, 27648
    s_nop 0
    buffer_load_dwordx4 v17, s[12:15], s28 offen lds
    s_add_u32 m0, s29, 28672
    s_nop 0
    buffer_load_dwordx4 v18, s[12:15], s28 offen lds
    s_waitcnt vmcnt(20)
    s_waitcnt lgkmcnt(0)
    s_barrier
    ds_read_b64_tr_b16 a[0:1], v11 offset:24576
    ds_read_b64_tr_b16 a[2:3], v11 offset:25344
    ds_read_b64_tr_b16 a[8:9], v11 offset:24608
    ds_read_b64_tr_b16 a[10:11], v11 offset:25376
    ds_read_b64_tr_b16 a[16:17], v11 offset:24640
    ds_read_b64_tr_b16 a[18:19], v11 offset:25408
    ds_read_b64_tr_b16 a[4:5], v11 offset:36864
    ds_read_b64_tr_b16 a[6:7], v11 offset:37632
    ds_read_b64_tr_b16 a[12:13], v11 offset:36896
    ds_read_b64_tr_b16 a[14:15], v11 offset:37664
    ds_read_b64_tr_b16 a[20:21], v11 offset:36928
    ds_read_b64_tr_b16 a[22:23], v11 offset:37696
    s_mul_i32 s29, s24, 5120
    s_add_u32 s28, s67, 123520
    s_add_u32 m0, s29, 49152
    s_nop 0
    buffer_load_dwordx4 v14, s[12:15], s28 offen lds
    s_add_u32 m0, s29, 50176
    s_nop 0
    buffer_load_dwordx4 v15, s[12:15], s28 offen lds
    s_add_u32 m0, s29, 51200
    s_nop 0
    buffer_load_dwordx4 v16, s[12:15], s28 offen lds
    s_add_u32 m0, s29, 52224
    s_nop 0
    buffer_load_dwordx4 v17, s[12:15], s28 offen lds
    s_add_u32 m0, s29, 53248
    s_nop 0
    buffer_load_dwordx4 v18, s[12:15], s28 offen lds
    s_waitcnt vmcnt(20)
    s_waitcnt lgkmcnt(0)
    s_barrier
    ds_read_b64_tr_b16 v[228:229], v22 offset:0
    ds_read_b64_tr_b16 v[230:231], v22 offset:1280
    ds_read_b64_tr_b16 v[132:133], v22 offset:32
    ds_read_b64_tr_b16 v[134:135], v22 offset:1312
    ds_read_b64_tr_b16 v[236:237], v22 offset:64
    ds_read_b64_tr_b16 v[238:239], v22 offset:1344
    ds_read_b64_tr_b16 v[140:141], v22 offset:96
    ds_read_b64_tr_b16 v[142:143], v22 offset:1376
    ds_read_b64_tr_b16 v[156:157], v22 offset:128
    ds_read_b64_tr_b16 v[158:159], v22 offset:1408
    s_mul_i32 s29, s24, 5120
    s_add_u32 s28, s67, 122880
    s_add_u32 m0, s29, 73728
    s_nop 0
    buffer_load_dwordx4 v14, s[12:15], s28 offen lds
    s_add_u32 m0, s29, 74752
    s_nop 0
    buffer_load_dwordx4 v15, s[12:15], s28 offen lds
    s_add_u32 m0, s29, 75776
    s_nop 0
    buffer_load_dwordx4 v16, s[12:15], s28 offen lds
    s_add_u32 m0, s29, 76800
    s_nop 0
    buffer_load_dwordx4 v17, s[12:15], s28 offen lds
    s_add_u32 m0, s29, 77824
    s_nop 0
    buffer_load_dwordx4 v18, s[12:15], s28 offen lds
    s_waitcnt vmcnt(20)
    s_waitcnt lgkmcnt(0)
    s_barrier
    ds_read_b64_tr_b16 v[124:125], v22 offset:24576
    ds_read_b64_tr_b16 v[126:127], v22 offset:25856
    ds_read_b64_tr_b16 v[188:189], v22 offset:24608
    ds_read_b64_tr_b16 v[190:191], v22 offset:25888
    ds_read_b64_tr_b16 v[196:197], v22 offset:24640
    ds_read_b64_tr_b16 v[198:199], v22 offset:25920
    ds_read_b64_tr_b16 v[204:205], v22 offset:24672
    ds_read_b64_tr_b16 v[206:207], v22 offset:25952
    ds_read_b64_tr_b16 v[252:253], v22 offset:24704
    ds_read_b64_tr_b16 v[254:255], v22 offset:25984
    s_mul_i32 s29, s24, 5120
    s_add_u32 s28, s67, 41600
    s_add_u32 m0, s29, 98304
    s_nop 0
    buffer_load_dwordx4 v14, s[12:15], s28 offen lds
    s_add_u32 m0, s29, 99328
    s_nop 0
    buffer_load_dwordx4 v15, s[12:15], s28 offen lds
    s_add_u32 m0, s29, 100352
    s_nop 0
    buffer_load_dwordx4 v16, s[12:15], s28 offen lds
    s_add_u32 m0, s29, 101376
    s_nop 0
    buffer_load_dwordx4 v17, s[12:15], s28 offen lds
    s_add_u32 m0, s29, 102400
    s_nop 0
    buffer_load_dwordx4 v18, s[12:15], s28 offen lds
    s_waitcnt vmcnt(20)
    s_waitcnt lgkmcnt(0)
    s_barrier
    ds_read_b64_tr_b16 v[116:117], v20 offset:0
    ds_read_b64_tr_b16 v[118:119], v20 offset:1280
    ds_read_b64_tr_b16 v[180:181], v20 offset:32
    ds_read_b64_tr_b16 v[182:183], v20 offset:1312
    ds_read_b64_tr_b16 v[212:213], v20 offset:64
    ds_read_b64_tr_b16 v[214:215], v20 offset:1344
    ds_read_b64_tr_b16 v[220:221], v20 offset:96
    ds_read_b64_tr_b16 v[222:223], v20 offset:1376
    ds_read_b64_tr_b16 v[148:149], v20 offset:128
    ds_read_b64_tr_b16 v[150:151], v20 offset:1408
    s_mul_i32 s29, s24, 5120
    s_add_u32 s28, s67, 40960
    s_add_u32 m0, s29, 122880
    s_nop 0
    buffer_load_dwordx4 v14, s[12:15], s28 offen lds
    s_add_u32 m0, s29, 123904
    s_nop 0
    buffer_load_dwordx4 v15, s[12:15], s28 offen lds
    s_add_u32 m0, s29, 124928
    s_nop 0
    buffer_load_dwordx4 v16, s[12:15], s28 offen lds
    s_add_u32 m0, s29, 125952
    s_nop 0
    buffer_load_dwordx4 v17, s[12:15], s28 offen lds
    s_add_u32 m0, s29, 126976
    s_nop 0
    buffer_load_dwordx4 v18, s[12:15], s28 offen lds
    s_waitcnt vmcnt(20)
    s_waitcnt lgkmcnt(0)
    s_barrier
    ds_read_b64_tr_b16 v[108:109], v20 offset:24576
    ds_read_b64_tr_b16 v[110:111], v20 offset:25856
    ds_read_b64_tr_b16 a[252:253], v20 offset:24608
    ds_read_b64_tr_b16 a[254:255], v20 offset:25888
    ds_read_b64_tr_b16 v[164:165], v20 offset:24640
    ds_read_b64_tr_b16 v[166:167], v20 offset:25920
    ds_read_b64_tr_b16 v[172:173], v20 offset:24672
    ds_read_b64_tr_b16 v[174:175], v20 offset:25952
    ds_read_b64_tr_b16 v[244:245], v20 offset:24704
    ds_read_b64_tr_b16 v[246:247], v20 offset:25984
    s_mul_i32 s29, s24, 5120
    s_add_u32 s28, s67, 21120
    s_add_u32 m0, s29, 0
    s_nop 0
    buffer_load_dwordx4 v14, s[12:15], s28 offen lds
    s_add_u32 m0, s29, 1024
    s_nop 0
    buffer_load_dwordx4 v15, s[12:15], s28 offen lds
    s_add_u32 m0, s29, 2048
    s_nop 0
    buffer_load_dwordx4 v16, s[12:15], s28 offen lds
    s_add_u32 m0, s29, 3072
    s_nop 0
    buffer_load_dwordx4 v17, s[12:15], s28 offen lds
    s_add_u32 m0, s29, 4096
    s_nop 0
    buffer_load_dwordx4 v18, s[12:15], s28 offen lds
    s_waitcnt vmcnt(20)
    s_waitcnt lgkmcnt(0)
    s_barrier
    ds_read_b64_tr_b16 a[220:221], v21 offset:0
    ds_read_b64_tr_b16 a[222:223], v21 offset:1280
    ds_read_b64_tr_b16 v[92:93], v21 offset:32
    ds_read_b64_tr_b16 v[94:95], v21 offset:1312
    ds_read_b64_tr_b16 v[100:101], v21 offset:64
    ds_read_b64_tr_b16 v[102:103], v21 offset:1344
    ds_read_b64_tr_b16 a[228:229], v21 offset:96
    ds_read_b64_tr_b16 a[230:231], v21 offset:1376
    ds_read_b64_tr_b16 a[244:245], v21 offset:128
    ds_read_b64_tr_b16 a[246:247], v21 offset:1408
    s_mul_i32 s29, s24, 5120
    s_add_u32 s28, s67, 20480
    s_add_u32 m0, s29, 24576
    s_nop 0
    buffer_load_dwordx4 v14, s[12:15], s28 offen lds
    s_add_u32 m0, s29, 25600
    s_nop 0
    buffer_load_dwordx4 v15, s[12:15], s28 offen lds
    s_add_u32 m0, s29, 26624
    s_nop 0
    buffer_load_dwordx4 v16, s[12:15], s28 offen lds
    s_add_u32 m0, s29, 27648
    s_nop 0
    buffer_load_dwordx4 v17, s[12:15], s28 offen lds
    s_add_u32 m0, s29, 28672
    s_nop 0
    buffer_load_dwordx4 v18, s[12:15], s28 offen lds
    s_waitcnt vmcnt(20)
    s_waitcnt lgkmcnt(0)
    s_barrier
    ds_read_b64_tr_b16 a[188:189], v21 offset:24576
    ds_read_b64_tr_b16 a[190:191], v21 offset:25856
    ds_read_b64_tr_b16 a[196:197], v21 offset:24608
    ds_read_b64_tr_b16 a[198:199], v21 offset:25888
    ds_read_b64_tr_b16 a[204:205], v21 offset:24640
    ds_read_b64_tr_b16 a[206:207], v21 offset:25920
    ds_read_b64_tr_b16 a[212:213], v21 offset:24672
    ds_read_b64_tr_b16 a[214:215], v21 offset:25952
    ds_read_b64_tr_b16 a[236:237], v21 offset:24704
    ds_read_b64_tr_b16 a[238:239], v21 offset:25984
    s_mul_i32 s29, s24, 5120
    s_add_u32 s28, s67, 640
    s_add_u32 m0, s29, 49152
    s_nop 0
    buffer_load_dwordx4 v14, s[12:15], s28 offen lds
    s_add_u32 m0, s29, 50176
    s_nop 0
    buffer_load_dwordx4 v15, s[12:15], s28 offen lds
    s_add_u32 m0, s29, 51200
    s_nop 0
    buffer_load_dwordx4 v16, s[12:15], s28 offen lds
    s_add_u32 m0, s29, 52224
    s_nop 0
    buffer_load_dwordx4 v17, s[12:15], s28 offen lds
    s_add_u32 m0, s29, 53248
    s_nop 0
    buffer_load_dwordx4 v18, s[12:15], s28 offen lds
    s_waitcnt vmcnt(20)
    s_waitcnt lgkmcnt(0)
    s_barrier
    ds_read_b64_tr_b16 v[224:225], v22 offset:0
    ds_read_b64_tr_b16 v[226:227], v22 offset:1280
    ds_read_b64_tr_b16 v[128:129], v22 offset:32
    ds_read_b64_tr_b16 v[130:131], v22 offset:1312
    ds_read_b64_tr_b16 v[232:233], v22 offset:64
    ds_read_b64_tr_b16 v[234:235], v22 offset:1344
    ds_read_b64_tr_b16 v[136:137], v22 offset:96
    ds_read_b64_tr_b16 v[138:139], v22 offset:1376
    ds_read_b64_tr_b16 v[152:153], v22 offset:128
    ds_read_b64_tr_b16 v[154:155], v22 offset:1408
    s_mul_i32 s29, s24, 5120
    s_add_u32 s28, s67, 0
    s_add_u32 m0, s29, 73728
    s_nop 0
    buffer_load_dwordx4 v14, s[12:15], s28 offen lds
    s_add_u32 m0, s29, 74752
    s_nop 0
    buffer_load_dwordx4 v15, s[12:15], s28 offen lds
    s_add_u32 m0, s29, 75776
    s_nop 0
    buffer_load_dwordx4 v16, s[12:15], s28 offen lds
    s_add_u32 m0, s29, 76800
    s_nop 0
    buffer_load_dwordx4 v17, s[12:15], s28 offen lds
    s_add_u32 m0, s29, 77824
    s_nop 0
    buffer_load_dwordx4 v18, s[12:15], s28 offen lds
    s_waitcnt vmcnt(20)
    s_waitcnt lgkmcnt(0)
    s_barrier
    ds_read_b64_tr_b16 v[120:121], v22 offset:24576
    ds_read_b64_tr_b16 v[122:123], v22 offset:25856
    ds_read_b64_tr_b16 v[184:185], v22 offset:24608
    ds_read_b64_tr_b16 v[186:187], v22 offset:25888
    ds_read_b64_tr_b16 v[192:193], v22 offset:24640
    ds_read_b64_tr_b16 v[194:195], v22 offset:25920
    ds_read_b64_tr_b16 v[200:201], v22 offset:24672
    ds_read_b64_tr_b16 v[202:203], v22 offset:25952
    ds_read_b64_tr_b16 v[248:249], v22 offset:24704
    ds_read_b64_tr_b16 v[250:251], v22 offset:25984
    s_waitcnt vmcnt(15)
    s_waitcnt lgkmcnt(0)
    s_barrier
    ds_read_b64_tr_b16 v[112:113], v20 offset:0
    ds_read_b64_tr_b16 v[114:115], v20 offset:1280
    ds_read_b64_tr_b16 v[176:177], v20 offset:32
    ds_read_b64_tr_b16 v[178:179], v20 offset:1312
    ds_read_b64_tr_b16 v[208:209], v20 offset:64
    ds_read_b64_tr_b16 v[210:211], v20 offset:1344
    ds_read_b64_tr_b16 v[216:217], v20 offset:96
    ds_read_b64_tr_b16 v[218:219], v20 offset:1376
    ds_read_b64_tr_b16 v[144:145], v20 offset:128
    ds_read_b64_tr_b16 v[146:147], v20 offset:1408
    s_waitcnt vmcnt(10)
    s_waitcnt lgkmcnt(0)
    s_barrier
    ds_read_b64_tr_b16 v[104:105], v20 offset:24576
    ds_read_b64_tr_b16 v[106:107], v20 offset:25856
    ds_read_b64_tr_b16 a[248:249], v20 offset:24608
    ds_read_b64_tr_b16 a[250:251], v20 offset:25888
    ds_read_b64_tr_b16 v[160:161], v20 offset:24640
    ds_read_b64_tr_b16 v[162:163], v20 offset:25920
    ds_read_b64_tr_b16 v[168:169], v20 offset:24672
    ds_read_b64_tr_b16 v[170:171], v20 offset:25952
    ds_read_b64_tr_b16 v[240:241], v20 offset:24704
    ds_read_b64_tr_b16 v[242:243], v20 offset:25984
    s_mul_i32 s28, s24, 32768
    v_lshlrev_b32 v25, 4, v1
    v_add_u32 v25, s28, v25
    buffer_load_dwordx2 v[2:3], off, s[16:19], 0 offset:128 sc1
    s_waitcnt vmcnt(6)
    s_waitcnt lgkmcnt(0)
    s_barrier
    ds_read_b64_tr_b16 a[216:217], v21 offset:0
    ds_read_b64_tr_b16 a[218:219], v21 offset:1280
    ds_read_b64_tr_b16 v[88:89], v21 offset:32
    ds_read_b64_tr_b16 v[90:91], v21 offset:1312
    ds_read_b64_tr_b16 v[96:97], v21 offset:64
    ds_read_b64_tr_b16 v[98:99], v21 offset:1344
    ds_read_b64_tr_b16 a[224:225], v21 offset:96
    ds_read_b64_tr_b16 a[226:227], v21 offset:1376
    ds_read_b64_tr_b16 a[240:241], v21 offset:128
    ds_read_b64_tr_b16 a[242:243], v21 offset:1408
    s_waitcnt vmcnt(1)
    s_waitcnt lgkmcnt(0)
    s_barrier
    ds_read_b64_tr_b16 a[184:185], v21 offset:24576
    ds_read_b64_tr_b16 a[186:187], v21 offset:25856
    ds_read_b64_tr_b16 a[192:193], v21 offset:24608
    ds_read_b64_tr_b16 a[194:195], v21 offset:25888
    ds_read_b64_tr_b16 a[200:201], v21 offset:24640
    ds_read_b64_tr_b16 a[202:203], v21 offset:25920
    ds_read_b64_tr_b16 a[208:209], v21 offset:24672
    ds_read_b64_tr_b16 a[210:211], v21 offset:25952
    ds_read_b64_tr_b16 a[232:233], v21 offset:24704
    ds_read_b64_tr_b16 a[234:235], v21 offset:25984
    s_waitcnt vmcnt(0) lgkmcnt(0)
    s_barrier
    s_mov_b32 s32, 0
Lws_14:
    v_readfirstlane_b32 s28, v2
    v_readfirstlane_b32 s34, v3
    s_nop 0
    s_min_u32 s28, s28, s34
    s_cmp_eq_u32 s28, 0
    s_cbranch_scc1 Lretry_15
    s_and_b32 s62, s34, 24576
    s_xor_b32 s63, s62, 16384
    s_add_u32 s62, s62, s33
    s_add_u32 s63, s63, s33
    s_and_b32 s34, s34, 8192
    s_add_u32 s33, s33, s34
    v_lshlrev_b32 v23, 4, v1
    s_lshl_b32 s28, s24, 10
    s_add_u32 s28, s28, 65536
    v_add_u32 v18, s28, v23
    v_add_u32 v19, 4096, v18
    s_lshl_b32 s28, s24, 9
    s_add_u32 s28, s28, 98304
    v_add_u32 v20, s28, v23
    s_lshl_b32 s96, s24, 10
    s_add_u32 s96, s96, 131072
    s_add_u32 s97, s96, 4096
    s_lshl_b32 s98, s24, 9
    s_add_u32 s98, s98, 139264
    v_and_b32 v21, 31, v1
    v_lshlrev_b32 v21, 2, v21
    v_lshl_add_u32 v21, v1, 7, v21
    v_add_u32 v21, 131072, v21
    v_add_u32 v23, 131072, v23
    v_bfe_u32 v24, v1, 1, 1
    v_mul_u32_u24 v24, 0xaaaa, v24
    v_add_u32 v24, 0x4444, v24
    s_mov_b32 s20, s38
    s_mov_b32 s21, s39
    s_mov_b32 s22, 10240
    s_mov_b32 s23, 0x20000
    s_sub_u32 s28, s96, 131072
    s_lshr_b32 s28, s28, 4
    v_add_u32 v2, s28, v1
    v_bfe_u32 v3, v2, 2, 2
    v_lshlrev_b32 v3, 1, v3
    v_and_or_b32 v3, v2, 1, v3
    v_bfe_u32 v4, v2, 1, 1
    v_lshrrev_b32 v2, 4, v2
    v_lshl_add_u32 v4, v2, 1, v4
    v_mul_u32_u24 v3, 1280, v3
    v_lshl_add_u32 v2, v4, 4, v3
    s_mov_b32 m0, s96
    s_nop 0
    buffer_load_dwordx4 v2, s[20:23], 0 offen lds
    s_sub_u32 s28, s97, 131072
    s_lshr_b32 s28, s28, 4
    v_add_u32 v2, s28, v1
    v_bfe_u32 v3, v2, 2, 2
    v_lshlrev_b32 v3, 1, v3
    v_and_or_b32 v3, v2, 1, v3
    v_bfe_u32 v4, v2, 1, 1
    v_lshrrev_b32 v2, 4, v2
    v_lshl_add_u32 v4, v2, 1, v4
    v_mul_u32_u24 v3, 1280, v3
    v_lshl_add_u32 v2, v4, 4, v3
    s_mov_b32 m0, s97
    s_nop 0
    buffer_load_dwordx4 v2, s[20:23], 0 offen lds
    s_sub_u32 s28, s98, 131072
    s_lshr_b32 s28, s28, 4
    v_add_u32 v2, s28, v1
    v_bfe_u32 v3, v2, 2, 2
    v_lshlrev_b32 v3, 1, v3
    v_and_or_b32 v3, v2, 1, v3
    v_bfe_u32 v4, v2, 1, 1
    v_lshrrev_b32 v2, 4, v2
    v_lshl_add_u32 v4, v2, 1, v4
    v_mul_u32_u24 v3, 1280, v3
    v_lshl_add_u32 v2, v4, 4, v3
    s_mov_b32 m0, s98
    s_mov_b32 exec_hi, 0
    buffer_load_dwordx4 v2, s[20:23], 0 offen lds
    s_mov_b64 exec, -1
    ds_write_b128 v25, v[32:35] offset:0
    ds_write_b128 v25, v[36:39] offset:1024
    ds_write_b128 v25, v[40:43] offset:2048
    ds_write_b128 v25, v[44:47] offset:3072
    ds_write_b128 v25, v[48:51] offset:4096
    ds_write_b128 v25, v[52:55] offset:5120
    ds_write_b128 v25, v[56:59] offset:6144
    ds_write_b128 v25, v[60:63] offset:7168
    ds_write_b128 v25, v[64:67] offset:8192
    ds_write_b128 v25, v[68:71] offset:9216
    ds_write_b128 v25, v[72:75] offset:10240
    ds_write_b128 v25, v[76:79] offset:11264
    ds_write_b128 v25, v[80:83] offset:12288
    ds_write_b128 v25, v[84:87] offset:13312
    ds_write_b128 v25, v[88:91] offset:14336
    ds_write_b128 v25, v[92:95] offset:15360
    ds_write_b128 v25, v[96:99] offset:16384
    ds_write_b128 v25, v[100:103] offset:17408
    ds_write_b128 v25, v[104:107] offset:18432
    ds_write_b128 v25, v[108:111] offset:19456
    ds_write_b128 v25, v[112:115] offset:20480
    ds_write_b128 v25, v[116:119] offset:21504
    ds_write_b128 v25, v[120:123] offset:22528
    ds_write_b128 v25, v[124:127] offset:23552
    ds_write_b128 v25, v[128:131] offset:24576
    ds_write_b128 v25, v[132:135] offset:25600
    ds_write_b128 v25, v[136:139] offset:26624
    ds_write_b128 v25, v[140:143] offset:27648
    ds_write_b128 v25, v[144:147] offset:28672
    ds_write_b128 v25, v[148:151] offset:29696
    ds_write_b128 v25, v[152:155] offset:30720
    ds_write_b128 v25, v[156:159] offset:31744
    s_waitcnt lgkmcnt(0)
    v_mov_b32 v156, -1
    v_mov_b32 v157, -1
    v_mov_b32 v158, -1
    v_mov_b32 v159, -1
    v_and_b32 v26, 7, v1
    v_lshlrev_b32 v26, 5, v26
    v_lshrrev_b32 v2, 3, v1
    v_lshl_add_u32 v26, v2, 2, v26
    s_lshl_b32 s28, s24, 8
    s_add_u32 s28, s28, 141312
    v_add_u32 v26, s28, v26
    v_lshrrev_b32 v27, 4, v1
    v_lshlrev_b32 v27, 8, v27
    v_and_b32 v2, 15, v1
    v_lshl_add_u32 v27, v2, 3, v27
    v_add_u32 v27, 141312, v27
    s_add_u32 s35, s62, 104448
    s_add_u32 s75, s63, 104576
    s_mov_b32 s26, 0
    s_add_u32 s65, s26, 2
    s_bfe_u32 s29, s65, 0x10001
    s_lshl_b32 s29, s29, 13
    s_lshl_b32 s65, s65, 20
    s_sub_u32 s65, s65, s34
    s_add_u32 s65, s65, s33
    s_xor_b32 s29, s29, s34
    s_add_u32 s65, s65, s29
    s_add_u32 s66, s65, 327680
    v_mov_b64 v[6:7], 0
    v_mov_b64 v[8:9], 0
    v_mov_b64 v[10:11], 0
    v_mov_b64 v[12:13], 0
    v_mov_b64 v[14:15], 0
    v_mov_b64 v[16:17], 0
    v_mov_b64 v[104:105], 0
    v_mov_b64 v[106:107], 0
    v_mov_b64 v[108:109], 0
    v_mov_b64 v[110:111], 0
    v_mov_b64 v[112:113], 0
    v_mov_b64 v[114:115], 0
    v_mov_b64 v[116:117], 0
    v_mov_b64 v[118:119], 0
    v_mov_b64 v[120:121], 0
    v_mov_b64 v[122:123], 0
    v_mov_b64 v[124:125], 0
    v_mov_b64 v[126:127], 0
    v_mov_b64 v[128:129], 0
    v_mov_b64 v[130:131], 0
    v_mov_b64 v[132:133], 0
    v_mov_b64 v[134:135], 0
    v_mov_b64 v[136:137], 0
    v_mov_b64 v[138:139], 0
    v_mov_b64 v[140:141], 0
    v_mov_b64 v[142:143], 0
    ds_read_b128 v[32:35], v25 offset:0
    ds_read_b128 v[36:39], v25 offset:1024
    ds_read_b128 v[40:43], v25 offset:2048
    ds_read_b128 v[44:47], v25 offset:3072
    ds_read_b128 v[48:51], v25 offset:4096
    ds_read_b128 v[52:55], v25 offset:5120
    ds_read_b128 v[56:59], v25 offset:6144
    ds_read_b128 v[60:63], v25 offset:7168
    s_mov_b32 s72, 0
    s_mov_b32 s73, 10
    s_mov_b32 s32, 0
    s_waitcnt vmcnt(0)
    s_branch LZ_got
.p2align 6
LZ_top:
    s_and_b32 s68, s26, 3
    s_lshl_b32 s68, s68, 17
    s_add_u32 s68, s68, s63
    s_mov_b32 s32, 0
Lhw_16:
    buffer_load_dword v2, off, s[4:7], s75 sc1
    s_waitcnt vmcnt(0)
    v_cmp_gt_u32 vcc, s26, v2
    s_cbranch_vccnz Lretry_17
Lad_18:
    s_sub_u32 s74, s74, 8
    s_cbranch_scc0 Lad_18
    s_mov_b32 s32, 0
LZ_poll:
    s_mov_b32 m0, s96
    s_nop 0
    buffer_load_dwordx4 v18, s[4:7], s68 offen sc1 lds
    s_mov_b32 m0, s97
    s_nop 0
    buffer_load_dwordx4 v19, s[4:7], s68 offen sc1 lds
    s_mov_b32 m0, s98
    s_mov_b32 exec_hi, 0
    buffer_load_dwordx4 v20, s[4:7], s68 offen sc1 lds
    s_mov_b64 exec, -1
    s_waitcnt vmcnt(2)
LZ_got:
    s_waitcnt lgkmcnt(0)
    s_barrier
    ds_read_b128 v[64:67], v23 offset:0
    ds_read_b128 v[68:71], v23 offset:1024
    s_waitcnt lgkmcnt(1)
    v_smfmac_f32_16x16x64_bf16 v[6:9], v[64:67], a[0:7], v24
    ds_read_b128 v[72:75], v23 offset:2048
    v_smfmac_f32_16x16x64_bf16 v[10:13], v[64:67], a[8:15], v24
    ds_read_b128 v[76:79], v23 offset:3072
    v_smfmac_f32_16x16x64_bf16 v[14:17], v[64:67], a[16:23], v24
    s_waitcnt lgkmcnt(2)
    v_smfmac_f32_16x16x64_bf16 v[6:9], v[68:71], a[24:31], v24
    s_waitcnt vmcnt(0)
    s_barrier
    v_smfmac_f32_16x16x64_bf16 v[10:13], v[68:71], a[32:39], v24
    ds_read2st64_b32 v[2:3], v21 offset0:0 offset1:8
    v_smfmac_f32_16x16x64_bf16 v[14:17], v[68:71], a[40:47], v24
    s_waitcnt lgkmcnt(2)
    ds_read_b128 v[80:83], v23 offset:4096
    v_smfmac_f32_16x16x64_bf16 v[6:9], v[72:75], a[48:55], v24
    ds_read_b128 v[84:87], v23 offset:5120
    v_smfmac_f32_16x16x64_bf16 v[10:13], v[72:75], a[56:63], v24
    ds_read_b128 v[88:91], v23 offset:6144
    v_smfmac_f32_16x16x64_bf16 v[14:17], v[72:75], a[64:71], v24
    s_waitcnt lgkmcnt(3)
    ds_read_b128 v[92:95], v23 offset:7168
    v_max_u32 v2, v2, v3
    v_smfmac_f32_16x16x64_bf16 v[6:9], v[76:79], a[72:79], v24
    s_waitcnt lgkmcnt(3)
    ds_read_b128 v[96:99], v23 offset:8192
    v_cmp_eq_u32 vcc, -1, v2
    v_smfmac_f32_16x16x64_bf16 v[6:9], v[80:83], a[80:87], v24
    s_waitcnt lgkmcnt(3)
    ds_read_b128 v[100:103], v23 offset:9216
    v_smfmac_f32_16x16x64_bf16 v[6:9], v[84:87], a[88:95], v24
    s_waitcnt lgkmcnt(3)
    s_cbranch_vccnz LZ_redo0
LZ_keep0:
    v_smfmac_f32_16x16x64_bf16 v[6:9], v[88:91], v[32:39], v24
    s_waitcnt lgkmcnt(2)
    ds_read_b128 v[32:35], v25 offset:8192
    v_max_u32 v2, v64, v65
    v_smfmac_f32_16x16x64_bf16 v[6:9], v[92:95], v[40:47], v24
    s_waitcnt lgkmcnt(2)
    ds_read_b128 v[36:39], v25 offset:9216
    v_max3_u32 v2, v2, v66, v67
    v_smfmac_f32_16x16x64_bf16 v[6:9], v[96:99], a[96:103], v24
    s_waitcnt lgkmcnt(2)
    ds_read_b128 v[40:43], v25 offset:10240
    v_max3_u32 v2, v2, v68, v69
    v_smfmac_f32_16x16x64_bf16 v[6:9], v[100:103], v[48:55], v24
    ds_read_b128 v[44:47], v25 offset:11264
    v_max3_u32 v2, v2, v70, v71
    v_smfmac_f32_16x16x64_bf16 v[10:13], v[76:79], a[104:111], v24
    ds_read_b128 v[48:51], v25 offset:12288
    v_max3_u32 v2, v2, v72, v73
    v_smfmac_f32_16x16x64_bf16 v[10:13], v[80:83], v[56:63], v24
    ds_read_b128 v[52:55], v25 offset:13312
    v_max3_u32 v2, v2, v74, v75
    v_smfmac_f32_16x16x64_bf16 v[10:13], v[84:87], a[112:119], v24
    ds_read_b128 v[56:59], v25 offset:14336
    v_add_f32 v6, v6, v8
    v_smfmac_f32_16x16x64_bf16 v[10:13], v[88:91], a[120:127], v24
    ds_read_b128 v[60:63], v25 offset:15360
    v_add_f32 v7, v7, v9
    v_smfmac_f32_16x16x64_bf16 v[10:13], v[92:95], a[128:135], v24
    v_cvt_pk_bf16_f32 v6, v6, v7
    v_smfmac_f32_16x16x64_bf16 v[10:13], v[96:99], a[136:143], v24
    s_waitcnt lgkmcnt(6)
    ds_write_b32 v26, v6 offset:0
    v_max3_u32 v2, v2, v76, v77
    v_smfmac_f32_16x16x64_bf16 v[10:13], v[100:103], v[32:39], v24
    ds_read_b128 v[32:35], v25 offset:16384
    v_max3_u32 v2, v2, v78, v79
    v_smfmac_f32_16x16x64_bf16 v[14:17], v[76:79], a[144:151], v24
    ds_read_b128 v[36:39], v25 offset:17408
    v_max3_u32 v2, v2, v80, v81
    v_smfmac_f32_16x16x64_bf16 v[14:17], v[80:83], a[152:159], v24
    s_waitcnt lgkmcnt(2)
    s_barrier
    v_max3_u32 v2, v2, v82, v83
    v_smfmac_f32_16x16x64_bf16 v[14:17], v[84:87], a[160:167], v24
    ds_read_b64_tr_b16 v[144:145], v27 offset:0
    v_add_f32 v10, v10, v12
    v_smfmac_f32_16x16x64_bf16 v[14:17], v[88:91], v[40:47], v24
    ds_read_b64_tr_b16 v[146:147], v27 offset:128
    v_add_f32 v11, v11, v13
    v_smfmac_f32_16x16x64_bf16 v[14:17], v[92:95], a[168:175], v24
    ds_read_b128 v[40:43], v25 offset:18432
    v_cvt_pk_bf16_f32 v10, v10, v11
    v_smfmac_f32_16x16x64_bf16 v[14:17], v[96:99], a[176:183], v24
    ds_write_b32 v26, v10 offset:1024
    v_max3_u32 v2, v2, v84, v85
    v_smfmac_f32_16x16x64_bf16 v[14:17], v[100:103], v[48:55], v24
    s_waitcnt lgkmcnt(2)
    ds_read_b128 v[44:47], v25 offset:19456
    v_max3_u32 v2, v2, v86, v87
    v_smfmac_f32_16x16x64_bf16 v[104:107], v[144:147], a[184:191], v24
    ds_read_b128 v[48:51], v25 offset:20480
    v_max3_u32 v2, v2, v88, v89
    v_smfmac_f32_16x16x64_bf16 v[108:111], v[144:147], a[192:199], v24
    ds_read_b128 v[52:55], v25 offset:21504
    v_max3_u32 v2, v2, v90, v91
    v_smfmac_f32_16x16x64_bf16 v[112:115], v[144:147], a[200:207], v24
    s_waitcnt lgkmcnt(3)
    s_barrier
    v_add_f32 v14, v14, v16
    v_smfmac_f32_16x16x64_bf16 v[116:119], v[144:147], a[208:215], v24
    ds_read_b64_tr_b16 v[148:149], v27 offset:1024
    v_add_f32 v15, v15, v17
    v_smfmac_f32_16x16x64_bf16 v[124:127], v[144:147], a[216:223], v24
    ds_read_b64_tr_b16 v[150:151], v27 offset:1152
    v_cvt_pk_bf16_f32 v14, v14, v15
    v_smfmac_f32_16x16x64_bf16 v[128:131], v[144:147], v[56:63], v24
    ds_write_b32 v26, v14 offset:2048
    v_max3_u32 v2, v2, v92, v93
    v_smfmac_f32_16x16x64_bf16 v[132:135], v[144:147], v[32:39], v24
    ds_read_b128 v[56:59], v25 offset:22528
    v_max3_u32 v2, v2, v94, v95
    v_smfmac_f32_16x16x64_bf16 v[136:139], v[144:147], a[224:231], v24
    ds_read_b128 v[60:63], v25 offset:23552
    v_max3_u32 v2, v2, v96, v97
    v_smfmac_f32_16x16x64_bf16 v[120:123], v[144:147], a[232:239], v24
    ds_read_b128 v[32:35], v25 offset:24576
    v_max3_u32 v2, v2, v98, v99
    v_smfmac_f32_16x16x64_bf16 v[140:143], v[144:147], a[240:247], v24
    s_waitcnt lgkmcnt(4)
    s_waitcnt lgkmcnt(3)
    s_barrier
    v_max3_u32 v2, v2, v100, v101
    v_smfmac_f32_16x16x64_bf16 v[104:107], v[148:151], v[40:47], v24
    ds_read_b64_tr_b16 v[152:153], v27 offset:2048
    v_max3_u32 v2, v2, v102, v103
    v_smfmac_f32_16x16x64_bf16 v[108:111], v[148:151], a[248:255], v24
    ds_read_b64_tr_b16 v[154:155], v27 offset:2176
    v_cmp_eq_u32 vcc, -1, v2
    v_smfmac_f32_16x16x64_bf16 v[112:115], v[148:151], v[160:167], v24
    s_cbranch_vccnz LZ_redo
LZ_keep:
    v_smfmac_f32_16x16x64_bf16 v[116:119], v[148:151], v[168:175], v24
    ds_read_b128 v[36:39], v25 offset:25600
    v_smfmac_f32_16x16x64_bf16 v[124:127], v[148:151], v[48:55], v24
    ds_read_b128 v[40:43], v25 offset:26624
    v_smfmac_f32_16x16x64_bf16 v[128:131], v[148:151], v[176:183], v24
    s_waitcnt lgkmcnt(2)
    ds_read_b128 v[44:47], v25 offset:27648
    v_smfmac_f32_16x16x64_bf16 v[104:107], v[152:155], v[56:63], v24
    ds_read_b128 v[48:51], v25 offset:28672
    v_smfmac_f32_16x16x64_bf16 v[108:111], v[152:155], v[184:191], v24
    ds_read_b128 v[52:55], v25 offset:29696
    v_smfmac_f32_16x16x64_bf16 v[112:115], v[152:155], v[192:199], v24
    ds_read_b128 v[56:59], v25 offset:30720
    v_smfmac_f32_16x16x64_bf16 v[116:119], v[152:155], v[200:207], v24
    ds_read_b128 v[60:63], v25 offset:31744
    v_add_f32 v104, v104, v106
    v_add_f32 v105, v105, v107
    v_smfmac_f32_16x16x64_bf16 v[132:135], v[148:151], v[208:215], v24
    v_cvt_pk_bf16_f32 v64, v104, v105
    v_add_f32 v108, v108, v110
    v_smfmac_f32_16x16x64_bf16 v[136:139], v[148:151], v[216:223], v24
    v_add_f32 v109, v109, v111
    v_cvt_pk_bf16_f32 v66, v108, v109
    v_smfmac_f32_16x16x64_bf16 v[124:127], v[152:155], v[224:231], v24
    s_waitcnt lgkmcnt(6)
    v_add_f32 v112, v112, v114
    v_add_f32 v113, v113, v115
    v_smfmac_f32_16x16x64_bf16 v[128:131], v[152:155], v[32:39], v24
    v_cvt_pk_bf16_f32 v65, v112, v113
    v_add_f32 v116, v116, v118
    v_smfmac_f32_16x16x64_bf16 v[132:135], v[152:155], v[232:239], v24
    s_waitcnt lgkmcnt(4)
    v_add_f32 v117, v117, v119
    v_cvt_pk_bf16_f32 v67, v116, v117
    v_smfmac_f32_16x16x64_bf16 v[136:139], v[152:155], v[40:47], v24
    v_permlane32_swap_b32 v64, v65
    v_permlane32_swap_b32 v66, v67
    v_smfmac_f32_16x16x64_bf16 v[120:123], v[148:151], v[240:247], v24
    s_waitcnt lgkmcnt(2)
    v_permlane16_swap_b32 v64, v66
    v_permlane16_swap_b32 v65, v67
    v_smfmac_f32_16x16x64_bf16 v[140:143], v[148:151], v[48:55], v24
    v_min_u32 v64, -2, v64
    v_min_u32 v66, -2, v66
    v_smfmac_f32_16x16x64_bf16 v[120:123], v[152:155], v[248:255], v24
    s_waitcnt lgkmcnt(0)
    buffer_store_dwordx4 v[64:67], v28, s[4:7], s65 offen sc1
    v_add_f32 v124, v124, v126
    v_smfmac_f32_16x16x64_bf16 v[140:143], v[152:155], v[56:63], v24
    v_add_f32 v125, v125, v127
    v_cvt_pk_bf16_f32 v68, v124, v125
    v_add_f32 v128, v128, v130
    v_add_f32 v129, v129, v131
    v_cvt_pk_bf16_f32 v70, v128, v129
    v_add_f32 v132, v132, v134
    v_add_f32 v133, v133, v135
    v_cvt_pk_bf16_f32 v69, v132, v133
    v_add_f32 v136, v136, v138
    v_add_f32 v137, v137, v139
    v_cvt_pk_bf16_f32 v71, v136, v137
    v_add_f32 v120, v120, v122
    v_add_f32 v121, v121, v123
    v_permlane32_swap_b32 v68, v69
    v_permlane32_swap_b32 v70, v71
    v_cvt_pk_bf16_f32 v72, v120, v121
    v_add_f32 v140, v140, v142
    v_permlane16_swap_b32 v68, v70
    v_permlane16_swap_b32 v69, v71
    v_add_f32 v141, v141, v143
    v_cvt_pk_bf16_f32 v73, v140, v141
    v_min_u32 v68, -2, v68
    v_min_u32 v70, -2, v70
    buffer_store_dwordx4 v[68:71], v28, s[4:7], s66 offen sc1
    v_permlane32_swap_b32 v72, v73
    v_min_u32 v72, -2, v72
    buffer_store_dwordx2 v[72:73], v29, s[4:7], s65 offen sc1
    s_barrier
    s_min_u32 s29, s32, 1
    s_lshl_b32 s72, s72, 1
    s_or_b32 s72, s72, s29
    s_and_b32 s72, s72, 7
    s_mul_i32 s29, s29, s72
    s_cmp_gt_u32 s29, 1
    s_cselect_b32 s28, 12, -1
    s_add_i32 s73, s73, s28
    s_max_i32 s73, s73, 10
    s_min_i32 s73, s73, 160
    s_mov_b32 s74, s73
    s_sub_u32 s30, s26, 8
    s_cmp_ge_u32 s30, 4
    s_cbranch_scc1 LZ_nox
    s_add_u32 s28, s26, 54
    s_bfe_u32 s29, s28, 0x10001
    s_lshl_b32 s29, s29, 13
    s_lshl_b32 s28, s28, 20
    s_sub_u32 s28, s28, s34
    s_add_u32 s28, s28, s33
    s_xor_b32 s29, s29, s34
    s_add_u32 s28, s28, s29
    buffer_store_dwordx4 v[156:159], v28, s[4:7], s28 offen sc1
    buffer_store_dwordx2 v[156:157], v29, s[4:7], s28 offen sc1
    s_add_u32 s28, s28, 327680
    buffer_store_dwordx4 v[156:159], v28, s[4:7], s28 offen sc1
LZ_nox:
    s_cmp_ge_u32 s26, 58
    s_cbranch_scc1 LZ_nop
    s_add_u32 s28, s26, 4
    s_bfe_u32 s29, s28, 0x10001
    s_lshl_b32 s29, s29, 13
    s_lshl_b32 s28, s28, 20
    s_sub_u32 s28, s28, s34
    s_add_u32 s28, s28, s33
    s_xor_b32 s29, s29, s34
    s_add_u32 s28, s28, s29
    buffer_store_dwordx4 v[156:159], v28, s[4:7], s28 offen sc1
    buffer_store_dwordx2 v[156:157], v29, s[4:7], s28 offen sc1
    s_add_u32 s28, s28, 327680
    buffer_store_dwordx4 v[156:159], v28, s[4:7], s28 offen sc1
LZ_nop:
    s_add_u32 s26, s26, 1
    s_cmp_ge_u32 s26, 64
    s_cbranch_scc1 LZ_end
    s_add_u32 s65, s26, 2
    s_bfe_u32 s29, s65, 0x10001
    s_lshl_b32 s29, s29, 13
    s_lshl_b32 s65, s65, 20
    s_sub_u32 s65, s65, s34
    s_add_u32 s65, s65, s33
    s_xor_b32 s29, s29, s34
    s_add_u32 s65, s65, s29
    s_add_u32 s66, s65, 327680
    v_mov_b64 v[6:7], 0
    v_mov_b64 v[8:9], 0
    v_mov_b64 v[10:11], 0
    v_mov_b64 v[12:13], 0
    v_mov_b64 v[14:15], 0
    v_mov_b64 v[16:17], 0
    v_mov_b64 v[104:105], 0
    v_mov_b64 v[106:107], 0
    v_mov_b64 v[108:109], 0
    v_mov_b64 v[110:111], 0
    v_mov_b64 v[112:113], 0
    v_mov_b64 v[114:115], 0
    v_mov_b64 v[116:117], 0
    v_mov_b64 v[118:119], 0
    v_mov_b64 v[120:121], 0
    v_mov_b64 v[122:123], 0
    v_mov_b64 v[124:125], 0
    v_mov_b64 v[126:127], 0
    v_mov_b64 v[128:129], 0
    v_mov_b64 v[130:131], 0
    v_mov_b64 v[132:133], 0
    v_mov_b64 v[134:135], 0
    v_mov_b64 v[136:137], 0
    v_mov_b64 v[138:139], 0
    v_mov_b64 v[140:141], 0
    v_mov_b64 v[142:143], 0
    ds_read_b128 v[32:35], v25 offset:0
    ds_read_b128 v[36:39], v25 offset:1024
    ds_read_b128 v[40:43], v25 offset:2048
    ds_read_b128 v[44:47], v25 offset:3072
    ds_read_b128 v[48:51], v25 offset:4096
    ds_read_b128 v[52:55], v25 offset:5120
    ds_read_b128 v[56:59], v25 offset:6144
    ds_read_b128 v[60:63], v25 offset:7168
    s_branch LZ_top
LZ_end:
    s_endpgm
LZ_redo0:
    s_cmp_eq_u32 s26, 0
    s_cbranch_scc1 LZ_keep0
    s_waitcnt lgkmcnt(0)
    s_barrier
    s_mov_b32 m0, s96
    s_nop 0
    buffer_load_dwordx4 v18, s[4:7], s68 offen sc1 lds
    s_mov_b32 m0, s97
    s_nop 0
    buffer_load_dwordx4 v19, s[4:7], s68 offen sc1 lds
    s_mov_b32 m0, s98
    s_mov_b32 exec_hi, 0
    buffer_load_dwordx4 v20, s[4:7], s68 offen sc1 lds
    s_mov_b64 exec, -1
    v_mov_b64 v[6:7], 0
    v_mov_b64 v[8:9], 0
    v_mov_b64 v[10:11], 0
    v_mov_b64 v[12:13], 0
    v_mov_b64 v[14:15], 0
    v_mov_b64 v[16:17], 0
    s_branch LZ_care
LZ_redo:
    s_cmp_eq_u32 s26, 0
    s_cbranch_scc1 LZ_keep
    s_waitcnt lgkmcnt(0)
    s_barrier
    s_nop 7
    v_mov_b64 v[6:7], 0
    v_mov_b64 v[8:9], 0
    v_mov_b64 v[10:11], 0
    v_mov_b64 v[12:13], 0
    v_mov_b64 v[14:15], 0
    v_mov_b64 v[16:17], 0
    v_mov_b64 v[104:105], 0
    v_mov_b64 v[106:107], 0
    v_mov_b64 v[108:109], 0
    v_mov_b64 v[110:111], 0
    v_mov_b64 v[112:113], 0
    v_mov_b64 v[114:115], 0
    v_mov_b64 v[116:117], 0
    v_mov_b64 v[118:119], 0
    v_mov_b64 v[120:121], 0
    v_mov_b64 v[122:123], 0
    v_mov_b64 v[124:125], 0
    v_mov_b64 v[126:127], 0
    v_mov_b64 v[128:129], 0
    v_mov_b64 v[130:131], 0
    v_mov_b64 v[132:133], 0
    v_mov_b64 v[134:135], 0
    v_mov_b64 v[136:137], 0
    v_mov_b64 v[138:139], 0
    v_mov_b64 v[140:141], 0
    v_mov_b64 v[142:143], 0
    ds_read_b128 v[32:35], v25 offset:0
    ds_read_b128 v[36:39], v25 offset:1024
    ds_read_b128 v[40:43], v25 offset:2048
    ds_read_b128 v[44:47], v25 offset:3072
    ds_read_b128 v[48:51], v25 offset:4096
    ds_read_b128 v[52:55], v25 offset:5120
    ds_read_b128 v[56:59], v25 offset:6144
    ds_read_b128 v[60:63], v25 offset:7168
LZ_again:
    s_mov_b32 m0, s96
    s_nop 0
    buffer_load_dwordx4 v18, s[4:7], s68 offen sc1 lds
    s_mov_b32 m0, s97
    s_nop 0
    buffer_load_dwordx4 v19, s[4:7], s68 offen sc1 lds
    s_mov_b32 m0, s98
    s_mov_b32 exec_hi, 0
    buffer_load_dwordx4 v20, s[4:7], s68 offen sc1 lds
    s_mov_b64 exec, -1
LZ_care:
    s_add_u32 s32, s32, 1
    v_mov_b32 v3, s96
    v_mov_b32 v2, s97
    v_cmp_gt_u32 vcc, 8, v1
    s_nop 1
    v_cndmask_b32 v3, v2, v3, vcc
    v_and_b32 v2, 7, v1
    v_lshl_add_u32 v3, v2, 7, v3
    v_and_b32 v2, 3, v1
    v_lshl_add_u32 v2, v2, 7, s98
    v_cmp_gt_u32 vcc, 16, v1
    s_nop 1
    v_cndmask_b32 v3, v2, v3, vcc
    v_and_b32 v2, 31, v1
    v_lshl_add_u32 v3, v2, 2, v3
    s_waitcnt vmcnt(0)
    ds_read_b32 v2, v3
    s_waitcnt lgkmcnt(0)
    v_cmp_eq_u32 vcc, -1, v2
    s_cmp_ge_u32 s32, 200000
    s_cbranch_scc1 LZ_giveup
    s_cbranch_vccz LZ_got
    s_branch LZ_again
LZ_giveup:
    v_mov_b32 v2, 13
    v_mov_b32 v3, 4
    buffer_store_dword v2, v3, s[16:19], 0 offen sc1
    s_endpgm
Lretry_15:
    s_sleep 6
    buffer_load_dwordx2 v[2:3], off, s[16:19], 0 offset:128 sc1
    s_waitcnt vmcnt(0)
    s_add_u32 s32, s32, 1
    s_cmp_lt_u32 s32, 200000
    s_cbranch_scc1 Lws_14
    v_mov_b32 v2, 1
    v_mov_b32 v3, 4
    buffer_store_dword v2, v3, s[16:19], 0 offen sc1
    s_endpgm
Lretry_17:
    s_add_u32 s32, s32, 1
    s_cmp_lt_u32 s32, 200000
    s_cbranch_scc1 Lhw_16
    v_mov_b32 v2, 12
    v_mov_b32 v3, 4
    buffer_store_dword v2, v3, s[16:19], 0 offen sc1
    s_endpgm
E_Z:
.p2align 6
W_C:
R_C:
    s_mov_b32 s12, s36
    s_mov_b32 s13, s37
    s_mov_b32 s14, 2621440
    s_mov_b32 s15, 0x20000
    s_add_u32 s28, s25, 0
    s_mul_i32 s28, s28, 40960
    s_mul_i32 s29, s24, 10240
    s_add_u32 s29, s29, s28
    v_and_b32 v2, 7, v1
    v_mul_u32_u24 v2, 1280, v2
    v_lshrrev_b32 v3, 3, v1
    v_lshl_add_u32 v2, v3, 4, v2
    buffer_load_dwordx4 v[8:11], v2, s[12:15], s29 offen offset:0
    buffer_load_dwordx4 v[12:15], v2, s[12:15], s29 offen offset:128
    buffer_load_dwordx4 v[16:19], v2, s[12:15], s29 offen offset:256
    buffer_load_dwordx4 v[20:23], v2, s[12:15], s29 offen offset:384
    buffer_load_dwordx4 v[24:27], v2, s[12:15], s29 offen offset:512
    buffer_load_dwordx4 v[28:31], v2, s[12:15], s29 offen offset:640
    buffer_load_dwordx4 v[32:35], v2, s[12:15], s29 offen offset:768
    buffer_load_dwordx4 v[36:39], v2, s[12:15], s29 offen offset:896
    buffer_load_dwordx4 v[40:43], v2, s[12:15], s29 offen offset:1024
    buffer_load_dwordx4 v[44:47], v2, s[12:15], s29 offen offset:1152
    v_and_b32 v2, 7, v1
    v_lshlrev_b32 v2, 4, v2
    v_bfe_u32 v3, v1, 3, 2
    v_lshl_add_u32 v2, v3, 8, v2
    v_lshrrev_b32 v3, 5, v1
    v_lshl_add_u32 v2, v3, 10, v2
    s_lshr_b32 s29, s24, 1
    s_mul_i32 s29, s29, 20480
    s_add_u32 s28, s28, s29
    s_and_b32 s29, s24, 1
    s_lshl_b32 s29, s29, 7
    s_add_u32 s29, s29, s28
    v_mov_b32 v4, 0
    v_mov_b32 v5, 0
    s_waitcnt vmcnt(9)
    v_lshlrev_b32 v56, 16, v8
    v_and_b32 v57, 0xffff0000, v8
    v_pk_add_f32 v[4:5], v[4:5], v[56:57]
    v_lshlrev_b32 v58, 16, v9
    v_and_b32 v59, 0xffff0000, v9
    v_pk_add_f32 v[4:5], v[4:5], v[58:59]
    v_lshlrev_b32 v60, 16, v10
    v_and_b32 v61, 0xffff0000, v10
    v_pk_add_f32 v[4:5], v[4:5], v[60:61]
    v_lshlrev_b32 v62, 16, v11
    v_and_b32 v63, 0xffff0000, v11
    v_pk_add_f32 v[4:5], v[4:5], v[62:63]
    s_waitcnt vmcnt(8)
    v_lshlrev_b32 v64, 16, v12
    v_and_b32 v65, 0xffff0000, v12
    v_pk_add_f32 v[4:5], v[4:5], v[64:65]
    v_lshlrev_b32 v66, 16, v13
    v_and_b32 v67, 0xffff0000, v13
    v_pk_add_f32 v[4:5], v[4:5], v[66:67]
    v_lshlrev_b32 v68, 16, v14
    v_and_b32 v69, 0xffff0000, v14
    v_pk_add_f32 v[4:5], v[4:5], v[68:69]
    v_lshlrev_b32 v70, 16, v15
    v_and_b32 v71, 0xffff0000, v15
    v_pk_add_f32 v[4:5], v[4:5], v[70:71]
    s_waitcnt vmcnt(7)
    v_lshlrev_b32 v72, 16, v16
    v_and_b32 v73, 0xffff0000, v16
    v_pk_add_f32 v[4:5], v[4:5], v[72:73]
    v_lshlrev_b32 v74, 16, v17
    v_and_b32 v75, 0xffff0000, v17
    v_pk_add_f32 v[4:5], v[4:5], v[74:75]
    v_lshlrev_b32 v76, 16, v18
    v_and_b32 v77, 0xffff0000, v18
    v_pk_add_f32 v[4:5], v[4:5], v[76:77]
    v_lshlrev_b32 v78, 16, v19
    v_and_b32 v79, 0xffff0000, v19
    v_pk_add_f32 v[4:5], v[4:5], v[78:79]
    s_waitcnt vmcnt(6)
    v_lshlrev_b32 v80, 16, v20
    v_and_b32 v81, 0xffff0000, v20
    v_pk_add_f32 v[4:5], v[4:5], v[80:81]
    v_lshlrev_b32 v82, 16, v21
    v_and_b32 v83, 0xffff0000, v21
    v_pk_add_f32 v[4:5], v[4:5], v[82:83]
    v_lshlrev_b32 v84, 16, v22
    v_and_b32 v85, 0xffff0000, v22
    v_pk_add_f32 v[4:5], v[4:5], v[84:85]
    v_lshlrev_b32 v86, 16, v23
    v_and_b32 v87, 0xffff0000, v23
    v_pk_add_f32 v[4:5], v[4:5], v[86:87]
    s_waitcnt vmcnt(5)
    v_lshlrev_b32 v88, 16, v24
    v_and_b32 v89, 0xffff0000, v24
    v_pk_add_f32 v[4:5], v[4:5], v[88:89]
    v_lshlrev_b32 v90, 16, v25
    v_and_b32 v91, 0xffff0000, v25
    v_pk_add_f32 v[4:5], v[4:5], v[90:91]
    v_lshlrev_b32 v92, 16, v26
    v_and_b32 v93, 0xffff0000, v26
    v_pk_add_f32 v[4:5], v[4:5], v[92:93]
    v_lshlrev_b32 v94, 16, v27
    v_and_b32 v95, 0xffff0000, v27
    v_pk_add_f32 v[4:5], v[4:5], v[94:95]
    s_waitcnt vmcnt(4)
    v_lshlrev_b32 v96, 16, v28
    v_and_b32 v97, 0xffff0000, v28
    v_pk_add_f32 v[4:5], v[4:5], v[96:97]
    v_lshlrev_b32 v98, 16, v29
    v_and_b32 v99, 0xffff0000, v29
    v_pk_add_f32 v[4:5], v[4:5], v[98:99]
    v_lshlrev_b32 v100, 16, v30
    v_and_b32 v101, 0xffff0000, v30
    v_pk_add_f32 v[4:5], v[4:5], v[100:101]
    v_lshlrev_b32 v102, 16, v31
    v_and_b32 v103, 0xffff0000, v31
    v_pk_add_f32 v[4:5], v[4:5], v[102:103]
    s_waitcnt vmcnt(3)
    v_lshlrev_b32 v104, 16, v32
    v_and_b32 v105, 0xffff0000, v32
    v_pk_add_f32 v[4:5], v[4:5], v[104:105]
    v_lshlrev_b32 v106, 16, v33
    v_and_b32 v107, 0xffff0000, v33
    v_pk_add_f32 v[4:5], v[4:5], v[106:107]
    v_lshlrev_b32 v108, 16, v34
    v_and_b32 v109, 0xffff0000, v34
    v_pk_add_f32 v[4:5], v[4:5], v[108:109]
    v_lshlrev_b32 v110, 16, v35
    v_and_b32 v111, 0xffff0000, v35
    v_pk_add_f32 v[4:5], v[4:5], v[110:111]
    s_waitcnt vmcnt(2)
    v_lshlrev_b32 v112, 16, v36
    v_and_b32 v113, 0xffff0000, v36
    v_pk_add_f32 v[4:5], v[4:5], v[112:113]
    v_lshlrev_b32 v114, 16, v37
    v_and_b32 v115, 0xffff0000, v37
    v_pk_add_f32 v[4:5], v[4:5], v[114:115]
    v_lshlrev_b32 v116, 16, v38
    v_and_b32 v117, 0xffff0000, v38
    v_pk_add_f32 v[4:5], v[4:5], v[116:117]
    v_lshlrev_b32 v118, 16, v39
    v_and_b32 v119, 0xffff0000, v39
    v_pk_add_f32 v[4:5], v[4:5], v[118:119]
    s_waitcnt vmcnt(1)
    v_lshlrev_b32 v120, 16, v40
    v_and_b32 v121, 0xffff0000, v40
    v_pk_add_f32 v[4:5], v[4:5], v[120:121]
    v_lshlrev_b32 v122, 16, v41
    v_and_b32 v123, 0xffff0000, v41
    v_pk_add_f32 v[4:5], v[4:5], v[122:123]
    v_lshlrev_b32 v124, 16, v42
    v_and_b32 v125, 0xffff0000, v42
    v_pk_add_f32 v[4:5], v[4:5], v[124:125]
    v_lshlrev_b32 v126, 16, v43
    v_and_b32 v127, 0xffff0000, v43
    v_pk_add_f32 v[4:5], v[4:5], v[126:127]
    s_waitcnt vmcnt(0)
    v_lshlrev_b32 v128, 16, v44
    v_and_b32 v129, 0xffff0000, v44
    v_pk_add_f32 v[4:5], v[4:5], v[128:129]
    v_lshlrev_b32 v130, 16, v45
    v_and_b32 v131, 0xffff0000, v45
    v_pk_add_f32 v[4:5], v[4:5], v[130:131]
    v_lshlrev_b32 v132, 16, v46
    v_and_b32 v133, 0xffff0000, v46
    v_pk_add_f32 v[4:5], v[4:5], v[132:133]
    v_lshlrev_b32 v134, 16, v47
    v_and_b32 v135, 0xffff0000, v47
    v_pk_add_f32 v[4:5], v[4:5], v[134:135]
    v_add_f32 v4, v4, v5
    s_nop 1
    v_add_f32_dpp v4, v4, v4 row_ror:8 row_mask:0xf bank_mask:0xf
    v_mov_b32 v7, v4
    s_nop 1
    v_permlane16_swap_b32 v4, v7
    v_add_f32 v4, v4, v7
    v_mov_b32 v7, v4
    s_nop 1
    v_permlane32_swap_b32 v4, v7
    v_add_f32 v4, v4, v7
    v_mul_f32 v4, 0x3acccccd, v4
    v_mov_b32 v5, v4
    v_mov_b32 v48, 0
    v_mov_b32 v49, 0
    v_pk_add_f32 v[50:51], v[56:57], v[4:5] neg_lo:[0,1] neg_hi:[0,1]
    v_pk_fma_f32 v[48:49], v[50:51], v[50:51], v[48:49]
    v_pk_add_f32 v[50:51], v[58:59], v[4:5] neg_lo:[0,1] neg_hi:[0,1]
    v_pk_fma_f32 v[48:49], v[50:51], v[50:51], v[48:49]
    v_pk_add_f32 v[50:51], v[60:61], v[4:5] neg_lo:[0,1] neg_hi:[0,1]
    v_pk_fma_f32 v[48:49], v[50:51], v[50:51], v[48:49]
    v_pk_add_f32 v[50:51], v[62:63], v[4:5] neg_lo:[0,1] neg_hi:[0,1]
    v_pk_fma_f32 v[48:49], v[50:51], v[50:51], v[48:49]
    v_pk_add_f32 v[50:51], v[64:65], v[4:5] neg_lo:[0,1] neg_hi:[0,1]
    v_pk_fma_f32 v[48:49], v[50:51], v[50:51], v[48:49]
    v_pk_add_f32 v[50:51], v[66:67], v[4:5] neg_lo:[0,1] neg_hi:[0,1]
    v_pk_fma_f32 v[48:49], v[50:51], v[50:51], v[48:49]
    v_pk_add_f32 v[50:51], v[68:69], v[4:5] neg_lo:[0,1] neg_hi:[0,1]
    v_pk_fma_f32 v[48:49], v[50:51], v[50:51], v[48:49]
    v_pk_add_f32 v[50:51], v[70:71], v[4:5] neg_lo:[0,1] neg_hi:[0,1]
    v_pk_fma_f32 v[48:49], v[50:51], v[50:51], v[48:49]
    v_pk_add_f32 v[50:51], v[72:73], v[4:5] neg_lo:[0,1] neg_hi:[0,1]
    v_pk_fma_f32 v[48:49], v[50:51], v[50:51], v[48:49]
    v_pk_add_f32 v[50:51], v[74:75], v[4:5] neg_lo:[0,1] neg_hi:[0,1]
    v_pk_fma_f32 v[48:49], v[50:51], v[50:51], v[48:49]
    v_pk_add_f32 v[50:51], v[76:77], v[4:5] neg_lo:[0,1] neg_hi:[0,1]
    v_pk_fma_f32 v[48:49], v[50:51], v[50:51], v[48:49]
    v_pk_add_f32 v[50:51], v[78:79], v[4:5] neg_lo:[0,1] neg_hi:[0,1]
    v_pk_fma_f32 v[48:49], v[50:51], v[50:51], v[48:49]
    v_pk_add_f32 v[50:51], v[80:81], v[4:5] neg_lo:[0,1] neg_hi:[0,1]
    v_pk_fma_f32 v[48:49], v[50:51], v[50:51], v[48:49]
    v_pk_add_f32 v[50:51], v[82:83], v[4:5] neg_lo:[0,1] neg_hi:[0,1]
    v_pk_fma_f32 v[48:49], v[50:51], v[50:51], v[48:49]
    v_pk_add_f32 v[50:51], v[84:85], v[4:5] neg_lo:[0,1] neg_hi:[0,1]
    v_pk_fma_f32 v[48:49], v[50:51], v[50:51], v[48:49]
    v_pk_add_f32 v[50:51], v[86:87], v[4:5] neg_lo:[0,1] neg_hi:[0,1]
    v_pk_fma_f32 v[48:49], v[50:51], v[50:51], v[48:49]
    v_pk_add_f32 v[50:51], v[88:89], v[4:5] neg_lo:[0,1] neg_hi:[0,1]
    v_pk_fma_f32 v[48:49], v[50:51], v[50:51], v[48:49]
    v_pk_add_f32 v[50:51], v[90:91], v[4:5] neg_lo:[0,1] neg_hi:[0,1]
    v_pk_fma_f32 v[48:49], v[50:51], v[50:51], v[48:49]
    v_pk_add_f32 v[50:51], v[92:93], v[4:5] neg_lo:[0,1] neg_hi:[0,1]
    v_pk_fma_f32 v[48:49], v[50:51], v[50:51], v[48:49]
    v_pk_add_f32 v[50:51], v[94:95], v[4:5] neg_lo:[0,1] neg_hi:[0,1]
    v_pk_fma_f32 v[48:49], v[50:51], v[50:51], v[48:49]
    v_pk_add_f32 v[50:51], v[96:97], v[4:5] neg_lo:[0,1] neg_hi:[0,1]
    v_pk_fma_f32 v[48:49], v[50:51], v[50:51], v[48:49]
    v_pk_add_f32 v[50:51], v[98:99], v[4:5] neg_lo:[0,1] neg_hi:[0,1]
    v_pk_fma_f32 v[48:49], v[50:51], v[50:51], v[48:49]
    v_pk_add_f32 v[50:51], v[100:101], v[4:5] neg_lo:[0,1] neg_hi:[0,1]
    v_pk_fma_f32 v[48:49], v[50:51], v[50:51], v[48:49]
    v_pk_add_f32 v[50:51], v[102:103], v[4:5] neg_lo:[0,1] neg_hi:[0,1]
    v_pk_fma_f32 v[48:49], v[50:51], v[50:51], v[48:49]
    v_pk_add_f32 v[50:51], v[104:105], v[4:5] neg_lo:[0,1] neg_hi:[0,1]
    v_pk_fma_f32 v[48:49], v[50:51], v[50:51], v[48:49]
    v_pk_add_f32 v[50:51], v[106:107], v[4:5] neg_lo:[0,1] neg_hi:[0,1]
    v_pk_fma_f32 v[48:49], v[50:51], v[50:51], v[48:49]
    v_pk_add_f32 v[50:51], v[108:109], v[4:5] neg_lo:[0,1] neg_hi:[0,1]
    v_pk_fma_f32 v[48:49], v[50:51], v[50:51], v[48:49]
    v_pk_add_f32 v[50:51], v[110:111], v[4:5] neg_lo:[0,1] neg_hi:[0,1]
    v_pk_fma_f32 v[48:49], v[50:51], v[50:51], v[48:49]
    v_pk_add_f32 v[50:51], v[112:113], v[4:5] neg_lo:[0,1] neg_hi:[0,1]
    v_pk_fma_f32 v[48:49], v[50:51], v[50:51], v[48:49]
    v_pk_add_f32 v[50:51], v[114:115], v[4:5] neg_lo:[0,1] neg_hi:[0,1]
    v_pk_fma_f32 v[48:49], v[50:51], v[50:51], v[48:49]
    v_pk_add_f32 v[50:51], v[116:117], v[4:5] neg_lo:[0,1] neg_hi:[0,1]
    v_pk_fma_f32 v[48:49], v[50:51], v[50:51], v[48:49]
    v_pk_add_f32 v[50:51], v[118:119], v[4:5] neg_lo:[0,1] neg_hi:[0,1]
    v_pk_fma_f32 v[48:49], v[50:51], v[50:51], v[48:49]
    v_pk_add_f32 v[50:51], v[120:121], v[4:5] neg_lo:[0,1] neg_hi:[0,1]
    v_pk_fma_f32 v[48:49], v[50:51], v[50:51], v[48:49]
    v_pk_add_f32 v[50:51], v[122:123], v[4:5] neg_lo:[0,1] neg_hi:[0,1]
    v_pk_fma_f32 v[48:49], v[50:51], v[50:51], v[48:49]
    v_pk_add_f32 v[50:51], v[124:125], v[4:5] neg_lo:[0,1] neg_hi:[0,1]
    v_pk_fma_f32 v[48:49], v[50:51], v[50:51], v[48:49]
    v_pk_add_f32 v[50:51], v[126:127], v[4:5] neg_lo:[0,1] neg_hi:[0,1]
    v_pk_fma_f32 v[48:49], v[50:51], v[50:51], v[48:49]
    v_pk_add_f32 v[50:51], v[128:129], v[4:5] neg_lo:[0,1] neg_hi:[0,1]
    v_pk_fma_f32 v[48:49], v[50:51], v[50:51], v[48:49]
    v_pk_add_f32 v[50:51], v[130:131], v[4:5] neg_lo:[0,1] neg_hi:[0,1]
    v_pk_fma_f32 v[48:49], v[50:51], v[50:51], v[48:49]
    v_pk_add_f32 v[50:51], v[132:133], v[4:5] neg_lo:[0,1] neg_hi:[0,1]
    v_pk_fma_f32 v[48:49], v[50:51], v[50:51], v[48:49]
    v_pk_add_f32 v[50:51], v[134:135], v[4:5] neg_lo:[0,1] neg_hi:[0,1]
    v_pk_fma_f32 v[48:49], v[50:51], v[50:51], v[48:49]
    v_add_f32 v6, v48, v49
    s_nop 1
    v_add_f32_dpp v6, v6, v6 row_ror:8 row_mask:0xf bank_mask:0xf
    v_mov_b32 v7, v6
    s_nop 1
    v_permlane16_swap_b32 v6, v7
    v_add_f32 v6, v6, v7
    v_mov_b32 v7, v6
    s_nop 1
    v_permlane32_swap_b32 v6, v7
    v_add_f32 v6, v6, v7
    v_mul_f32 v6, 0x3acccccd, v6
    v_cvt_pk_bf16_f32 v6, v6, v6
    v_and_b32 v6, 0xffff0000, v6
    v_add_f32 v6, 0x3727c5ac, v6
    v_cvt_pk_bf16_f32 v6, v6, v6
    v_and_b32 v6, 0xffff0000, v6
    v_sqrt_f32 v6, v6
    s_nop 0
    v_cvt_pk_bf16_f32 v6, v6, v6
    v_and_b32 v6, 0xffff0000, v6
    v_rcp_f32 v6, v6
    s_nop 0
    v_mov_b32 v7, v6
    v_cvt_pk_bf16_f32 v4, v4, v4
    v_and_b32 v4, 0xffff0000, v4
    v_mov_b32 v5, v4
    v_pk_add_f32 v[56:57], v[56:57], v[4:5] neg_lo:[0,1] neg_hi:[0,1]
    v_cvt_pk_bf16_f32 v8, v56, v57
    v_lshlrev_b32 v56, 16, v8
    v_and_b32 v57, 0xffff0000, v8
    v_pk_mul_f32 v[56:57], v[56:57], v[6:7]
    v_cvt_pk_bf16_f32 v8, v56, v57
    v_pk_add_f32 v[58:59], v[58:59], v[4:5] neg_lo:[0,1] neg_hi:[0,1]
    v_cvt_pk_bf16_f32 v9, v58, v59
    v_lshlrev_b32 v58, 16, v9
    v_and_b32 v59, 0xffff0000, v9
    v_pk_mul_f32 v[58:59], v[58:59], v[6:7]
    v_cvt_pk_bf16_f32 v9, v58, v59
    v_pk_add_f32 v[60:61], v[60:61], v[4:5] neg_lo:[0,1] neg_hi:[0,1]
    v_cvt_pk_bf16_f32 v10, v60, v61
    v_lshlrev_b32 v60, 16, v10
    v_and_b32 v61, 0xffff0000, v10
    v_pk_mul_f32 v[60:61], v[60:61], v[6:7]
    v_cvt_pk_bf16_f32 v10, v60, v61
    v_pk_add_f32 v[62:63], v[62:63], v[4:5] neg_lo:[0,1] neg_hi:[0,1]
    v_cvt_pk_bf16_f32 v11, v62, v63
    v_lshlrev_b32 v62, 16, v11
    v_and_b32 v63, 0xffff0000, v11
    v_pk_mul_f32 v[62:63], v[62:63], v[6:7]
    v_cvt_pk_bf16_f32 v11, v62, v63
    buffer_store_dwordx4 v[8:11], v2, s[4:7], s29 offen offset:0 sc1
    v_pk_add_f32 v[64:65], v[64:65], v[4:5] neg_lo:[0,1] neg_hi:[0,1]
    v_cvt_pk_bf16_f32 v12, v64, v65
    v_lshlrev_b32 v64, 16, v12
    v_and_b32 v65, 0xffff0000, v12
    v_pk_mul_f32 v[64:65], v[64:65], v[6:7]
    v_cvt_pk_bf16_f32 v12, v64, v65
    v_pk_add_f32 v[66:67], v[66:67], v[4:5] neg_lo:[0,1] neg_hi:[0,1]
    v_cvt_pk_bf16_f32 v13, v66, v67
    v_lshlrev_b32 v66, 16, v13
    v_and_b32 v67, 0xffff0000, v13
    v_pk_mul_f32 v[66:67], v[66:67], v[6:7]
    v_cvt_pk_bf16_f32 v13, v66, v67
    v_pk_add_f32 v[68:69], v[68:69], v[4:5] neg_lo:[0,1] neg_hi:[0,1]
    v_cvt_pk_bf16_f32 v14, v68, v69
    v_lshlrev_b32 v68, 16, v14
    v_and_b32 v69, 0xffff0000, v14
    v_pk_mul_f32 v[68:69], v[68:69], v[6:7]
    v_cvt_pk_bf16_f32 v14, v68, v69
    v_pk_add_f32 v[70:71], v[70:71], v[4:5] neg_lo:[0,1] neg_hi:[0,1]
    v_cvt_pk_bf16_f32 v15, v70, v71
    v_lshlrev_b32 v70, 16, v15
    v_and_b32 v71, 0xffff0000, v15
    v_pk_mul_f32 v[70:71], v[70:71], v[6:7]
    v_cvt_pk_bf16_f32 v15, v70, v71
    buffer_store_dwordx4 v[12:15], v2, s[4:7], s29 offen offset:2048 sc1
    v_pk_add_f32 v[72:73], v[72:73], v[4:5] neg_lo:[0,1] neg_hi:[0,1]
    v_cvt_pk_bf16_f32 v16, v72, v73
    v_lshlrev_b32 v72, 16, v16
    v_and_b32 v73, 0xffff0000, v16
    v_pk_mul_f32 v[72:73], v[72:73], v[6:7]
    v_cvt_pk_bf16_f32 v16, v72, v73
    v_pk_add_f32 v[74:75], v[74:75], v[4:5] neg_lo:[0,1] neg_hi:[0,1]
    v_cvt_pk_bf16_f32 v17, v74, v75
    v_lshlrev_b32 v74, 16, v17
    v_and_b32 v75, 0xffff0000, v17
    v_pk_mul_f32 v[74:75], v[74:75], v[6:7]
    v_cvt_pk_bf16_f32 v17, v74, v75
    v_pk_add_f32 v[76:77], v[76:77], v[4:5] neg_lo:[0,1] neg_hi:[0,1]
    v_cvt_pk_bf16_f32 v18, v76, v77
    v_lshlrev_b32 v76, 16, v18
    v_and_b32 v77, 0xffff0000, v18
    v_pk_mul_f32 v[76:77], v[76:77], v[6:7]
    v_cvt_pk_bf16_f32 v18, v76, v77
    v_pk_add_f32 v[78:79], v[78:79], v[4:5] neg_lo:[0,1] neg_hi:[0,1]
    v_cvt_pk_bf16_f32 v19, v78, v79
    v_lshlrev_b32 v78, 16, v19
    v_and_b32 v79, 0xffff0000, v19
    v_pk_mul_f32 v[78:79], v[78:79], v[6:7]
    v_cvt_pk_bf16_f32 v19, v78, v79
    s_add_u32 s29, s29, 4096
    buffer_store_dwordx4 v[16:19], v2, s[4:7], s29 offen offset:0 sc1
    v_pk_add_f32 v[80:81], v[80:81], v[4:5] neg_lo:[0,1] neg_hi:[0,1]
    v_cvt_pk_bf16_f32 v20, v80, v81
    v_lshlrev_b32 v80, 16, v20
    v_and_b32 v81, 0xffff0000, v20
    v_pk_mul_f32 v[80:81], v[80:81], v[6:7]
    v_cvt_pk_bf16_f32 v20, v80, v81
    v_pk_add_f32 v[82:83], v[82:83], v[4:5] neg_lo:[0,1] neg_hi:[0,1]
    v_cvt_pk_bf16_f32 v21, v82, v83
    v_lshlrev_b32 v82, 16, v21
    v_and_b32 v83, 0xffff0000, v21
    v_pk_mul_f32 v[82:83], v[82:83], v[6:7]
    v_cvt_pk_bf16_f32 v21, v82, v83
    v_pk_add_f32 v[84:85], v[84:85], v[4:5] neg_lo:[0,1] neg_hi:[0,1]
    v_cvt_pk_bf16_f32 v22, v84, v85
    v_lshlrev_b32 v84, 16, v22
    v_and_b32 v85, 0xffff0000, v22
    v_pk_mul_f32 v[84:85], v[84:85], v[6:7]
    v_cvt_pk_bf16_f32 v22, v84, v85
    v_pk_add_f32 v[86:87], v[86:87], v[4:5] neg_lo:[0,1] neg_hi:[0,1]
    v_cvt_pk_bf16_f32 v23, v86, v87
    v_lshlrev_b32 v86, 16, v23
    v_and_b32 v87, 0xffff0000, v23
    v_pk_mul_f32 v[86:87], v[86:87], v[6:7]
    v_cvt_pk_bf16_f32 v23, v86, v87
    buffer_store_dwordx4 v[20:23], v2, s[4:7], s29 offen offset:2048 sc1
    v_pk_add_f32 v[88:89], v[88:89], v[4:5] neg_lo:[0,1] neg_hi:[0,1]
    v_cvt_pk_bf16_f32 v24, v88, v89
    v_lshlrev_b32 v88, 16, v24
    v_and_b32 v89, 0xffff0000, v24
    v_pk_mul_f32 v[88:89], v[88:89], v[6:7]
    v_cvt_pk_bf16_f32 v24, v88, v89
    v_pk_add_f32 v[90:91], v[90:91], v[4:5] neg_lo:[0,1] neg_hi:[0,1]
    v_cvt_pk_bf16_f32 v25, v90, v91
    v_lshlrev_b32 v90, 16, v25
    v_and_b32 v91, 0xffff0000, v25
    v_pk_mul_f32 v[90:91], v[90:91], v[6:7]
    v_cvt_pk_bf16_f32 v25, v90, v91
    v_pk_add_f32 v[92:93], v[92:93], v[4:5] neg_lo:[0,1] neg_hi:[0,1]
    v_cvt_pk_bf16_f32 v26, v92, v93
    v_lshlrev_b32 v92, 16, v26
    v_and_b32 v93, 0xffff0000, v26
    v_pk_mul_f32 v[92:93], v[92:93], v[6:7]
    v_cvt_pk_bf16_f32 v26, v92, v93
    v_pk_add_f32 v[94:95], v[94:95], v[4:5] neg_lo:[0,1] neg_hi:[0,1]
    v_cvt_pk_bf16_f32 v27, v94, v95
    v_lshlrev_b32 v94, 16, v27
    v_and_b32 v95, 0xffff0000, v27
    v_pk_mul_f32 v[94:95], v[94:95], v[6:7]
    v_cvt_pk_bf16_f32 v27, v94, v95
    s_add_u32 s29, s29, 4096
    buffer_store_dwordx4 v[24:27], v2, s[4:7], s29 offen offset:0 sc1
    v_pk_add_f32 v[96:97], v[96:97], v[4:5] neg_lo:[0,1] neg_hi:[0,1]
    v_cvt_pk_bf16_f32 v28, v96, v97
    v_lshlrev_b32 v96, 16, v28
    v_and_b32 v97, 0xffff0000, v28
    v_pk_mul_f32 v[96:97], v[96:97], v[6:7]
    v_cvt_pk_bf16_f32 v28, v96, v97
    v_pk_add_f32 v[98:99], v[98:99], v[4:5] neg_lo:[0,1] neg_hi:[0,1]
    v_cvt_pk_bf16_f32 v29, v98, v99
    v_lshlrev_b32 v98, 16, v29
    v_and_b32 v99, 0xffff0000, v29
    v_pk_mul_f32 v[98:99], v[98:99], v[6:7]
    v_cvt_pk_bf16_f32 v29, v98, v99
    v_pk_add_f32 v[100:101], v[100:101], v[4:5] neg_lo:[0,1] neg_hi:[0,1]
    v_cvt_pk_bf16_f32 v30, v100, v101
    v_lshlrev_b32 v100, 16, v30
    v_and_b32 v101, 0xffff0000, v30
    v_pk_mul_f32 v[100:101], v[100:101], v[6:7]
    v_cvt_pk_bf16_f32 v30, v100, v101
    v_pk_add_f32 v[102:103], v[102:103], v[4:5] neg_lo:[0,1] neg_hi:[0,1]
    v_cvt_pk_bf16_f32 v31, v102, v103
    v_lshlrev_b32 v102, 16, v31
    v_and_b32 v103, 0xffff0000, v31
    v_pk_mul_f32 v[102:103], v[102:103], v[6:7]
    v_cvt_pk_bf16_f32 v31, v102, v103
    buffer_store_dwordx4 v[28:31], v2, s[4:7], s29 offen offset:2048 sc1
    v_pk_add_f32 v[104:105], v[104:105], v[4:5] neg_lo:[0,1] neg_hi:[0,1]
    v_cvt_pk_bf16_f32 v32, v104, v105
    v_lshlrev_b32 v104, 16, v32
    v_and_b32 v105, 0xffff0000, v32
    v_pk_mul_f32 v[104:105], v[104:105], v[6:7]
    v_cvt_pk_bf16_f32 v32, v104, v105
    v_pk_add_f32 v[106:107], v[106:107], v[4:5] neg_lo:[0,1] neg_hi:[0,1]
    v_cvt_pk_bf16_f32 v33, v106, v107
    v_lshlrev_b32 v106, 16, v33
    v_and_b32 v107, 0xffff0000, v33
    v_pk_mul_f32 v[106:107], v[106:107], v[6:7]
    v_cvt_pk_bf16_f32 v33, v106, v107
    v_pk_add_f32 v[108:109], v[108:109], v[4:5] neg_lo:[0,1] neg_hi:[0,1]
    v_cvt_pk_bf16_f32 v34, v108, v109
    v_lshlrev_b32 v108, 16, v34
    v_and_b32 v109, 0xffff0000, v34
    v_pk_mul_f32 v[108:109], v[108:109], v[6:7]
    v_cvt_pk_bf16_f32 v34, v108, v109
    v_pk_add_f32 v[110:111], v[110:111], v[4:5] neg_lo:[0,1] neg_hi:[0,1]
    v_cvt_pk_bf16_f32 v35, v110, v111
    v_lshlrev_b32 v110, 16, v35
    v_and_b32 v111, 0xffff0000, v35
    v_pk_mul_f32 v[110:111], v[110:111], v[6:7]
    v_cvt_pk_bf16_f32 v35, v110, v111
    s_add_u32 s29, s29, 4096
    buffer_store_dwordx4 v[32:35], v2, s[4:7], s29 offen offset:0 sc1
    v_pk_add_f32 v[112:113], v[112:113], v[4:5] neg_lo:[0,1] neg_hi:[0,1]
    v_cvt_pk_bf16_f32 v36, v112, v113
    v_lshlrev_b32 v112, 16, v36
    v_and_b32 v113, 0xffff0000, v36
    v_pk_mul_f32 v[112:113], v[112:113], v[6:7]
    v_cvt_pk_bf16_f32 v36, v112, v113
    v_pk_add_f32 v[114:115], v[114:115], v[4:5] neg_lo:[0,1] neg_hi:[0,1]
    v_cvt_pk_bf16_f32 v37, v114, v115
    v_lshlrev_b32 v114, 16, v37
    v_and_b32 v115, 0xffff0000, v37
    v_pk_mul_f32 v[114:115], v[114:115], v[6:7]
    v_cvt_pk_bf16_f32 v37, v114, v115
    v_pk_add_f32 v[116:117], v[116:117], v[4:5] neg_lo:[0,1] neg_hi:[0,1]
    v_cvt_pk_bf16_f32 v38, v116, v117
    v_lshlrev_b32 v116, 16, v38
    v_and_b32 v117, 0xffff0000, v38
    v_pk_mul_f32 v[116:117], v[116:117], v[6:7]
    v_cvt_pk_bf16_f32 v38, v116, v117
    v_pk_add_f32 v[118:119], v[118:119], v[4:5] neg_lo:[0,1] neg_hi:[0,1]
    v_cvt_pk_bf16_f32 v39, v118, v119
    v_lshlrev_b32 v118, 16, v39
    v_and_b32 v119, 0xffff0000, v39
    v_pk_mul_f32 v[118:119], v[118:119], v[6:7]
    v_cvt_pk_bf16_f32 v39, v118, v119
    buffer_store_dwordx4 v[36:39], v2, s[4:7], s29 offen offset:2048 sc1
    v_pk_add_f32 v[120:121], v[120:121], v[4:5] neg_lo:[0,1] neg_hi:[0,1]
    v_cvt_pk_bf16_f32 v40, v120, v121
    v_lshlrev_b32 v120, 16, v40
    v_and_b32 v121, 0xffff0000, v40
    v_pk_mul_f32 v[120:121], v[120:121], v[6:7]
    v_cvt_pk_bf16_f32 v40, v120, v121
    v_pk_add_f32 v[122:123], v[122:123], v[4:5] neg_lo:[0,1] neg_hi:[0,1]
    v_cvt_pk_bf16_f32 v41, v122, v123
    v_lshlrev_b32 v122, 16, v41
    v_and_b32 v123, 0xffff0000, v41
    v_pk_mul_f32 v[122:123], v[122:123], v[6:7]
    v_cvt_pk_bf16_f32 v41, v122, v123
    v_pk_add_f32 v[124:125], v[124:125], v[4:5] neg_lo:[0,1] neg_hi:[0,1]
    v_cvt_pk_bf16_f32 v42, v124, v125
    v_lshlrev_b32 v124, 16, v42
    v_and_b32 v125, 0xffff0000, v42
    v_pk_mul_f32 v[124:125], v[124:125], v[6:7]
    v_cvt_pk_bf16_f32 v42, v124, v125
    v_pk_add_f32 v[126:127], v[126:127], v[4:5] neg_lo:[0,1] neg_hi:[0,1]
    v_cvt_pk_bf16_f32 v43, v126, v127
    v_lshlrev_b32 v126, 16, v43
    v_and_b32 v127, 0xffff0000, v43
    v_pk_mul_f32 v[126:127], v[126:127], v[6:7]
    v_cvt_pk_bf16_f32 v43, v126, v127
    s_add_u32 s29, s29, 4096
    buffer_store_dwordx4 v[40:43], v2, s[4:7], s29 offen offset:0 sc1
    v_pk_add_f32 v[128:129], v[128:129], v[4:5] neg_lo:[0,1] neg_hi:[0,1]
    v_cvt_pk_bf16_f32 v44, v128, v129
    v_lshlrev_b32 v128, 16, v44
    v_and_b32 v129, 0xffff0000, v44
    v_pk_mul_f32 v[128:129], v[128:129], v[6:7]
    v_cvt_pk_bf16_f32 v44, v128, v129
    v_pk_add_f32 v[130:131], v[130:131], v[4:5] neg_lo:[0,1] neg_hi:[0,1]
    v_cvt_pk_bf16_f32 v45, v130, v131
    v_lshlrev_b32 v130, 16, v45
    v_and_b32 v131, 0xffff0000, v45
    v_pk_mul_f32 v[130:131], v[130:131], v[6:7]
    v_cvt_pk_bf16_f32 v45, v130, v131
    v_pk_add_f32 v[132:133], v[132:133], v[4:5] neg_lo:[0,1] neg_hi:[0,1]
    v_cvt_pk_bf16_f32 v46, v132, v133
    v_lshlrev_b32 v132, 16, v46
    v_and_b32 v133, 0xffff0000, v46
    v_pk_mul_f32 v[132:133], v[132:133], v[6:7]
    v_cvt_pk_bf16_f32 v46, v132, v133
    v_pk_add_f32 v[134:135], v[134:135], v[4:5] neg_lo:[0,1] neg_hi:[0,1]
    v_cvt_pk_bf16_f32 v47, v134, v135
    v_lshlrev_b32 v134, 16, v47
    v_and_b32 v135, 0xffff0000, v47
    v_pk_mul_f32 v[134:135], v[134:135], v[6:7]
    v_cvt_pk_bf16_f32 v47, v134, v135
    buffer_store_dwordx4 v[44:47], v2, s[4:7], s29 offen offset:2048 sc1
    s_waitcnt vmcnt(0)
    s_lshr_b32 s28, s25, 5
    s_lshl_b32 s28, s28, 15
    s_and_b32 s29, s25, 31
    s_lshl_b32 s29, s29, 8
    s_add_u32 s28, s28, s29
    s_add_u32 s28, s28, 65536
    v_and_b32 v8, 0x38, v1
    v_lshlrev_b32 v8, 2, v8
    v_and_b32 v2, 1, v1
    v_lshl_add_u32 v8, v2, 4, v8
    v_cmp_eq_u32 s[98:99], 0, v2
    v_and_b32 v2, 6, v1
    v_lshl_add_u32 v8, v2, 1, v8
    v_add_u32 v8, s28, v8
    s_lshl_b32 s28, s24, 13
    s_add_u32 s28, s28, s33
    s_add_u32 s28, s28, 131072
    v_mov_b32 v2, -1
    buffer_store_dword v2, v8, s[4:7], s28 offen sc1
    s_add_u32 s28, s28, 131072
    v_mov_b32 v2, -1
    buffer_store_dword v2, v8, s[4:7], s28 offen sc1
    v_xor_b32 v0, 0, v0
    v_or_b32 v0, s25, v0
    v_min_u32 v0, 1, v0
    v_lshlrev_b32 v0, 30, v0
    v_mov_b32 v4, 0
    s_add_u32 s28, s33, 104576
    buffer_store_dword v4, v0, s[4:7], s28 offen sc1
    s_add_u32 s28, s33, 112768
    buffer_store_dword v4, v0, s[4:7], s28 offen sc1
    s_add_u32 s28, s33, 120960
    buffer_store_dword v4, v0, s[4:7], s28 offen sc1
    s_add_u32 s28, s33, 129152
    buffer_store_dword v4, v0, s[4:7], s28 offen sc1
    s_waitcnt vmcnt(0)
    s_barrier
    s_cmp_lg_u32 s24, 0
    s_cbranch_scc1 Larr_19
    s_and_b32 s28, s2, 1
    s_lshl_b32 s28, s28, 6
    v_mov_b32 v4, 1
    s_mov_b64 exec, 1
    buffer_atomic_add v4, off, s[16:19], s28 sc1
    s_mov_b64 exec, -1
Larr_19:
    s_cmp_lg_u32 s24, 0
    s_cbranch_scc1 LC_pull
    v_lshlrev_b32 v6, 4, v1
    v_bfe_u32 v7, v1, 1, 1
    v_mul_u32_u24 v7, 0xaaaa, v7
    v_add_u32 v7, 0x4444, v7
    v_mov_b32 v2, v1
    v_bfe_u32 v3, v2, 2, 2
    v_lshlrev_b32 v3, 1, v3
    v_and_or_b32 v3, v2, 1, v3
    v_bfe_u32 v4, v2, 1, 1
    v_lshrrev_b32 v2, 4, v2
    v_lshl_add_u32 v4, v2, 1, v4
    v_lshlrev_b32 v10, 4, v3
    v_lshl_add_u32 v10, v2, 8, v10
    v_and_b32 v2, 2, v1
    v_lshl_add_u32 v10, v2, 2, v10
    v_add_u32 v10, 100352, v10
    s_cmp_ge_u32 s25, 20
    s_cselect_b32 s28, 20, 0
    s_sub_u32 s28, s25, s28
    s_mul_i32 s28, s28, 52
    s_lshr_b32 s28, s28, 8
    s_lshl_b32 s28, s28, 7
    s_add_u32 s28, s28, 163610624
    v_and_b32 v9, 31, v1
    v_lshlrev_b32 v9, 9, v9
    v_add_u32 v9, s28, v9
    s_lshl_b32 s64, s25, 15
    s_add_u32 s64, s64, 60817408
    s_lshl_b32 s70, s25, 14
    s_mov_b32 s32, 0
    buffer_load_dwordx2 v[2:3], off, s[16:19], 0 offset:128 sc1
    s_waitcnt vmcnt(0)
Lws_20:
    v_readfirstlane_b32 s28, v2
    v_readfirstlane_b32 s34, v3
    s_nop 0
    s_min_u32 s28, s28, s34
    s_cmp_eq_u32 s28, 0
    s_cbranch_scc1 Lretry_21
    s_and_b32 s62, s34, 24576
    s_xor_b32 s63, s62, 16384
    s_add_u32 s62, s62, s33
    s_add_u32 s63, s63, s33
    s_and_b32 s34, s34, 8192
    s_add_u32 s33, s33, s34
    s_add_u32 s35, s62, 104448
    s_add_u32 s75, s63, 104576
    s_mov_b32 s26, 0
    s_mov_b32 s72, 0
    s_mov_b32 s73, 18
    s_mov_b32 s74, s73
    v_mov_b32 v11, 0
.p2align 6
LC_top:
    s_add_u32 s30, s26, 1
    s_mov_b32 s32, 0
Lcf_22:
    v_cmp_gt_u32 vcc, s30, v11
    s_cbranch_vccnz Lcf1_23
    s_add_u32 s28, s64, 0
    buffer_load_dwordx4 a[0:3], v6, s[4:7], s28 offen offset:0 sc1
    buffer_load_dwordx4 a[4:7], v6, s[4:7], s28 offen offset:1024 sc1
    buffer_load_dwordx4 a[8:11], v6, s[4:7], s28 offen offset:2048 sc1
    buffer_load_dwordx4 a[12:15], v6, s[4:7], s28 offen offset:3072 sc1
    s_add_u32 s28, s64, 4096
    buffer_load_dwordx4 a[16:19], v6, s[4:7], s28 offen offset:0 sc1
    buffer_load_dwordx4 a[20:23], v6, s[4:7], s28 offen offset:1024 sc1
    buffer_load_dwordx4 a[24:27], v6, s[4:7], s28 offen offset:2048 sc1
    buffer_load_dwordx4 a[28:31], v6, s[4:7], s28 offen offset:3072 sc1
    s_add_u32 s28, s64, 8192
    buffer_load_dwordx4 a[32:35], v6, s[4:7], s28 offen offset:0 sc1
    buffer_load_dwordx4 a[36:39], v6, s[4:7], s28 offen offset:1024 sc1
    buffer_load_dwordx4 a[40:43], v6, s[4:7], s28 offen offset:2048 sc1
    buffer_load_dwordx4 a[44:47], v6, s[4:7], s28 offen offset:3072 sc1
    s_add_u32 s28, s64, 12288
    buffer_load_dwordx4 a[48:51], v6, s[4:7], s28 offen offset:0 sc1
    buffer_load_dwordx4 a[52:55], v6, s[4:7], s28 offen offset:1024 sc1
    buffer_load_dwordx4 a[56:59], v6, s[4:7], s28 offen offset:2048 sc1
    buffer_load_dwordx4 a[60:63], v6, s[4:7], s28 offen offset:3072 sc1
    s_add_u32 s28, s64, 16384
    buffer_load_dwordx4 a[64:67], v6, s[4:7], s28 offen offset:0 sc1
    buffer_load_dwordx4 a[68:71], v6, s[4:7], s28 offen offset:1024 sc1
    buffer_load_dwordx4 a[72:75], v6, s[4:7], s28 offen offset:2048 sc1
    buffer_load_dwordx4 a[76:79], v6, s[4:7], s28 offen offset:3072 sc1
    s_add_u32 s28, s64, 20480
    buffer_load_dwordx4 a[80:83], v6, s[4:7], s28 offen offset:0 sc1
    buffer_load_dwordx4 a[84:87], v6, s[4:7], s28 offen offset:1024 sc1
    buffer_load_dwordx4 a[88:91], v6, s[4:7], s28 offen offset:2048 sc1
    buffer_load_dwordx4 a[92:95], v6, s[4:7], s28 offen offset:3072 sc1
    s_add_u32 s28, s64, 24576
    buffer_load_dwordx4 a[96:99], v6, s[4:7], s28 offen offset:0 sc1
    buffer_load_dwordx4 a[100:103], v6, s[4:7], s28 offen offset:1024 sc1
    buffer_load_dwordx4 a[104:107], v6, s[4:7], s28 offen offset:2048 sc1
    buffer_load_dwordx4 a[108:111], v6, s[4:7], s28 offen offset:3072 sc1
    s_add_u32 s28, s64, 28672
    buffer_load_dwordx4 a[112:115], v6, s[4:7], s28 offen offset:0 sc1
    buffer_load_dwordx4 a[116:119], v6, s[4:7], s28 offen offset:1024 sc1
    buffer_load_dwordx4 a[120:123], v6, s[4:7], s28 offen offset:2048 sc1
    buffer_load_dwordx4 a[124:127], v6, s[4:7], s28 offen offset:3072 sc1
    v_cmp_ge_u32 vcc, s30, v11
    s_cbranch_vccz Lff_24
    buffer_load_dword v11, v9, s[4:7], 0 offen sc1
Lff_24:
    v_mov_b64 v[124:125], 0
    v_mov_b64 v[126:127], 0
    v_mov_b32 v5, s30
    s_and_b32 s68, s26, 3
    s_lshl_b32 s68, s68, 17
    s_add_u32 s68, s68, s62
    s_add_u32 s69, s68, 4096
    s_add_u32 s67, s68, 32768
    s_add_u32 s71, s68, 36864
    s_add_u32 s66, s26, 1
    s_and_b32 s66, s66, 3
    s_lshl_b32 s66, s66, 17
    s_add_u32 s66, s66, s63
    s_add_u32 s65, s26, 2
    s_bfe_u32 s29, s65, 0x10001
    s_lshl_b32 s29, s29, 13
    s_lshl_b32 s65, s65, 20
    s_sub_u32 s65, s65, s34
    s_add_u32 s65, s65, s33
    s_xor_b32 s29, s29, s34
    s_add_u32 s65, s65, s29
    s_add_u32 s65, s65, s70
    s_add_u32 s31, s65, 4096
    s_mov_b32 s32, 0
    s_waitcnt vmcnt(24)
Lhw_25:
    buffer_load_dword v2, off, s[4:7], s35 sc1
    s_waitcnt vmcnt(0)
    v_cmp_gt_u32 vcc, s30, v2
    s_cbranch_vccnz Lretry_26
Lad_27:
    s_sub_u32 s74, s74, 8
    s_cbranch_scc0 Lad_27
    s_mov_b32 s32, 0
    buffer_load_dwordx4 v[12:15], v6, s[4:7], s65 offen offset:0 sc1
    buffer_load_dwordx4 v[16:19], v6, s[4:7], s65 offen offset:1024 sc1
    buffer_load_dwordx4 v[20:23], v6, s[4:7], s65 offen offset:2048 sc1
    buffer_load_dwordx4 v[24:27], v6, s[4:7], s65 offen offset:3072 sc1
    buffer_load_dwordx4 v[28:31], v6, s[4:7], s31 offen offset:0 sc1
    buffer_load_dwordx4 v[32:35], v6, s[4:7], s31 offen offset:1024 sc1
    buffer_load_dwordx4 v[36:39], v6, s[4:7], s31 offen offset:2048 sc1
    buffer_load_dwordx4 v[40:43], v6, s[4:7], s31 offen offset:3072 sc1
    s_nop 15
    s_nop 15
    s_nop 15
    buffer_load_dwordx4 v[44:47], v6, s[4:7], s68 offen offset:0 sc1
    buffer_load_dwordx4 v[48:51], v6, s[4:7], s67 offen offset:0 sc1
    buffer_load_dwordx4 v[52:55], v6, s[4:7], s68 offen offset:1024 sc1
    buffer_load_dwordx4 v[56:59], v6, s[4:7], s67 offen offset:1024 sc1
    buffer_load_dwordx4 v[60:63], v6, s[4:7], s68 offen offset:2048 sc1
    buffer_load_dwordx4 v[64:67], v6, s[4:7], s67 offen offset:2048 sc1
    buffer_load_dwordx4 v[68:71], v6, s[4:7], s68 offen offset:3072 sc1
    buffer_load_dwordx4 v[72:75], v6, s[4:7], s67 offen offset:3072 sc1
    buffer_load_dwordx4 v[76:79], v6, s[4:7], s69 offen offset:0 sc1
    buffer_load_dwordx4 v[80:83], v6, s[4:7], s71 offen offset:0 sc1
    buffer_load_dwordx4 v[84:87], v6, s[4:7], s69 offen offset:1024 sc1
    buffer_load_dwordx4 v[88:91], v6, s[4:7], s71 offen offset:1024 sc1
    buffer_load_dwordx4 v[92:95], v6, s[4:7], s69 offen offset:2048 sc1
    buffer_load_dwordx4 v[96:99], v6, s[4:7], s71 offen offset:2048 sc1
    buffer_load_dwordx4 v[100:103], v6, s[4:7], s69 offen offset:3072 sc1
    buffer_load_dwordx4 v[104:107], v6, s[4:7], s71 offen offset:3072 sc1
    buffer_load_dwordx2 v[108:109], v10, s[4:7], s68 offen offset:0 sc1
    buffer_load_dwordx2 v[110:111], v10, s[4:7], s68 offen offset:128 sc1
    buffer_load_dwordx2 v[112:113], v10, s[4:7], s68 offen offset:1024 sc1
    buffer_load_dwordx2 v[114:115], v10, s[4:7], s68 offen offset:1152 sc1
    buffer_load_dwordx2 v[116:117], v10, s[4:7], s68 offen offset:2048 sc1
    buffer_load_dwordx2 v[118:119], v10, s[4:7], s68 offen offset:2176 sc1
    buffer_load_dwordx2 v[120:121], v10, s[4:7], s68 offen offset:3072 sc1
    buffer_load_dwordx2 v[122:123], v10, s[4:7], s68 offen offset:3200 sc1
LC_pc:
    v_mov_b32 v2, 0
    s_waitcnt vmcnt(24)
    v_max3_u32 v2, v2, v12, v14
    v_max3_u32 v2, v2, v16, v18
    v_max3_u32 v2, v2, v20, v22
    v_max3_u32 v2, v2, v24, v26
    v_max3_u32 v2, v2, v28, v30
    v_max3_u32 v2, v2, v32, v34
    v_max3_u32 v2, v2, v36, v38
    v_max3_u32 v2, v2, v40, v42
    s_waitcnt vmcnt(23)
    v_smfmac_f32_16x16x64_bf16 v[124:127], v[44:47], a[0:7], v7
    s_waitcnt vmcnt(22)
    v_max3_u32 v2, v2, v44, v46
    v_smfmac_f32_16x16x64_bf16 v[124:127], v[48:51], a[64:71], v7
    s_waitcnt vmcnt(21)
    v_max3_u32 v2, v2, v48, v50
    v_smfmac_f32_16x16x64_bf16 v[124:127], v[52:55], a[8:15], v7
    s_waitcnt vmcnt(20)
    v_max3_u32 v2, v2, v52, v54
    v_smfmac_f32_16x16x64_bf16 v[124:127], v[56:59], a[72:79], v7
    s_waitcnt vmcnt(19)
    v_max3_u32 v2, v2, v56, v58
    v_smfmac_f32_16x16x64_bf16 v[124:127], v[60:63], a[16:23], v7
    s_waitcnt vmcnt(18)
    v_max3_u32 v2, v2, v60, v62
    v_cmp_eq_u32 vcc, -1, v2
    v_smfmac_f32_16x16x64_bf16 v[124:127], v[64:67], a[80:87], v7
    s_waitcnt vmcnt(17)
    s_cbranch_vccnz Lretry_28
    v_max3_u32 v2, v2, v64, v66
    v_smfmac_f32_16x16x64_bf16 v[124:127], v[68:71], a[24:31], v7
    buffer_store_dword v5, v0, s[4:7], s75 offen sc1
    s_waitcnt vmcnt(17)
    v_max3_u32 v2, v2, v68, v70
    v_smfmac_f32_16x16x64_bf16 v[124:127], v[72:75], a[88:95], v7
    s_waitcnt vmcnt(16)
    v_max3_u32 v2, v2, v72, v74
    v_smfmac_f32_16x16x64_bf16 v[124:127], v[76:79], a[32:39], v7
    s_waitcnt vmcnt(15)
    v_max3_u32 v2, v2, v76, v78
    v_smfmac_f32_16x16x64_bf16 v[124:127], v[80:83], a[96:103], v7
    s_waitcnt vmcnt(14)
    v_max3_u32 v2, v2, v80, v82
    v_smfmac_f32_16x16x64_bf16 v[124:127], v[84:87], a[40:47], v7
    s_waitcnt vmcnt(13)
    v_max3_u32 v2, v2, v84, v86
    v_smfmac_f32_16x16x64_bf16 v[124:127], v[88:91], a[104:111], v7
    s_waitcnt vmcnt(12)
    v_max3_u32 v2, v2, v88, v90
    v_smfmac_f32_16x16x64_bf16 v[124:127], v[92:95], a[48:55], v7
    s_waitcnt vmcnt(11)
    v_max3_u32 v2, v2, v92, v94
    v_smfmac_f32_16x16x64_bf16 v[124:127], v[96:99], a[112:119], v7
    s_waitcnt vmcnt(10)
    v_max3_u32 v2, v2, v96, v98
    v_smfmac_f32_16x16x64_bf16 v[124:127], v[100:103], a[56:63], v7
    s_waitcnt vmcnt(9)
    v_max3_u32 v2, v2, v100, v102
    v_smfmac_f32_16x16x64_bf16 v[124:127], v[104:107], a[120:127], v7
    s_waitcnt vmcnt(7)
    v_max3_u32 v2, v2, v104, v106
    v_smfmac_f32_16x16x64_bf16 v[124:127], v[108:111], v[12:19], v7
    s_waitcnt vmcnt(5)
    v_max3_u32 v2, v2, v108, v110
    v_smfmac_f32_16x16x64_bf16 v[124:127], v[112:115], v[20:27], v7
    s_waitcnt vmcnt(3)
    v_max3_u32 v2, v2, v112, v114
    v_smfmac_f32_16x16x64_bf16 v[124:127], v[116:119], v[28:35], v7
    s_waitcnt vmcnt(1)
    v_max3_u32 v2, v2, v116, v118
    v_smfmac_f32_16x16x64_bf16 v[124:127], v[120:123], v[36:43], v7
    v_max3_u32 v2, v2, v120, v122
    v_max3_u32 v2, v2, v109, v111
    v_max3_u32 v2, v2, v113, v115
    v_max3_u32 v2, v2, v117, v119
    v_max3_u32 v2, v2, v121, v123
    v_cmp_eq_u32 vcc, -1, v2
    s_cbranch_vccnz Lretry_28
    s_nop 0
    v_add_f32 v124, v124, v126
    v_add_f32 v125, v125, v127
    s_nop 0
    v_mov_b32_dpp v128, v124 quad_perm:[1,0,3,2] row_mask:0xf bank_mask:0xf
    v_mov_b32_dpp v129, v125 quad_perm:[1,0,3,2] row_mask:0xf bank_mask:0xf
    v_cvt_pk_bf16_f32 v128, v124, v128
    v_cvt_pk_bf16_f32 v129, v129, v125
    v_cndmask_b32 v128, v129, v128, s[98:99]
    v_min_u32 v128, -2, v128
    buffer_store_dword v128, v8, s[4:7], s66 offen sc1
    s_add_u32 s66, s26, 3
    s_and_b32 s66, s66, 3
    s_lshl_b32 s66, s66, 17
    s_add_u32 s66, s66, s63
    v_mov_b32 v2, -1
    buffer_store_dword v2, v8, s[4:7], s66 offen sc1
    s_min_u32 s29, s32, 1
    s_lshl_b32 s72, s72, 1
    s_or_b32 s72, s72, s29
    s_and_b32 s72, s72, 7
    s_mul_i32 s29, s29, s72
    s_cmp_gt_u32 s29, 1
    s_cselect_b32 s28, 12, -1
    s_add_i32 s73, s73, s28
    s_max_i32 s73, s73, 18
    s_min_i32 s73, s73, 160
    s_mov_b32 s74, s73
    s_add_u32 s64, s64, 1310720
    s_add_u32 s26, s26, 1
    s_cmp_lt_u32 s26, 63
    s_cbranch_scc1 LC_top
    s_endpgm
LC_pull:
    s_endpgm
Lretry_21:
    s_sleep 6
    buffer_load_dwordx2 v[2:3], off, s[16:19], 0 offset:128 sc1
    s_waitcnt vmcnt(0)
    s_add_u32 s32, s32, 1
    s_cmp_lt_u32 s32, 200000
    s_cbranch_scc1 Lws_20
    v_mov_b32 v2, 1
    v_mov_b32 v3, 4
    buffer_store_dword v2, v3, s[16:19], 0 offen sc1
    s_endpgm
Lcf1_23:
    s_cmp_eq_u32 s32, 0
    s_cbranch_scc1 Lcf1_23s
    s_sleep 6
Lcf1_23s:
    buffer_load_dword v11, v9, s[4:7], 0 offen sc1
    s_waitcnt vmcnt(0)
    s_add_u32 s32, s32, 1
    s_cmp_lt_u32 s32, 200000
    s_cbranch_scc1 Lcf_22
    v_mov_b32 v2, 20
    v_mov_b32 v3, 4
    buffer_store_dword v2, v3, s[16:19], 0 offen sc1
    s_endpgm
Lretry_26:
    s_add_u32 s32, s32, 1
    s_cmp_lt_u32 s32, 200000
    s_cbranch_scc1 Lhw_25
    v_mov_b32 v2, 23
    v_mov_b32 v3, 4
    buffer_store_dword v2, v3, s[16:19], 0 offen sc1
    s_endpgm
Lretry_28:
    buffer_load_dwordx4 v[12:15], v6, s[4:7], s65 offen offset:0 sc1
    buffer_load_dwordx4 v[16:19], v6, s[4:7], s65 offen offset:1024 sc1
    buffer_load_dwordx4 v[20:23], v6, s[4:7], s65 offen offset:2048 sc1
    buffer_load_dwordx4 v[24:27], v6, s[4:7], s65 offen offset:3072 sc1
    buffer_load_dwordx4 v[28:31], v6, s[4:7], s31 offen offset:0 sc1
    buffer_load_dwordx4 v[32:35], v6, s[4:7], s31 offen offset:1024 sc1
    buffer_load_dwordx4 v[36:39], v6, s[4:7], s31 offen offset:2048 sc1
    buffer_load_dwordx4 v[40:43], v6, s[4:7], s31 offen offset:3072 sc1
    buffer_load_dwordx4 v[44:47], v6, s[4:7], s68 offen offset:0 sc1
    buffer_load_dwordx4 v[48:51], v6, s[4:7], s67 offen offset:0 sc1
    buffer_load_dwordx4 v[52:55], v6, s[4:7], s68 offen offset:1024 sc1
    buffer_load_dwordx4 v[56:59], v6, s[4:7], s67 offen offset:1024 sc1
    buffer_load_dwordx4 v[60:63], v6, s[4:7], s68 offen offset:2048 sc1
    buffer_load_dwordx4 v[64:67], v6, s[4:7], s67 offen offset:2048 sc1
    buffer_load_dwordx4 v[68:71], v6, s[4:7], s68 offen offset:3072 sc1
    buffer_load_dwordx4 v[72:75], v6, s[4:7], s67 offen offset:3072 sc1
    buffer_load_dwordx4 v[76:79], v6, s[4:7], s69 offen offset:0 sc1
    buffer_load_dwordx4 v[80:83], v6, s[4:7], s71 offen offset:0 sc1
    buffer_load_dwordx4 v[84:87], v6, s[4:7], s69 offen offset:1024 sc1
    buffer_load_dwordx4 v[88:91], v6, s[4:7], s71 offen offset:1024 sc1
    buffer_load_dwordx4 v[92:95], v6, s[4:7], s69 offen offset:2048 sc1
    buffer_load_dwordx4 v[96:99], v6, s[4:7], s71 offen offset:2048 sc1
    buffer_load_dwordx4 v[100:103], v6, s[4:7], s69 offen offset:3072 sc1
    buffer_load_dwordx4 v[104:107], v6, s[4:7], s71 offen offset:3072 sc1
    buffer_load_dwordx2 v[108:109], v10, s[4:7], s68 offen offset:0 sc1
    buffer_load_dwordx2 v[110:111], v10, s[4:7], s68 offen offset:128 sc1
    buffer_load_dwordx2 v[112:113], v10, s[4:7], s68 offen offset:1024 sc1
    buffer_load_dwordx2 v[114:115], v10, s[4:7], s68 offen offset:1152 sc1
    buffer_load_dwordx2 v[116:117], v10, s[4:7], s68 offen offset:2048 sc1
    buffer_load_dwordx2 v[118:119], v10, s[4:7], s68 offen offset:2176 sc1
    buffer_load_dwordx2 v[120:121], v10, s[4:7], s68 offen offset:3072 sc1
    buffer_load_dwordx2 v[122:123], v10, s[4:7], s68 offen offset:3200 sc1
    v_mov_b64 v[124:125], 0
    v_mov_b64 v[126:127], 0
    s_add_u32 s32, s32, 1
    s_cmp_lt_u32 s32, 200000
    s_cbranch_scc1 LC_pc
    v_mov_b32 v2, 22
    v_mov_b32 v3, 4
    buffer_store_dword v2, v3, s[16:19], 0 offen sc1
    s_endpgm
E_C:
.p2align 6
W_K:
R_K:
    s_lshl_b32 s35, s25, 9
    s_lshl_b32 s28, s24, 7
    s_add_u32 s35, s35, s28
    s_add_u32 s35, s35, 163577856
    v_mov_b32 v2, 0
    s_mov_b64 exec, 1
    buffer_store_dword v2, off, s[4:7], s35 sc1
    s_mov_b64 exec, -1
    s_mov_b32 s8, s42
    s_mov_b32 s9, s43
    s_mov_b32 s10, 7864320
    s_mov_b32 s11, 0x20000
    s_and_b32 s28, s24, 1
    s_lshl_b32 s28, s28, 2
    v_lshrrev_b32 v2, 5, v1
    v_add_u32 v2, 0, v2
    v_or_b32 v3, s28, v2
    v_lshlrev_b32 v3, 1, v3
    v_and_b32 v4, 31, v1
    v_xor_b32 v4, v4, v3
    v_mul_u32_u24 v2, 12288, v2
    v_lshl_add_u32 v6, v4, 4, v2
    v_lshrrev_b32 v2, 5, v1
    v_add_u32 v2, 2, v2
    v_or_b32 v3, s28, v2
    v_lshlrev_b32 v3, 1, v3
    v_and_b32 v4, 31, v1
    v_xor_b32 v4, v4, v3
    v_mul_u32_u24 v2, 12288, v2
    v_lshl_add_u32 v7, v4, 4, v2
    v_bfe_u32 v2, v1, 2, 3
    v_lshrrev_b32 v3, 4, v1
    v_lshlrev_b32 v3, 3, v3
    v_bfe_u32 v4, v1, 2, 2
    v_add_u32 v3, v3, v4
    v_lshlrev_b32 v3, 9, v3
    v_and_b32 v4, 3, v1
    v_lshl_add_u32 v3, v4, 3, v3
    s_lshl_b32 s28, s24, 2
    s_add_u32 s28, s28, 0
    v_xor_b32 v10, s28, v2
    v_lshl_add_u32 v10, v10, 5, v3
    v_add_u32 v11, 49152, v10
    v_add_u32 v12, 98304, v10
    s_lshl_b32 s28, s24, 2
    s_add_u32 s28, s28, 1
    v_xor_b32 v13, s28, v2
    v_lshl_add_u32 v13, v13, 5, v3
    v_add_u32 v14, 49152, v13
    v_add_u32 v15, 98304, v13
    s_lshl_b32 s28, s24, 2
    s_add_u32 s28, s28, 2
    v_xor_b32 v16, s28, v2
    v_lshl_add_u32 v16, v16, 5, v3
    v_add_u32 v17, 49152, v16
    v_add_u32 v18, 98304, v16
    s_lshl_b32 s28, s24, 2
    s_add_u32 s28, s28, 3
    v_xor_b32 v19, s28, v2
    v_lshl_add_u32 v19, v19, 5, v3
    v_add_u32 v20, 49152, v19
    v_add_u32 v21, 98304, v19
    s_mul_i32 s64, s24, 98304
    s_lshl_b32 s28, s25, 9
    s_add_u32 s64, s64, s28
    s_mul_i32 s29, s24, 4096
    s_add_u32 s28, s64, 0
    s_add_u32 m0, s29, 0
    s_nop 0
    buffer_load_dwordx4 v6, s[8:11], s28 offen lds
    s_add_u32 m0, s29, 1024
    s_nop 0
    buffer_load_dwordx4 v7, s[8:11], s28 offen lds
    s_add_u32 s28, s64, 49152
    s_add_u32 m0, s29, 2048
    s_nop 0
    buffer_load_dwordx4 v6, s[8:11], s28 offen lds
    s_add_u32 m0, s29, 3072
    s_nop 0
    buffer_load_dwordx4 v7, s[8:11], s28 offen lds
    s_mul_i32 s29, s24, 4096
    s_add_u32 s28, s64, 393216
    s_add_u32 m0, s29, 24576
    s_nop 0
    buffer_load_dwordx4 v6, s[8:11], s28 offen lds
    s_add_u32 m0, s29, 25600
    s_nop 0
    buffer_load_dwordx4 v7, s[8:11], s28 offen lds
    s_add_u32 s28, s64, 442368
    s_add_u32 m0, s29, 26624
    s_nop 0
    buffer_load_dwordx4 v6, s[8:11], s28 offen lds
    s_add_u32 m0, s29, 27648
    s_nop 0
    buffer_load_dwordx4 v7, s[8:11], s28 offen lds
    s_waitcnt vmcnt(8)
    s_barrier
    s_cmp_lg_u32 s24, 0
    s_cbranch_scc1 Larr_29
    s_and_b32 s28, s2, 1
    s_lshl_b32 s28, s28, 6
    v_mov_b32 v2, 1
    s_mov_b64 exec, 1
    buffer_atomic_add v2, off, s[16:19], s28 sc1
    s_mov_b64 exec, -1
Larr_29:
    s_mul_i32 s29, s24, 4096
    s_add_u32 s28, s64, 786432
    s_add_u32 m0, s29, 49152
    s_nop 0
    buffer_load_dwordx4 v6, s[8:11], s28 offen lds
    s_add_u32 m0, s29, 50176
    s_nop 0
    buffer_load_dwordx4 v7, s[8:11], s28 offen lds
    s_add_u32 s28, s64, 835584
    s_add_u32 m0, s29, 51200
    s_nop 0
    buffer_load_dwordx4 v6, s[8:11], s28 offen lds
    s_add_u32 m0, s29, 52224
    s_nop 0
    buffer_load_dwordx4 v7, s[8:11], s28 offen lds
    s_mul_i32 s29, s24, 4096
    s_add_u32 s28, s64, 1179648
    s_add_u32 m0, s29, 73728
    s_nop 0
    buffer_load_dwordx4 v6, s[8:11], s28 offen lds
    s_add_u32 m0, s29, 74752
    s_nop 0
    buffer_load_dwordx4 v7, s[8:11], s28 offen lds
    s_add_u32 s28, s64, 1228800
    s_add_u32 m0, s29, 75776
    s_nop 0
    buffer_load_dwordx4 v6, s[8:11], s28 offen lds
    s_add_u32 m0, s29, 76800
    s_nop 0
    buffer_load_dwordx4 v7, s[8:11], s28 offen lds
    s_mul_i32 s29, s24, 4096
    s_add_u32 s28, s64, 1572864
    s_add_u32 m0, s29, 98304
    s_nop 0
    buffer_load_dwordx4 v6, s[8:11], s28 offen lds
    s_add_u32 m0, s29, 99328
    s_nop 0
    buffer_load_dwordx4 v7, s[8:11], s28 offen lds
    s_add_u32 s28, s64, 1622016
    s_add_u32 m0, s29, 100352
    s_nop 0
    buffer_load_dwordx4 v6, s[8:11], s28 offen lds
    s_add_u32 m0, s29, 101376
    s_nop 0
    buffer_load_dwordx4 v7, s[8:11], s28 offen lds
    s_mul_i32 s29, s24, 4096
    s_add_u32 s28, s64, 1966080
    s_add_u32 m0, s29, 122880
    s_nop 0
    buffer_load_dwordx4 v6, s[8:11], s28 offen lds
    s_add_u32 m0, s29, 123904
    s_nop 0
    buffer_load_dwordx4 v7, s[8:11], s28 offen lds
    s_add_u32 s28, s64, 2015232
    s_add_u32 m0, s29, 124928
    s_nop 0
    buffer_load_dwordx4 v6, s[8:11], s28 offen lds
    s_add_u32 m0, s29, 125952
    s_nop 0
    buffer_load_dwordx4 v7, s[8:11], s28 offen lds
    s_waitcnt vmcnt(20)
    s_waitcnt lgkmcnt(0)
    s_barrier
    ds_read_b64_tr_b16 a[0:1], v10 offset:0
    ds_read_b64_tr_b16 a[2:3], v10 offset:2048
    ds_read_b64_tr_b16 a[80:81], v13 offset:0
    ds_read_b64_tr_b16 a[82:83], v13 offset:2048
    ds_read_b64_tr_b16 a[160:161], v16 offset:0
    ds_read_b64_tr_b16 a[162:163], v16 offset:2048
    ds_read_b64_tr_b16 a[240:241], v19 offset:0
    ds_read_b64_tr_b16 a[242:243], v19 offset:2048
    s_waitcnt vmcnt(16)
    s_waitcnt lgkmcnt(0)
    s_barrier
    ds_read_b64_tr_b16 a[4:5], v10 offset:24576
    ds_read_b64_tr_b16 a[6:7], v10 offset:26624
    ds_read_b64_tr_b16 a[84:85], v13 offset:24576
    ds_read_b64_tr_b16 a[86:87], v13 offset:26624
    ds_read_b64_tr_b16 a[164:165], v16 offset:24576
    ds_read_b64_tr_b16 a[166:167], v16 offset:26624
    ds_read_b64_tr_b16 a[244:245], v19 offset:24576
    ds_read_b64_tr_b16 a[246:247], v19 offset:26624
    s_mul_i32 s29, s24, 4096
    s_add_u32 s28, s64, 2359296
    s_add_u32 m0, s29, 0
    s_nop 0
    buffer_load_dwordx4 v6, s[8:11], s28 offen lds
    s_add_u32 m0, s29, 1024
    s_nop 0
    buffer_load_dwordx4 v7, s[8:11], s28 offen lds
    s_add_u32 s28, s64, 2408448
    s_add_u32 m0, s29, 2048
    s_nop 0
    buffer_load_dwordx4 v6, s[8:11], s28 offen lds
    s_add_u32 m0, s29, 3072
    s_nop 0
    buffer_load_dwordx4 v7, s[8:11], s28 offen lds
    s_waitcnt vmcnt(16)
    s_waitcnt lgkmcnt(0)
    s_barrier
    ds_read_b64_tr_b16 a[8:9], v11 offset:0
    ds_read_b64_tr_b16 a[10:11], v11 offset:2048
    ds_read_b64_tr_b16 a[88:89], v14 offset:0
    ds_read_b64_tr_b16 a[90:91], v14 offset:2048
    ds_read_b64_tr_b16 a[168:169], v17 offset:0
    ds_read_b64_tr_b16 a[170:171], v17 offset:2048
    ds_read_b64_tr_b16 a[248:249], v20 offset:0
    ds_read_b64_tr_b16 a[250:251], v20 offset:2048
    s_mul_i32 s29, s24, 4096
    s_add_u32 s28, s64, 2752512
    s_add_u32 m0, s29, 24576
    s_nop 0
    buffer_load_dwordx4 v6, s[8:11], s28 offen lds
    s_add_u32 m0, s29, 25600
    s_nop 0
    buffer_load_dwordx4 v7, s[8:11], s28 offen lds
    s_add_u32 s28, s64, 2801664
    s_add_u32 m0, s29, 26624
    s_nop 0
    buffer_load_dwordx4 v6, s[8:11], s28 offen lds
    s_add_u32 m0, s29, 27648
    s_nop 0
    buffer_load_dwordx4 v7, s[8:11], s28 offen lds
    s_waitcnt vmcnt(16)
    s_waitcnt lgkmcnt(0)
    s_barrier
    ds_read_b64_tr_b16 a[12:13], v11 offset:24576
    ds_read_b64_tr_b16 a[14:15], v11 offset:26624
    ds_read_b64_tr_b16 a[92:93], v14 offset:24576
    ds_read_b64_tr_b16 a[94:95], v14 offset:26624
    ds_read_b64_tr_b16 a[172:173], v17 offset:24576
    ds_read_b64_tr_b16 a[174:175], v17 offset:26624
    ds_read_b64_tr_b16 a[252:253], v20 offset:24576
    ds_read_b64_tr_b16 a[254:255], v20 offset:26624
    s_mul_i32 s29, s24, 4096
    s_add_u32 s28, s64, 3145728
    s_add_u32 m0, s29, 49152
    s_nop 0
    buffer_load_dwordx4 v6, s[8:11], s28 offen lds
    s_add_u32 m0, s29, 50176
    s_nop 0
    buffer_load_dwordx4 v7, s[8:11], s28 offen lds
    s_add_u32 s28, s64, 3194880
    s_add_u32 m0, s29, 51200
    s_nop 0
    buffer_load_dwordx4 v6, s[8:11], s28 offen lds
    s_add_u32 m0, s29, 52224
    s_nop 0
    buffer_load_dwordx4 v7, s[8:11], s28 offen lds
    s_waitcnt vmcnt(16)
    s_waitcnt lgkmcnt(0)
    s_barrier
    ds_read_b64_tr_b16 a[16:17], v12 offset:0
    ds_read_b64_tr_b16 a[18:19], v12 offset:2048
    ds_read_b64_tr_b16 a[96:97], v15 offset:0
    ds_read_b64_tr_b16 a[98:99], v15 offset:2048
    ds_read_b64_tr_b16 a[176:177], v18 offset:0
    ds_read_b64_tr_b16 a[178:179], v18 offset:2048
    ds_read_b64_tr_b16 v[192:193], v21 offset:0
    ds_read_b64_tr_b16 v[194:195], v21 offset:2048
    s_mul_i32 s29, s24, 4096
    s_add_u32 s28, s64, 3538944
    s_add_u32 m0, s29, 73728
    s_nop 0
    buffer_load_dwordx4 v6, s[8:11], s28 offen lds
    s_add_u32 m0, s29, 74752
    s_nop 0
    buffer_load_dwordx4 v7, s[8:11], s28 offen lds
    s_add_u32 s28, s64, 3588096
    s_add_u32 m0, s29, 75776
    s_nop 0
    buffer_load_dwordx4 v6, s[8:11], s28 offen lds
    s_add_u32 m0, s29, 76800
    s_nop 0
    buffer_load_dwordx4 v7, s[8:11], s28 offen lds
    s_waitcnt vmcnt(16)
    s_waitcnt lgkmcnt(0)
    s_barrier
    ds_read_b64_tr_b16 a[20:21], v12 offset:24576
    ds_read_b64_tr_b16 a[22:23], v12 offset:26624
    ds_read_b64_tr_b16 a[100:101], v15 offset:24576
    ds_read_b64_tr_b16 a[102:103], v15 offset:26624
    ds_read_b64_tr_b16 a[180:181], v18 offset:24576
    ds_read_b64_tr_b16 a[182:183], v18 offset:26624
    ds_read_b64_tr_b16 v[196:197], v21 offset:24576
    ds_read_b64_tr_b16 v[198:199], v21 offset:26624
    s_mul_i32 s29, s24, 4096
    s_add_u32 s28, s64, 3932160
    s_add_u32 m0, s29, 98304
    s_nop 0
    buffer_load_dwordx4 v6, s[8:11], s28 offen lds
    s_add_u32 m0, s29, 99328
    s_nop 0
    buffer_load_dwordx4 v7, s[8:11], s28 offen lds
    s_add_u32 s28, s64, 3981312
    s_add_u32 m0, s29, 100352
    s_nop 0
    buffer_load_dwordx4 v6, s[8:11], s28 offen lds
    s_add_u32 m0, s29, 101376
    s_nop 0
    buffer_load_dwordx4 v7, s[8:11], s28 offen lds
    s_waitcnt vmcnt(16)
    s_waitcnt lgkmcnt(0)
    s_barrier
    ds_read_b64_tr_b16 a[24:25], v10 offset:0
    ds_read_b64_tr_b16 a[26:27], v10 offset:2048
    ds_read_b64_tr_b16 a[104:105], v13 offset:0
    ds_read_b64_tr_b16 a[106:107], v13 offset:2048
    ds_read_b64_tr_b16 a[184:185], v16 offset:0
    ds_read_b64_tr_b16 a[186:187], v16 offset:2048
    ds_read_b64_tr_b16 v[200:201], v19 offset:0
    ds_read_b64_tr_b16 v[202:203], v19 offset:2048
    s_mul_i32 s29, s24, 4096
    s_add_u32 s28, s64, 4325376
    s_add_u32 m0, s29, 122880
    s_nop 0
    buffer_load_dwordx4 v6, s[8:11], s28 offen lds
    s_add_u32 m0, s29, 123904
    s_nop 0
    buffer_load_dwordx4 v7, s[8:11], s28 offen lds
    s_add_u32 s28, s64, 4374528
    s_add_u32 m0, s29, 124928
    s_nop 0
    buffer_load_dwordx4 v6, s[8:11], s28 offen lds
    s_add_u32 m0, s29, 125952
    s_nop 0
    buffer_load_dwordx4 v7, s[8:11], s28 offen lds
    s_waitcnt vmcnt(16)
    s_waitcnt lgkmcnt(0)
    s_barrier
    ds_read_b64_tr_b16 a[28:29], v10 offset:24576
    ds_read_b64_tr_b16 a[30:31], v10 offset:26624
    ds_read_b64_tr_b16 a[108:109], v13 offset:24576
    ds_read_b64_tr_b16 a[110:111], v13 offset:26624
    ds_read_b64_tr_b16 a[188:189], v16 offset:24576
    ds_read_b64_tr_b16 a[190:191], v16 offset:26624
    ds_read_b64_tr_b16 v[204:205], v19 offset:24576
    ds_read_b64_tr_b16 v[206:207], v19 offset:26624
    s_mul_i32 s29, s24, 4096
    s_add_u32 s28, s64, 4718592
    s_add_u32 m0, s29, 0
    s_nop 0
    buffer_load_dwordx4 v6, s[8:11], s28 offen lds
    s_add_u32 m0, s29, 1024
    s_nop 0
    buffer_load_dwordx4 v7, s[8:11], s28 offen lds
    s_add_u32 s28, s64, 4767744
    s_add_u32 m0, s29, 2048
    s_nop 0
    buffer_load_dwordx4 v6, s[8:11], s28 offen lds
    s_add_u32 m0, s29, 3072
    s_nop 0
    buffer_load_dwordx4 v7, s[8:11], s28 offen lds
    s_waitcnt vmcnt(16)
    s_waitcnt lgkmcnt(0)
    s_barrier
    ds_read_b64_tr_b16 a[32:33], v11 offset:0
    ds_read_b64_tr_b16 a[34:35], v11 offset:2048
    ds_read_b64_tr_b16 a[112:113], v14 offset:0
    ds_read_b64_tr_b16 a[114:115], v14 offset:2048
    ds_read_b64_tr_b16 a[192:193], v17 offset:0
    ds_read_b64_tr_b16 a[194:195], v17 offset:2048
    ds_read_b64_tr_b16 v[208:209], v20 offset:0
    ds_read_b64_tr_b16 v[210:211], v20 offset:2048
    s_mul_i32 s29, s24, 4096
    s_add_u32 s28, s64, 5111808
    s_add_u32 m0, s29, 24576
    s_nop 0
    buffer_load_dwordx4 v6, s[8:11], s28 offen lds
    s_add_u32 m0, s29, 25600
    s_nop 0
    buffer_load_dwordx4 v7, s[8:11], s28 offen lds
    s_add_u32 s28, s64, 5160960
    s_add_u32 m0, s29, 26624
    s_nop 0
    buffer_load_dwordx4 v6, s[8:11], s28 offen lds
    s_add_u32 m0, s29, 27648
    s_nop 0
    buffer_load_dwordx4 v7, s[8:11], s28 offen lds
    s_waitcnt vmcnt(16)
    s_waitcnt lgkmcnt(0)
    s_barrier
    ds_read_b64_tr_b16 a[36:37], v11 offset:24576
    ds_read_b64_tr_b16 a[38:39], v11 offset:26624
    ds_read_b64_tr_b16 a[116:117], v14 offset:24576
    ds_read_b64_tr_b16 a[118:119], v14 offset:26624
    ds_read_b64_tr_b16 a[196:197], v17 offset:24576
    ds_read_b64_tr_b16 a[198:199], v17 offset:26624
    ds_read_b64_tr_b16 v[212:213], v20 offset:24576
    ds_read_b64_tr_b16 v[214:215], v20 offset:26624
    s_mul_i32 s29, s24, 4096
    s_add_u32 s28, s64, 5505024
    s_add_u32 m0, s29, 49152
    s_nop 0
    buffer_load_dwordx4 v6, s[8:11], s28 offen lds
    s_add_u32 m0, s29, 50176
    s_nop 0
    buffer_load_dwordx4 v7, s[8:11], s28 offen lds
    s_add_u32 s28, s64, 5554176
    s_add_u32 m0, s29, 51200
    s_nop 0
    buffer_load_dwordx4 v6, s[8:11], s28 offen lds
    s_add_u32 m0, s29, 52224
    s_nop 0
    buffer_load_dwordx4 v7, s[8:11], s28 offen lds
    s_waitcnt vmcnt(16)
    s_waitcnt lgkmcnt(0)
    s_barrier
    ds_read_b64_tr_b16 a[40:41], v12 offset:0
    ds_read_b64_tr_b16 a[42:43], v12 offset:2048
    ds_read_b64_tr_b16 a[120:121], v15 offset:0
    ds_read_b64_tr_b16 a[122:123], v15 offset:2048
    ds_read_b64_tr_b16 a[200:201], v18 offset:0
    ds_read_b64_tr_b16 a[202:203], v18 offset:2048
    ds_read_b64_tr_b16 v[216:217], v21 offset:0
    ds_read_b64_tr_b16 v[218:219], v21 offset:2048
    s_mul_i32 s29, s24, 4096
    s_add_u32 s28, s64, 5898240
    s_add_u32 m0, s29, 73728
    s_nop 0
    buffer_load_dwordx4 v6, s[8:11], s28 offen lds
    s_add_u32 m0, s29, 74752
    s_nop 0
    buffer_load_dwordx4 v7, s[8:11], s28 offen lds
    s_add_u32 s28, s64, 5947392
    s_add_u32 m0, s29, 75776
    s_nop 0
    buffer_load_dwordx4 v6, s[8:11], s28 offen lds
    s_add_u32 m0, s29, 76800
    s_nop 0
    buffer_load_dwordx4 v7, s[8:11], s28 offen lds
    s_waitcnt vmcnt(16)
    s_waitcnt lgkmcnt(0)
    s_barrier
    ds_read_b64_tr_b16 a[44:45], v12 offset:24576
    ds_read_b64_tr_b16 a[46:47], v12 offset:26624
    ds_read_b64_tr_b16 a[124:125], v15 offset:24576
    ds_read_b64_tr_b16 a[126:127], v15 offset:26624
    ds_read_b64_tr_b16 a[204:205], v18 offset:24576
    ds_read_b64_tr_b16 a[206:207], v18 offset:26624
    ds_read_b64_tr_b16 v[220:221], v21 offset:24576
    ds_read_b64_tr_b16 v[222:223], v21 offset:26624
    s_mul_i32 s29, s24, 4096
    s_add_u32 s28, s64, 6291456
    s_add_u32 m0, s29, 98304
    s_nop 0
    buffer_load_dwordx4 v6, s[8:11], s28 offen lds
    s_add_u32 m0, s29, 99328
    s_nop 0
    buffer_load_dwordx4 v7, s[8:11], s28 offen lds
    s_add_u32 s28, s64, 6340608
    s_add_u32 m0, s29, 100352
    s_nop 0
    buffer_load_dwordx4 v6, s[8:11], s28 offen lds
    s_add_u32 m0, s29, 101376
    s_nop 0
    buffer_load_dwordx4 v7, s[8:11], s28 offen lds
    s_waitcnt vmcnt(16)
    s_waitcnt lgkmcnt(0)
    s_barrier
    ds_read_b64_tr_b16 a[48:49], v10 offset:0
    ds_read_b64_tr_b16 a[50:51], v10 offset:2048
    ds_read_b64_tr_b16 a[128:129], v13 offset:0
    ds_read_b64_tr_b16 a[130:131], v13 offset:2048
    ds_read_b64_tr_b16 a[208:209], v16 offset:0
    ds_read_b64_tr_b16 a[210:211], v16 offset:2048
    ds_read_b64_tr_b16 v[224:225], v19 offset:0
    ds_read_b64_tr_b16 v[226:227], v19 offset:2048
    s_mul_i32 s29, s24, 4096
    s_add_u32 s28, s64, 6684672
    s_add_u32 m0, s29, 122880
    s_nop 0
    buffer_load_dwordx4 v6, s[8:11], s28 offen lds
    s_add_u32 m0, s29, 123904
    s_nop 0
    buffer_load_dwordx4 v7, s[8:11], s28 offen lds
    s_add_u32 s28, s64, 6733824
    s_add_u32 m0, s29, 124928
    s_nop 0
    buffer_load_dwordx4 v6, s[8:11], s28 offen lds
    s_add_u32 m0, s29, 125952
    s_nop 0
    buffer_load_dwordx4 v7, s[8:11], s28 offen lds
    s_waitcnt vmcnt(16)
    s_waitcnt lgkmcnt(0)
    s_barrier
    ds_read_b64_tr_b16 a[52:53], v10 offset:24576
    ds_read_b64_tr_b16 a[54:55], v10 offset:26624
    ds_read_b64_tr_b16 a[132:133], v13 offset:24576
    ds_read_b64_tr_b16 a[134:135], v13 offset:26624
    ds_read_b64_tr_b16 a[212:213], v16 offset:24576
    ds_read_b64_tr_b16 a[214:215], v16 offset:26624
    ds_read_b64_tr_b16 v[228:229], v19 offset:24576
    ds_read_b64_tr_b16 v[230:231], v19 offset:26624
    s_mul_i32 s29, s24, 4096
    s_add_u32 s28, s64, 7077888
    s_add_u32 m0, s29, 0
    s_nop 0
    buffer_load_dwordx4 v6, s[8:11], s28 offen lds
    s_add_u32 m0, s29, 1024
    s_nop 0
    buffer_load_dwordx4 v7, s[8:11], s28 offen lds
    s_add_u32 s28, s64, 7127040
    s_add_u32 m0, s29, 2048
    s_nop 0
    buffer_load_dwordx4 v6, s[8:11], s28 offen lds
    s_add_u32 m0, s29, 3072
    s_nop 0
    buffer_load_dwordx4 v7, s[8:11], s28 offen lds
    s_waitcnt vmcnt(16)
    s_waitcnt lgkmcnt(0)
    s_barrier
    ds_read_b64_tr_b16 a[56:57], v11 offset:0
    ds_read_b64_tr_b16 a[58:59], v11 offset:2048
    ds_read_b64_tr_b16 a[136:137], v14 offset:0
    ds_read_b64_tr_b16 a[138:139], v14 offset:2048
    ds_read_b64_tr_b16 a[216:217], v17 offset:0
    ds_read_b64_tr_b16 a[218:219], v17 offset:2048
    ds_read_b64_tr_b16 v[232:233], v20 offset:0
    ds_read_b64_tr_b16 v[234:235], v20 offset:2048
    s_mul_i32 s29, s24, 4096
    s_add_u32 s28, s64, 7471104
    s_add_u32 m0, s29, 24576
    s_nop 0
    buffer_load_dwordx4 v6, s[8:11], s28 offen lds
    s_add_u32 m0, s29, 25600
    s_nop 0
    buffer_load_dwordx4 v7, s[8:11], s28 offen lds
    s_add_u32 s28, s64, 7520256
    s_add_u32 m0, s29, 26624
    s_nop 0
    buffer_load_dwordx4 v6, s[8:11], s28 offen lds
    s_add_u32 m0, s29, 27648
    s_nop 0
    buffer_load_dwordx4 v7, s[8:11], s28 offen lds
    s_waitcnt vmcnt(16)
    s_waitcnt lgkmcnt(0)
    s_barrier
    ds_read_b64_tr_b16 a[60:61], v11 offset:24576
    ds_read_b64_tr_b16 a[62:63], v11 offset:26624
    ds_read_b64_tr_b16 a[140:141], v14 offset:24576
    ds_read_b64_tr_b16 a[142:143], v14 offset:26624
    ds_read_b64_tr_b16 a[220:221], v17 offset:24576
    ds_read_b64_tr_b16 a[222:223], v17 offset:26624
    ds_read_b64_tr_b16 v[236:237], v20 offset:24576
    ds_read_b64_tr_b16 v[238:239], v20 offset:26624
    s_waitcnt vmcnt(12)
    s_waitcnt lgkmcnt(0)
    s_barrier
    ds_read_b64_tr_b16 a[64:65], v12 offset:0
    ds_read_b64_tr_b16 a[66:67], v12 offset:2048
    ds_read_b64_tr_b16 a[144:145], v15 offset:0
    ds_read_b64_tr_b16 a[146:147], v15 offset:2048
    ds_read_b64_tr_b16 a[224:225], v18 offset:0
    ds_read_b64_tr_b16 a[226:227], v18 offset:2048
    ds_read_b64_tr_b16 v[240:241], v21 offset:0
    ds_read_b64_tr_b16 v[242:243], v21 offset:2048
    s_waitcnt vmcnt(8)
    s_waitcnt lgkmcnt(0)
    s_barrier
    ds_read_b64_tr_b16 a[68:69], v12 offset:24576
    ds_read_b64_tr_b16 a[70:71], v12 offset:26624
    ds_read_b64_tr_b16 a[148:149], v15 offset:24576
    ds_read_b64_tr_b16 a[150:151], v15 offset:26624
    ds_read_b64_tr_b16 a[228:229], v18 offset:24576
    ds_read_b64_tr_b16 a[230:231], v18 offset:26624
    ds_read_b64_tr_b16 v[244:245], v21 offset:24576
    ds_read_b64_tr_b16 v[246:247], v21 offset:26624
    buffer_load_dwordx2 v[2:3], off, s[16:19], 0 offset:128 sc1
    s_waitcnt vmcnt(5)
    s_waitcnt lgkmcnt(0)
    s_barrier
    ds_read_b64_tr_b16 a[72:73], v10 offset:0
    ds_read_b64_tr_b16 a[74:75], v10 offset:2048
    ds_read_b64_tr_b16 a[152:153], v13 offset:0
    ds_read_b64_tr_b16 a[154:155], v13 offset:2048
    ds_read_b64_tr_b16 a[232:233], v16 offset:0
    ds_read_b64_tr_b16 a[234:235], v16 offset:2048
    ds_read_b64_tr_b16 v[248:249], v19 offset:0
    ds_read_b64_tr_b16 v[250:251], v19 offset:2048
    s_waitcnt vmcnt(1)
    s_waitcnt lgkmcnt(0)
    s_barrier
    ds_read_b64_tr_b16 a[76:77], v10 offset:24576
    ds_read_b64_tr_b16 a[78:79], v10 offset:26624
    ds_read_b64_tr_b16 a[156:157], v13 offset:24576
    ds_read_b64_tr_b16 a[158:159], v13 offset:26624
    ds_read_b64_tr_b16 a[236:237], v16 offset:24576
    ds_read_b64_tr_b16 a[238:239], v16 offset:26624
    ds_read_b64_tr_b16 v[252:253], v19 offset:24576
    ds_read_b64_tr_b16 v[254:255], v19 offset:26624
    s_waitcnt vmcnt(0) lgkmcnt(0)
    s_barrier
    v_lshlrev_b32 v22, 4, v1
    v_mov_b32 v23, v22
    s_mov_b32 s32, 0
Lws_30:
    v_readfirstlane_b32 s28, v2
    s_nop 0
    s_cmp_eq_u32 s28, 0
    s_cbranch_scc1 Lretry_31
    s_mul_i32 s65, s25, 16384
    s_mul_i32 s28, s24, 4096
    s_add_u32 s65, s65, s28
    s_add_u32 s65, s65, 4194304
    s_mov_b32 s67, 536870912
    s_mov_b32 s26, 0
    s_mov_b32 s27, 0
    s_mul_i32 s30, s26, 40960
    s_mul_i32 s31, s24, 10240
    s_add_u32 s30, s30, s31
    s_add_u32 s31, s31, s27
    s_add_u32 m0, s31, 0
    s_nop 0
    buffer_load_dwordx4 v22, s[4:7], s30 offen offset:0 sc1 lds
    buffer_load_dwordx4 v22, s[4:7], s30 offen offset:1024 sc1 lds
    buffer_load_dwordx4 v22, s[4:7], s30 offen offset:2048 sc1 lds
    buffer_load_dwordx4 v22, s[4:7], s30 offen offset:3072 sc1 lds
    s_add_u32 m0, s31, 4096
    s_add_u32 s30, s30, 4096
    buffer_load_dwordx4 v22, s[4:7], s30 offen offset:0 sc1 lds
    buffer_load_dwordx4 v22, s[4:7], s30 offen offset:1024 sc1 lds
    buffer_load_dwordx4 v22, s[4:7], s30 offen offset:2048 sc1 lds
    buffer_load_dwordx4 v22, s[4:7], s30 offen offset:3072 sc1 lds
    s_add_u32 m0, s31, 8192
    s_add_u32 s30, s30, 4096
    buffer_load_dwordx4 v22, s[4:7], s30 offen offset:0 sc1 lds
    buffer_load_dwordx4 v22, s[4:7], s30 offen offset:1024 sc1 lds
    s_waitcnt vmcnt(0)
    s_barrier
    ds_read_b128 v[24:27], v23 offset:0
    ds_read_b128 v[28:31], v23 offset:20480
    ds_read_b128 v[32:35], v23 offset:1024
    ds_read_b128 v[36:39], v23 offset:21504
    ds_read_b128 v[40:43], v23 offset:2048
    ds_read_b128 v[44:47], v23 offset:22528
.p2align 6
LK_top:
    s_add_u32 s66, s26, 1
    s_min_u32 s66, s66, 63
    s_add_u32 s27, s27, 40960
    s_cmp_ge_u32 s27, 122880
    s_cselect_b32 s27, 0, s27
    s_mul_i32 s30, s66, 40960
    s_mul_i32 s31, s24, 10240
    s_add_u32 s30, s30, s31
    s_add_u32 s31, s31, s27
    s_waitcnt lgkmcnt(4)
    v_mfma_f32_16x16x32_bf16 v[56:59], a[0:3], v[24:27], 0
    v_mfma_f32_16x16x32_bf16 v[64:67], a[80:83], v[24:27], 0
    buffer_store_dwordx4 v[88:91], v22, s[4:7], s67 offen offset:0 sc1
    v_mfma_f32_16x16x32_bf16 v[72:75], a[160:163], v[24:27], 0
    v_mfma_f32_16x16x32_bf16 v[80:83], a[240:243], v[24:27], 0
    ds_read_b128 v[48:51], v23 offset:3072
    ds_read_b128 v[52:55], v23 offset:23552
    v_mfma_f32_16x16x32_bf16 v[60:63], a[0:3], v[28:31], 0
    s_add_u32 m0, s31, 0
    s_nop 0
    buffer_load_dwordx4 v22, s[4:7], s30 offen offset:0 sc1 lds
    v_mfma_f32_16x16x32_bf16 v[68:71], a[80:83], v[28:31], 0
    v_mfma_f32_16x16x32_bf16 v[76:79], a[160:163], v[28:31], 0
    v_mfma_f32_16x16x32_bf16 v[84:87], a[240:243], v[28:31], 0
    s_waitcnt lgkmcnt(4)
    v_mfma_f32_16x16x32_bf16 v[56:59], a[4:7], v[32:35], v[56:59]
    v_mfma_f32_16x16x32_bf16 v[64:67], a[84:87], v[32:35], v[64:67]
    buffer_store_dwordx4 v[92:95], v22, s[4:7], s67 offen offset:1024 sc1
    v_mfma_f32_16x16x32_bf16 v[72:75], a[164:167], v[32:35], v[72:75]
    v_mfma_f32_16x16x32_bf16 v[80:83], a[244:247], v[32:35], v[80:83]
    ds_read_b128 v[24:27], v23 offset:4096
    ds_read_b128 v[28:31], v23 offset:24576
    v_mfma_f32_16x16x32_bf16 v[60:63], a[4:7], v[36:39], v[60:63]
    buffer_load_dwordx4 v22, s[4:7], s30 offen offset:1024 sc1 lds
    v_mfma_f32_16x16x32_bf16 v[68:71], a[84:87], v[36:39], v[68:71]
    v_mfma_f32_16x16x32_bf16 v[76:79], a[164:167], v[36:39], v[76:79]
    v_mfma_f32_16x16x32_bf16 v[84:87], a[244:247], v[36:39], v[84:87]
    s_waitcnt lgkmcnt(4)
    v_mfma_f32_16x16x32_bf16 v[56:59], a[8:11], v[40:43], v[56:59]
    v_mfma_f32_16x16x32_bf16 v[64:67], a[88:91], v[40:43], v[64:67]
    buffer_store_dwordx4 v[96:99], v22, s[4:7], s67 offen offset:2048 sc1
    v_mfma_f32_16x16x32_bf16 v[72:75], a[168:171], v[40:43], v[72:75]
    v_mfma_f32_16x16x32_bf16 v[80:83], a[248:251], v[40:43], v[80:83]
    ds_read_b128 v[32:35], v23 offset:5120
    ds_read_b128 v[36:39], v23 offset:25600
    v_mfma_f32_16x16x32_bf16 v[60:63], a[8:11], v[44:47], v[60:63]
    buffer_load_dwordx4 v22, s[4:7], s30 offen offset:2048 sc1 lds
    v_mfma_f32_16x16x32_bf16 v[68:71], a[88:91], v[44:47], v[68:71]
    v_mfma_f32_16x16x32_bf16 v[76:79], a[168:171], v[44:47], v[76:79]
    v_mfma_f32_16x16x32_bf16 v[84:87], a[248:251], v[44:47], v[84:87]
    s_waitcnt lgkmcnt(4)
    v_mfma_f32_16x16x32_bf16 v[56:59], a[12:15], v[48:51], v[56:59]
    v_mfma_f32_16x16x32_bf16 v[64:67], a[92:95], v[48:51], v[64:67]
    buffer_store_dwordx4 v[100:103], v22, s[4:7], s67 offen offset:3072 sc1
    v_mfma_f32_16x16x32_bf16 v[72:75], a[172:175], v[48:51], v[72:75]
    v_mfma_f32_16x16x32_bf16 v[80:83], a[252:255], v[48:51], v[80:83]
    ds_read_b128 v[40:43], v23 offset:6144
    ds_read_b128 v[44:47], v23 offset:26624
    v_mfma_f32_16x16x32_bf16 v[60:63], a[12:15], v[52:55], v[60:63]
    buffer_load_dwordx4 v22, s[4:7], s30 offen offset:3072 sc1 lds
    v_mfma_f32_16x16x32_bf16 v[68:71], a[92:95], v[52:55], v[68:71]
    v_mfma_f32_16x16x32_bf16 v[76:79], a[172:175], v[52:55], v[76:79]
    v_mfma_f32_16x16x32_bf16 v[84:87], a[252:255], v[52:55], v[84:87]
    s_waitcnt lgkmcnt(4)
    v_mfma_f32_16x16x32_bf16 v[56:59], a[16:19], v[24:27], v[56:59]
    v_mfma_f32_16x16x32_bf16 v[64:67], a[96:99], v[24:27], v[64:67]
    v_mfma_f32_16x16x32_bf16 v[72:75], a[176:179], v[24:27], v[72:75]
    v_mfma_f32_16x16x32_bf16 v[80:83], v[192:195], v[24:27], v[80:83]
    ds_read_b128 v[48:51], v23 offset:7168
    ds_read_b128 v[52:55], v23 offset:27648
    v_mfma_f32_16x16x32_bf16 v[60:63], a[16:19], v[28:31], v[60:63]
    s_add_u32 m0, s31, 4096
    s_add_u32 s30, s30, 4096
    buffer_load_dwordx4 v22, s[4:7], s30 offen offset:0 sc1 lds
    v_mfma_f32_16x16x32_bf16 v[68:71], a[96:99], v[28:31], v[68:71]
    v_mfma_f32_16x16x32_bf16 v[76:79], a[176:179], v[28:31], v[76:79]
    v_mfma_f32_16x16x32_bf16 v[84:87], v[192:195], v[28:31], v[84:87]
    s_waitcnt lgkmcnt(4)
    v_mfma_f32_16x16x32_bf16 v[56:59], a[20:23], v[32:35], v[56:59]
    v_mfma_f32_16x16x32_bf16 v[64:67], a[100:103], v[32:35], v[64:67]
    v_mfma_f32_16x16x32_bf16 v[72:75], a[180:183], v[32:35], v[72:75]
    v_mfma_f32_16x16x32_bf16 v[80:83], v[196:199], v[32:35], v[80:83]
    ds_read_b128 v[24:27], v23 offset:8192
    ds_read_b128 v[28:31], v23 offset:28672
    v_mfma_f32_16x16x32_bf16 v[60:63], a[20:23], v[36:39], v[60:63]
    buffer_load_dwordx4 v22, s[4:7], s30 offen offset:1024 sc1 lds
    v_mfma_f32_16x16x32_bf16 v[68:71], a[100:103], v[36:39], v[68:71]
    v_mfma_f32_16x16x32_bf16 v[76:79], a[180:183], v[36:39], v[76:79]
    v_mfma_f32_16x16x32_bf16 v[84:87], v[196:199], v[36:39], v[84:87]
    s_waitcnt lgkmcnt(4)
    v_mfma_f32_16x16x32_bf16 v[56:59], a[24:27], v[40:43], v[56:59]
    v_mfma_f32_16x16x32_bf16 v[64:67], a[104:107], v[40:43], v[64:67]
    v_mfma_f32_16x16x32_bf16 v[72:75], a[184:187], v[40:43], v[72:75]
    v_mfma_f32_16x16x32_bf16 v[80:83], v[200:203], v[40:43], v[80:83]
    ds_read_b128 v[32:35], v23 offset:9216
    ds_read_b128 v[36:39], v23 offset:29696
    v_mfma_f32_16x16x32_bf16 v[60:63], a[24:27], v[44:47], v[60:63]
    buffer_load_dwordx4 v22, s[4:7], s30 offen offset:2048 sc1 lds
    v_mfma_f32_16x16x32_bf16 v[68:71], a[104:107], v[44:47], v[68:71]
    v_mfma_f32_16x16x32_bf16 v[76:79], a[184:187], v[44:47], v[76:79]
    v_mfma_f32_16x16x32_bf16 v[84:87], v[200:203], v[44:47], v[84:87]
    s_waitcnt lgkmcnt(4)
    v_mfma_f32_16x16x32_bf16 v[56:59], a[28:31], v[48:51], v[56:59]
    v_mfma_f32_16x16x32_bf16 v[64:67], a[108:111], v[48:51], v[64:67]
    v_mfma_f32_16x16x32_bf16 v[72:75], a[188:191], v[48:51], v[72:75]
    v_mfma_f32_16x16x32_bf16 v[80:83], v[204:207], v[48:51], v[80:83]
    ds_read_b128 v[40:43], v23 offset:10240
    ds_read_b128 v[44:47], v23 offset:30720
    v_mfma_f32_16x16x32_bf16 v[60:63], a[28:31], v[52:55], v[60:63]
    buffer_load_dwordx4 v22, s[4:7], s30 offen offset:3072 sc1 lds
    v_mfma_f32_16x16x32_bf16 v[68:71], a[108:111], v[52:55], v[68:71]
    v_mfma_f32_16x16x32_bf16 v[76:79], a[188:191], v[52:55], v[76:79]
    v_mfma_f32_16x16x32_bf16 v[84:87], v[204:207], v[52:55], v[84:87]
    s_waitcnt lgkmcnt(4)
    v_mfma_f32_16x16x32_bf16 v[56:59], a[32:35], v[24:27], v[56:59]
    v_mfma_f32_16x16x32_bf16 v[64:67], a[112:115], v[24:27], v[64:67]
    v_mfma_f32_16x16x32_bf16 v[72:75], a[192:195], v[24:27], v[72:75]
    v_mfma_f32_16x16x32_bf16 v[80:83], v[208:211], v[24:27], v[80:83]
    ds_read_b128 v[48:51], v23 offset:11264
    ds_read_b128 v[52:55], v23 offset:31744
    v_mfma_f32_16x16x32_bf16 v[60:63], a[32:35], v[28:31], v[60:63]
    s_add_u32 m0, s31, 8192
    s_add_u32 s30, s30, 4096
    buffer_load_dwordx4 v22, s[4:7], s30 offen offset:0 sc1 lds
    v_mfma_f32_16x16x32_bf16 v[68:71], a[112:115], v[28:31], v[68:71]
    v_mfma_f32_16x16x32_bf16 v[76:79], a[192:195], v[28:31], v[76:79]
    v_mfma_f32_16x16x32_bf16 v[84:87], v[208:211], v[28:31], v[84:87]
    s_waitcnt lgkmcnt(4)
    v_mfma_f32_16x16x32_bf16 v[56:59], a[36:39], v[32:35], v[56:59]
    v_mfma_f32_16x16x32_bf16 v[64:67], a[116:119], v[32:35], v[64:67]
    v_mfma_f32_16x16x32_bf16 v[72:75], a[196:199], v[32:35], v[72:75]
    v_mfma_f32_16x16x32_bf16 v[80:83], v[212:215], v[32:35], v[80:83]
    ds_read_b128 v[24:27], v23 offset:12288
    ds_read_b128 v[28:31], v23 offset:32768
    v_mfma_f32_16x16x32_bf16 v[60:63], a[36:39], v[36:39], v[60:63]
    buffer_load_dwordx4 v22, s[4:7], s30 offen offset:1024 sc1 lds
    v_mfma_f32_16x16x32_bf16 v[68:71], a[116:119], v[36:39], v[68:71]
    v_mfma_f32_16x16x32_bf16 v[76:79], a[196:199], v[36:39], v[76:79]
    v_mfma_f32_16x16x32_bf16 v[84:87], v[212:215], v[36:39], v[84:87]
    s_waitcnt lgkmcnt(4)
    v_mfma_f32_16x16x32_bf16 v[56:59], a[40:43], v[40:43], v[56:59]
    v_mfma_f32_16x16x32_bf16 v[64:67], a[120:123], v[40:43], v[64:67]
    v_mfma_f32_16x16x32_bf16 v[72:75], a[200:203], v[40:43], v[72:75]
    v_mfma_f32_16x16x32_bf16 v[80:83], v[216:219], v[40:43], v[80:83]
    ds_read_b128 v[32:35], v23 offset:13312
    ds_read_b128 v[36:39], v23 offset:33792
    v_mfma_f32_16x16x32_bf16 v[60:63], a[40:43], v[44:47], v[60:63]
    v_mfma_f32_16x16x32_bf16 v[68:71], a[120:123], v[44:47], v[68:71]
    v_mfma_f32_16x16x32_bf16 v[76:79], a[200:203], v[44:47], v[76:79]
    v_mfma_f32_16x16x32_bf16 v[84:87], v[216:219], v[44:47], v[84:87]
    s_waitcnt lgkmcnt(4)
    v_mfma_f32_16x16x32_bf16 v[56:59], a[44:47], v[48:51], v[56:59]
    v_mfma_f32_16x16x32_bf16 v[64:67], a[124:127], v[48:51], v[64:67]
    v_mfma_f32_16x16x32_bf16 v[72:75], a[204:207], v[48:51], v[72:75]
    v_mfma_f32_16x16x32_bf16 v[80:83], v[220:223], v[48:51], v[80:83]
    ds_read_b128 v[40:43], v23 offset:14336
    ds_read_b128 v[44:47], v23 offset:34816
    v_mfma_f32_16x16x32_bf16 v[60:63], a[44:47], v[52:55], v[60:63]
    v_mfma_f32_16x16x32_bf16 v[68:71], a[124:127], v[52:55], v[68:71]
    v_mfma_f32_16x16x32_bf16 v[76:79], a[204:207], v[52:55], v[76:79]
    v_mfma_f32_16x16x32_bf16 v[84:87], v[220:223], v[52:55], v[84:87]
    s_waitcnt lgkmcnt(4)
    v_mfma_f32_16x16x32_bf16 v[56:59], a[48:51], v[24:27], v[56:59]
    v_mfma_f32_16x16x32_bf16 v[64:67], a[128:131], v[24:27], v[64:67]
    v_mfma_f32_16x16x32_bf16 v[72:75], a[208:211], v[24:27], v[72:75]
    v_mfma_f32_16x16x32_bf16 v[80:83], v[224:227], v[24:27], v[80:83]
    ds_read_b128 v[48:51], v23 offset:15360
    ds_read_b128 v[52:55], v23 offset:35840
    v_mfma_f32_16x16x32_bf16 v[60:63], a[48:51], v[28:31], v[60:63]
    v_mfma_f32_16x16x32_bf16 v[68:71], a[128:131], v[28:31], v[68:71]
    v_mfma_f32_16x16x32_bf16 v[76:79], a[208:211], v[28:31], v[76:79]
    v_mfma_f32_16x16x32_bf16 v[84:87], v[224:227], v[28:31], v[84:87]
    s_waitcnt lgkmcnt(4)
    v_mfma_f32_16x16x32_bf16 v[56:59], a[52:55], v[32:35], v[56:59]
    v_mfma_f32_16x16x32_bf16 v[64:67], a[132:135], v[32:35], v[64:67]
    v_mfma_f32_16x16x32_bf16 v[72:75], a[212:215], v[32:35], v[72:75]
    v_mfma_f32_16x16x32_bf16 v[80:83], v[228:231], v[32:35], v[80:83]
    ds_read_b128 v[24:27], v23 offset:16384
    ds_read_b128 v[28:31], v23 offset:36864
    v_mfma_f32_16x16x32_bf16 v[60:63], a[52:55], v[36:39], v[60:63]
    v_mfma_f32_16x16x32_bf16 v[68:71], a[132:135], v[36:39], v[68:71]
    v_mfma_f32_16x16x32_bf16 v[76:79], a[212:215], v[36:39], v[76:79]
    v_mfma_f32_16x16x32_bf16 v[84:87], v[228:231], v[36:39], v[84:87]
    s_waitcnt lgkmcnt(4)
    v_mfma_f32_16x16x32_bf16 v[56:59], a[56:59], v[40:43], v[56:59]
    v_mfma_f32_16x16x32_bf16 v[64:67], a[136:139], v[40:43], v[64:67]
    v_mfma_f32_16x16x32_bf16 v[72:75], a[216:219], v[40:43], v[72:75]
    v_mfma_f32_16x16x32_bf16 v[80:83], v[232:235], v[40:43], v[80:83]
    ds_read_b128 v[32:35], v23 offset:17408
    ds_read_b128 v[36:39], v23 offset:37888
    v_mfma_f32_16x16x32_bf16 v[60:63], a[56:59], v[44:47], v[60:63]
    v_mfma_f32_16x16x32_bf16 v[68:71], a[136:139], v[44:47], v[68:71]
    v_mfma_f32_16x16x32_bf16 v[76:79], a[216:219], v[44:47], v[76:79]
    v_mfma_f32_16x16x32_bf16 v[84:87], v[232:235], v[44:47], v[84:87]
    s_waitcnt lgkmcnt(4)
    v_mfma_f32_16x16x32_bf16 v[56:59], a[60:63], v[48:51], v[56:59]
    v_mfma_f32_16x16x32_bf16 v[64:67], a[140:143], v[48:51], v[64:67]
    v_mfma_f32_16x16x32_bf16 v[72:75], a[220:223], v[48:51], v[72:75]
    v_mfma_f32_16x16x32_bf16 v[80:83], v[236:239], v[48:51], v[80:83]
    ds_read_b128 v[40:43], v23 offset:18432
    ds_read_b128 v[44:47], v23 offset:38912
    v_mfma_f32_16x16x32_bf16 v[60:63], a[60:63], v[52:55], v[60:63]
    v_mfma_f32_16x16x32_bf16 v[68:71], a[140:143], v[52:55], v[68:71]
    v_mfma_f32_16x16x32_bf16 v[76:79], a[220:223], v[52:55], v[76:79]
    v_mfma_f32_16x16x32_bf16 v[84:87], v[236:239], v[52:55], v[84:87]
    s_waitcnt vmcnt(7)
    v_mov_b32 v2, s26
    s_mov_b64 exec, 1
    buffer_store_dword v2, off, s[4:7], s35 sc1
    s_mov_b64 exec, -1
    s_waitcnt lgkmcnt(4)
    v_mfma_f32_16x16x32_bf16 v[56:59], a[64:67], v[24:27], v[56:59]
    v_mfma_f32_16x16x32_bf16 v[64:67], a[144:147], v[24:27], v[64:67]
    v_mfma_f32_16x16x32_bf16 v[72:75], a[224:227], v[24:27], v[72:75]
    v_mfma_f32_16x16x32_bf16 v[80:83], v[240:243], v[24:27], v[80:83]
    ds_read_b128 v[48:51], v23 offset:19456
    ds_read_b128 v[52:55], v23 offset:39936
    v_mfma_f32_16x16x32_bf16 v[60:63], a[64:67], v[28:31], v[60:63]
    v_mfma_f32_16x16x32_bf16 v[68:71], a[144:147], v[28:31], v[68:71]
    v_mfma_f32_16x16x32_bf16 v[76:79], a[224:227], v[28:31], v[76:79]
    v_mfma_f32_16x16x32_bf16 v[84:87], v[240:243], v[28:31], v[84:87]
    s_waitcnt lgkmcnt(4)
    v_mfma_f32_16x16x32_bf16 v[56:59], a[68:71], v[32:35], v[56:59]
    v_mfma_f32_16x16x32_bf16 v[64:67], a[148:151], v[32:35], v[64:67]
    v_mfma_f32_16x16x32_bf16 v[72:75], a[228:231], v[32:35], v[72:75]
    v_mfma_f32_16x16x32_bf16 v[80:83], v[244:247], v[32:35], v[80:83]
    s_waitcnt vmcnt(1)
    s_barrier
    v_add_u32 v23, s27, v22
    ds_read_b128 v[24:27], v23 offset:0
    ds_read_b128 v[28:31], v23 offset:20480
    v_mfma_f32_16x16x32_bf16 v[60:63], a[68:71], v[36:39], v[60:63]
    v_mfma_f32_16x16x32_bf16 v[68:71], a[148:151], v[36:39], v[68:71]
    v_mfma_f32_16x16x32_bf16 v[76:79], a[228:231], v[36:39], v[76:79]
    v_mfma_f32_16x16x32_bf16 v[84:87], v[244:247], v[36:39], v[84:87]
    s_waitcnt lgkmcnt(4)
    v_mfma_f32_16x16x32_bf16 v[56:59], a[72:75], v[40:43], v[56:59]
    v_mfma_f32_16x16x32_bf16 v[64:67], a[152:155], v[40:43], v[64:67]
    v_mfma_f32_16x16x32_bf16 v[72:75], a[232:235], v[40:43], v[72:75]
    v_mfma_f32_16x16x32_bf16 v[80:83], v[248:251], v[40:43], v[80:83]
    ds_read_b128 v[32:35], v23 offset:1024
    ds_read_b128 v[36:39], v23 offset:21504
    v_mfma_f32_16x16x32_bf16 v[60:63], a[72:75], v[44:47], v[60:63]
    v_mfma_f32_16x16x32_bf16 v[68:71], a[152:155], v[44:47], v[68:71]
    v_mfma_f32_16x16x32_bf16 v[76:79], a[232:235], v[44:47], v[76:79]
    v_mfma_f32_16x16x32_bf16 v[84:87], v[248:251], v[44:47], v[84:87]
    s_waitcnt lgkmcnt(4)
    v_mfma_f32_16x16x32_bf16 v[56:59], a[76:79], v[48:51], v[56:59]
    v_mfma_f32_16x16x32_bf16 v[64:67], a[156:159], v[48:51], v[64:67]
    v_mfma_f32_16x16x32_bf16 v[72:75], a[236:239], v[48:51], v[72:75]
    v_mfma_f32_16x16x32_bf16 v[80:83], v[252:255], v[48:51], v[80:83]
    ds_read_b128 v[40:43], v23 offset:2048
    ds_read_b128 v[44:47], v23 offset:22528
    v_mfma_f32_16x16x32_bf16 v[60:63], a[76:79], v[52:55], v[60:63]
    v_mfma_f32_16x16x32_bf16 v[68:71], a[156:159], v[52:55], v[68:71]
    v_mfma_f32_16x16x32_bf16 v[76:79], a[236:239], v[52:55], v[76:79]
    v_mfma_f32_16x16x32_bf16 v[84:87], v[252:255], v[52:55], v[84:87]
    v_cvt_pk_bf16_f32 v88, v56, v57
    v_cvt_pk_bf16_f32 v89, v58, v59
    v_cvt_pk_bf16_f32 v90, v60, v61
    v_cvt_pk_bf16_f32 v91, v62, v63
    v_cvt_pk_bf16_f32 v92, v64, v65
    v_cvt_pk_bf16_f32 v93, v66, v67
    v_cvt_pk_bf16_f32 v94, v68, v69
    v_cvt_pk_bf16_f32 v95, v70, v71
    v_cvt_pk_bf16_f32 v96, v72, v73
    v_cvt_pk_bf16_f32 v97, v74, v75
    v_cvt_pk_bf16_f32 v98, v76, v77
    v_cvt_pk_bf16_f32 v99, v78, v79
    v_cvt_pk_bf16_f32 v100, v80, v81
    v_cvt_pk_bf16_f32 v101, v82, v83
    v_cvt_pk_bf16_f32 v102, v84, v85
    v_cvt_pk_bf16_f32 v103, v86, v87
    s_mov_b32 s67, s65
    s_add_u32 s65, s65, 393216
    s_sub_u32 s28, s26, 1
    s_add_u32 s26, s26, 1
    s_cmp_lt_u32 s28, 62
    s_cbranch_scc1 LK_top
    buffer_store_dwordx4 v[88:91], v22, s[4:7], s67 offen offset:0 sc1
    buffer_store_dwordx4 v[92:95], v22, s[4:7], s67 offen offset:1024 sc1
    buffer_store_dwordx4 v[96:99], v22, s[4:7], s67 offen offset:2048 sc1
    buffer_store_dwordx4 v[100:103], v22, s[4:7], s67 offen offset:3072 sc1
    s_mov_b32 s67, 536870912
    s_waitcnt vmcnt(0)
    v_mov_b32 v2, s26
    s_mov_b64 exec, 1
    buffer_store_dword v2, off, s[4:7], s35 sc1
    s_mov_b64 exec, -1
    s_cmp_lt_u32 s26, 64
    s_cbranch_scc1 LK_top
    s_endpgm
Lretry_31:
    s_sleep 6
    buffer_load_dwordx2 v[2:3], off, s[16:19], 0 offset:128 sc1
    s_waitcnt vmcnt(0)
    s_add_u32 s32, s32, 1
    s_cmp_lt_u32 s32, 200000
    s_cbranch_scc1 Lws_30
    v_mov_b32 v2, 1
    v_mov_b32 v3, 4
    buffer_store_dword v2, v3, s[16:19], 0 offen sc1
    s_endpgm
E_K:
.p2align 6
W_V:
R_V:
    s_lshl_b32 s35, s25, 9
    s_lshl_b32 s28, s24, 7
    s_add_u32 s35, s35, s28
    s_add_u32 s35, s35, 163594240
    v_mov_b32 v2, 0
    s_mov_b64 exec, 1
    buffer_store_dword v2, off, s[4:7], s35 sc1
    s_mov_b64 exec, -1
    s_mov_b32 s8, s44
    s_mov_b32 s9, s45
    s_mov_b32 s10, 7864320
    s_mov_b32 s11, 0x20000
    s_and_b32 s28, s24, 1
    s_lshl_b32 s28, s28, 2
    v_lshrrev_b32 v2, 5, v1
    v_add_u32 v2, 0, v2
    v_or_b32 v3, s28, v2
    v_lshlrev_b32 v3, 1, v3
    v_and_b32 v4, 31, v1
    v_xor_b32 v4, v4, v3
    v_mul_u32_u24 v2, 12288, v2
    v_lshl_add_u32 v6, v4, 4, v2
    v_lshrrev_b32 v2, 5, v1
    v_add_u32 v2, 2, v2
    v_or_b32 v3, s28, v2
    v_lshlrev_b32 v3, 1, v3
    v_and_b32 v4, 31, v1
    v_xor_b32 v4, v4, v3
    v_mul_u32_u24 v2, 12288, v2
    v_lshl_add_u32 v7, v4, 4, v2
    v_bfe_u32 v2, v1, 2, 3
    v_lshrrev_b32 v3, 4, v1
    v_lshlrev_b32 v3, 3, v3
    v_bfe_u32 v4, v1, 2, 2
    v_add_u32 v3, v3, v4
    v_lshlrev_b32 v3, 9, v3
    v_and_b32 v4, 3, v1
    v_lshl_add_u32 v3, v4, 3, v3
    s_lshl_b32 s28, s24, 2
    s_add_u32 s28, s28, 0
    v_xor_b32 v10, s28, v2
    v_lshl_add_u32 v10, v10, 5, v3
    v_add_u32 v11, 49152, v10
    v_add_u32 v12, 98304, v10
    s_lshl_b32 s28, s24, 2
    s_add_u32 s28, s28, 1
    v_xor_b32 v13, s28, v2
    v_lshl_add_u32 v13, v13, 5, v3
    v_add_u32 v14, 49152, v13
    v_add_u32 v15, 98304, v13
    s_lshl_b32 s28, s24, 2
    s_add_u32 s28, s28, 2
    v_xor_b32 v16, s28, v2
    v_lshl_add_u32 v16, v16, 5, v3
    v_add_u32 v17, 49152, v16
    v_add_u32 v18, 98304, v16
    s_lshl_b32 s28, s24, 2
    s_add_u32 s28, s28, 3
    v_xor_b32 v19, s28, v2
    v_lshl_add_u32 v19, v19, 5, v3
    v_add_u32 v20, 49152, v19
    v_add_u32 v21, 98304, v19
    s_mul_i32 s64, s24, 98304
    s_lshl_b32 s28, s25, 9
    s_add_u32 s64, s64, s28
    s_mul_i32 s29, s24, 4096
    s_add_u32 s28, s64, 0
    s_add_u32 m0, s29, 0
    s_nop 0
    buffer_load_dwordx4 v6, s[8:11], s28 offen lds
    s_add_u32 m0, s29, 1024
    s_nop 0
    buffer_load_dwordx4 v7, s[8:11], s28 offen lds
    s_add_u32 s28, s64, 49152
    s_add_u32 m0, s29, 2048
    s_nop 0
    buffer_load_dwordx4 v6, s[8:11], s28 offen lds
    s_add_u32 m0, s29, 3072
    s_nop 0
    buffer_load_dwordx4 v7, s[8:11], s28 offen lds
    s_mul_i32 s29, s24, 4096
    s_add_u32 s28, s64, 393216
    s_add_u32 m0, s29, 24576
    s_nop 0
    buffer_load_dwordx4 v6, s[8:11], s28 offen lds
    s_add_u32 m0, s29, 25600
    s_nop 0
    buffer_load_dwordx4 v7, s[8:11], s28 offen lds
    s_add_u32 s28, s64, 442368
    s_add_u32 m0, s29, 26624
    s_nop 0
    buffer_load_dwordx4 v6, s[8:11], s28 offen lds
    s_add_u32 m0, s29, 27648
    s_nop 0
    buffer_load_dwordx4 v7, s[8:11], s28 offen lds
    s_waitcnt vmcnt(8)
    s_barrier
    s_cmp_lg_u32 s24, 0
    s_cbranch_scc1 Larr_32
    s_and_b32 s28, s2, 1
    s_lshl_b32 s28, s28, 6
    v_mov_b32 v2, 1
    s_mov_b64 exec, 1
    buffer_atomic_add v2, off, s[16:19], s28 sc1
    s_mov_b64 exec, -1
Larr_32:
    s_mul_i32 s29, s24, 4096
    s_add_u32 s28, s64, 786432
    s_add_u32 m0, s29, 49152
    s_nop 0
    buffer_load_dwordx4 v6, s[8:11], s28 offen lds
    s_add_u32 m0, s29, 50176
    s_nop 0
    buffer_load_dwordx4 v7, s[8:11], s28 offen lds
    s_add_u32 s28, s64, 835584
    s_add_u32 m0, s29, 51200
    s_nop 0
    buffer_load_dwordx4 v6, s[8:11], s28 offen lds
    s_add_u32 m0, s29, 52224
    s_nop 0
    buffer_load_dwordx4 v7, s[8:11], s28 offen lds
    s_mul_i32 s29, s24, 4096
    s_add_u32 s28, s64, 1179648
    s_add_u32 m0, s29, 73728
    s_nop 0
    buffer_load_dwordx4 v6, s[8:11], s28 offen lds
    s_add_u32 m0, s29, 74752
    s_nop 0
    buffer_load_dwordx4 v7, s[8:11], s28 offen lds
    s_add_u32 s28, s64, 1228800
    s_add_u32 m0, s29, 75776
    s_nop 0
    buffer_load_dwordx4 v6, s[8:11], s28 offen lds
    s_add_u32 m0, s29, 76800
    s_nop 0
    buffer_load_dwordx4 v7, s[8:11], s28 offen lds
    s_mul_i32 s29, s24, 4096
    s_add_u32 s28, s64, 1572864
    s_add_u32 m0, s29, 98304
    s_nop 0
    buffer_load_dwordx4 v6, s[8:11], s28 offen lds
    s_add_u32 m0, s29, 99328
    s_nop 0
    buffer_load_dwordx4 v7, s[8:11], s28 offen lds
    s_add_u32 s28, s64, 1622016
    s_add_u32 m0, s29, 100352
    s_nop 0
    buffer_load_dwordx4 v6, s[8:11], s28 offen lds
    s_add_u32 m0, s29, 101376
    s_nop 0
    buffer_load_dwordx4 v7, s[8:11], s28 offen lds
    s_mul_i32 s29, s24, 4096
    s_add_u32 s28, s64, 1966080
    s_add_u32 m0, s29, 122880
    s_nop 0
    buffer_load_dwordx4 v6, s[8:11], s28 offen lds
    s_add_u32 m0, s29, 123904
    s_nop 0
    buffer_load_dwordx4 v7, s[8:11], s28 offen lds
    s_add_u32 s28, s64, 2015232
    s_add_u32 m0, s29, 124928
    s_nop 0
    buffer_load_dwordx4 v6, s[8:11], s28 offen lds
    s_add_u32 m0, s29, 125952
    s_nop 0
    buffer_load_dwordx4 v7, s[8:11], s28 offen lds
    s_waitcnt vmcnt(20)
    s_waitcnt lgkmcnt(0)
    s_barrier
    ds_read_b64_tr_b16 a[0:1], v10 offset:0
    ds_read_b64_tr_b16 a[2:3], v10 offset:2048
    ds_read_b64_tr_b16 a[80:81], v13 offset:0
    ds_read_b64_tr_b16 a[82:83], v13 offset:2048
    ds_read_b64_tr_b16 a[160:161], v16 offset:0
    ds_read_b64_tr_b16 a[162:163], v16 offset:2048
    ds_read_b64_tr_b16 a[240:241], v19 offset:0
    ds_read_b64_tr_b16 a[242:243], v19 offset:2048
    s_waitcnt vmcnt(16)
    s_waitcnt lgkmcnt(0)
    s_barrier
    ds_read_b64_tr_b16 a[4:5], v10 offset:24576
    ds_read_b64_tr_b16 a[6:7], v10 offset:26624
    ds_read_b64_tr_b16 a[84:85], v13 offset:24576
    ds_read_b64_tr_b16 a[86:87], v13 offset:26624
    ds_read_b64_tr_b16 a[164:165], v16 offset:24576
    ds_read_b64_tr_b16 a[166:167], v16 offset:26624
    ds_read_b64_tr_b16 a[244:245], v19 offset:24576
    ds_read_b64_tr_b16 a[246:247], v19 offset:26624
    s_mul_i32 s29, s24, 4096
    s_add_u32 s28, s64, 2359296
    s_add_u32 m0, s29, 0
    s_nop 0
    buffer_load_dwordx4 v6, s[8:11], s28 offen lds
    s_add_u32 m0, s29, 1024
    s_nop 0
    buffer_load_dwordx4 v7, s[8:11], s28 offen lds
    s_add_u32 s28, s64, 2408448
    s_add_u32 m0, s29, 2048
    s_nop 0
    buffer_load_dwordx4 v6, s[8:11], s28 offen lds
    s_add_u32 m0, s29, 3072
    s_nop 0
    buffer_load_dwordx4 v7, s[8:11], s28 offen lds
    s_waitcnt vmcnt(16)
    s_waitcnt lgkmcnt(0)
    s_barrier
    ds_read_b64_tr_b16 a[8:9], v11 offset:0
    ds_read_b64_tr_b16 a[10:11], v11 offset:2048
    ds_read_b64_tr_b16 a[88:89], v14 offset:0
    ds_read_b64_tr_b16 a[90:91], v14 offset:2048
    ds_read_b64_tr_b16 a[168:169], v17 offset:0
    ds_read_b64_tr_b16 a[170:171], v17 offset:2048
    ds_read_b64_tr_b16 a[248:249], v20 offset:0
    ds_read_b64_tr_b16 a[250:251], v20 offset:2048
    s_mul_i32 s29, s24, 4096
    s_add_u32 s28, s64, 2752512
    s_add_u32 m0, s29, 24576
    s_nop 0
    buffer_load_dwordx4 v6, s[8:11], s28 offen lds
    s_add_u32 m0, s29, 25600
    s_nop 0
    buffer_load_dwordx4 v7, s[8:11], s28 offen lds
    s_add_u32 s28, s64, 2801664
    s_add_u32 m0, s29, 26624
    s_nop 0
    buffer_load_dwordx4 v6, s[8:11], s28 offen lds
    s_add_u32 m0, s29, 27648
    s_nop 0
    buffer_load_dwordx4 v7, s[8:11], s28 offen lds
    s_waitcnt vmcnt(16)
    s_waitcnt lgkmcnt(0)
    s_barrier
    ds_read_b64_tr_b16 a[12:13], v11 offset:24576
    ds_read_b64_tr_b16 a[14:15], v11 offset:26624
    ds_read_b64_tr_b16 a[92:93], v14 offset:24576
    ds_read_b64_tr_b16 a[94:95], v14 offset:26624
    ds_read_b64_tr_b16 a[172:173], v17 offset:24576
    ds_read_b64_tr_b16 a[174:175], v17 offset:26624
    ds_read_b64_tr_b16 a[252:253], v20 offset:24576
    ds_read_b64_tr_b16 a[254:255], v20 offset:26624
    s_mul_i32 s29, s24, 4096
    s_add_u32 s28, s64, 3145728
    s_add_u32 m0, s29, 49152
    s_nop 0
    buffer_load_dwordx4 v6, s[8:11], s28 offen lds
    s_add_u32 m0, s29, 50176
    s_nop 0
    buffer_load_dwordx4 v7, s[8:11], s28 offen lds
    s_add_u32 s28, s64, 3194880
    s_add_u32 m0, s29, 51200
    s_nop 0
    buffer_load_dwordx4 v6, s[8:11], s28 offen lds
    s_add_u32 m0, s29, 52224
    s_nop 0
    buffer_load_dwordx4 v7, s[8:11], s28 offen lds
    s_waitcnt vmcnt(16)
    s_waitcnt lgkmcnt(0)
    s_barrier
    ds_read_b64_tr_b16 a[16:17], v12 offset:0
    ds_read_b64_tr_b16 a[18:19], v12 offset:2048
    ds_read_b64_tr_b16 a[96:97], v15 offset:0
    ds_read_b64_tr_b16 a[98:99], v15 offset:2048
    ds_read_b64_tr_b16 a[176:177], v18 offset:0
    ds_read_b64_tr_b16 a[178:179], v18 offset:2048
    ds_read_b64_tr_b16 v[192:193], v21 offset:0
    ds_read_b64_tr_b16 v[194:195], v21 offset:2048
    s_mul_i32 s29, s24, 4096
    s_add_u32 s28, s64, 3538944
    s_add_u32 m0, s29, 73728
    s_nop 0
    buffer_load_dwordx4 v6, s[8:11], s28 offen lds
    s_add_u32 m0, s29, 74752
    s_nop 0
    buffer_load_dwordx4 v7, s[8:11], s28 offen lds
    s_add_u32 s28, s64, 3588096
    s_add_u32 m0, s29, 75776
    s_nop 0
    buffer_load_dwordx4 v6, s[8:11], s28 offen lds
    s_add_u32 m0, s29, 76800
    s_nop 0
    buffer_load_dwordx4 v7, s[8:11], s28 offen lds
    s_waitcnt vmcnt(16)
    s_waitcnt lgkmcnt(0)
    s_barrier
    ds_read_b64_tr_b16 a[20:21], v12 offset:24576
    ds_read_b64_tr_b16 a[22:23], v12 offset:26624
    ds_read_b64_tr_b16 a[100:101], v15 offset:24576
    ds_read_b64_tr_b16 a[102:103], v15 offset:26624
    ds_read_b64_tr_b16 a[180:181], v18 offset:24576
    ds_read_b64_tr_b16 a[182:183], v18 offset:26624
    ds_read_b64_tr_b16 v[196:197], v21 offset:24576
    ds_read_b64_tr_b16 v[198:199], v21 offset:26624
    s_mul_i32 s29, s24, 4096
    s_add_u32 s28, s64, 3932160
    s_add_u32 m0, s29, 98304
    s_nop 0
    buffer_load_dwordx4 v6, s[8:11], s28 offen lds
    s_add_u32 m0, s29, 99328
    s_nop 0
    buffer_load_dwordx4 v7, s[8:11], s28 offen lds
    s_add_u32 s28, s64, 3981312
    s_add_u32 m0, s29, 100352
    s_nop 0
    buffer_load_dwordx4 v6, s[8:11], s28 offen lds
    s_add_u32 m0, s29, 101376
    s_nop 0
    buffer_load_dwordx4 v7, s[8:11], s28 offen lds
    s_waitcnt vmcnt(16)
    s_waitcnt lgkmcnt(0)
    s_barrier
    ds_read_b64_tr_b16 a[24:25], v10 offset:0
    ds_read_b64_tr_b16 a[26:27], v10 offset:2048
    ds_read_b64_tr_b16 a[104:105], v13 offset:0
    ds_read_b64_tr_b16 a[106:107], v13 offset:2048
    ds_read_b64_tr_b16 a[184:185], v16 offset:0
    ds_read_b64_tr_b16 a[186:187], v16 offset:2048
    ds_read_b64_tr_b16 v[200:201], v19 offset:0
    ds_read_b64_tr_b16 v[202:203], v19 offset:2048
    s_mul_i32 s29, s24, 4096
    s_add_u32 s28, s64, 4325376
    s_add_u32 m0, s29, 122880
    s_nop 0
    buffer_load_dwordx4 v6, s[8:11], s28 offen lds
    s_add_u32 m0, s29, 123904
    s_nop 0
    buffer_load_dwordx4 v7, s[8:11], s28 offen lds
    s_add_u32 s28, s64, 4374528
    s_add_u32 m0, s29, 124928
    s_nop 0
    buffer_load_dwordx4 v6, s[8:11], s28 offen lds
    s_add_u32 m0, s29, 125952
    s_nop 0
    buffer_load_dwordx4 v7, s[8:11], s28 offen lds
    s_waitcnt vmcnt(16)
    s_waitcnt lgkmcnt(0)
    s_barrier
    ds_read_b64_tr_b16 a[28:29], v10 offset:24576
    ds_read_b64_tr_b16 a[30:31], v10 offset:26624
    ds_read_b64_tr_b16 a[108:109], v13 offset:24576
    ds_read_b64_tr_b16 a[110:111], v13 offset:26624
    ds_read_b64_tr_b16 a[188:189], v16 offset:24576
    ds_read_b64_tr_b16 a[190:191], v16 offset:26624
    ds_read_b64_tr_b16 v[204:205], v19 offset:24576
    ds_read_b64_tr_b16 v[206:207], v19 offset:26624
    s_mul_i32 s29, s24, 4096
    s_add_u32 s28, s64, 4718592
    s_add_u32 m0, s29, 0
    s_nop 0
    buffer_load_dwordx4 v6, s[8:11], s28 offen lds
    s_add_u32 m0, s29, 1024
    s_nop 0
    buffer_load_dwordx4 v7, s[8:11], s28 offen lds
    s_add_u32 s28, s64, 4767744
    s_add_u32 m0, s29, 2048
    s_nop 0
    buffer_load_dwordx4 v6, s[8:11], s28 offen lds
    s_add_u32 m0, s29, 3072
    s_nop 0
    buffer_load_dwordx4 v7, s[8:11], s28 offen lds
    s_waitcnt vmcnt(16)
    s_waitcnt lgkmcnt(0)
    s_barrier
    ds_read_b64_tr_b16 a[32:33], v11 offset:0
    ds_read_b64_tr_b16 a[34:35], v11 offset:2048
    ds_read_b64_tr_b16 a[112:113], v14 offset:0
    ds_read_b64_tr_b16 a[114:115], v14 offset:2048
    ds_read_b64_tr_b16 a[192:193], v17 offset:0
    ds_read_b64_tr_b16 a[194:195], v17 offset:2048
    ds_read_b64_tr_b16 v[208:209], v20 offset:0
    ds_read_b64_tr_b16 v[210:211], v20 offset:2048
    s_mul_i32 s29, s24, 4096
    s_add_u32 s28, s64, 5111808
    s_add_u32 m0, s29, 24576
    s_nop 0
    buffer_load_dwordx4 v6, s[8:11], s28 offen lds
    s_add_u32 m0, s29, 25600
    s_nop 0
    buffer_load_dwordx4 v7, s[8:11], s28 offen lds
    s_add_u32 s28, s64, 5160960
    s_add_u32 m0, s29, 26624
    s_nop 0
    buffer_load_dwordx4 v6, s[8:11], s28 offen lds
    s_add_u32 m0, s29, 27648
    s_nop 0
    buffer_load_dwordx4 v7, s[8:11], s28 offen lds
    s_waitcnt vmcnt(16)
    s_waitcnt lgkmcnt(0)
    s_barrier
    ds_read_b64_tr_b16 a[36:37], v11 offset:24576
    ds_read_b64_tr_b16 a[38:39], v11 offset:26624
    ds_read_b64_tr_b16 a[116:117], v14 offset:24576
    ds_read_b64_tr_b16 a[118:119], v14 offset:26624
    ds_read_b64_tr_b16 a[196:197], v17 offset:24576
    ds_read_b64_tr_b16 a[198:199], v17 offset:26624
    ds_read_b64_tr_b16 v[212:213], v20 offset:24576
    ds_read_b64_tr_b16 v[214:215], v20 offset:26624
    s_mul_i32 s29, s24, 4096
    s_add_u32 s28, s64, 5505024
    s_add_u32 m0, s29, 49152
    s_nop 0
    buffer_load_dwordx4 v6, s[8:11], s28 offen lds
    s_add_u32 m0, s29, 50176
    s_nop 0
    buffer_load_dwordx4 v7, s[8:11], s28 offen lds
    s_add_u32 s28, s64, 5554176
    s_add_u32 m0, s29, 51200
    s_nop 0
    buffer_load_dwordx4 v6, s[8:11], s28 offen lds
    s_add_u32 m0, s29, 52224
    s_nop 0
    buffer_load_dwordx4 v7, s[8:11], s28 offen lds
    s_waitcnt vmcnt(16)
    s_waitcnt lgkmcnt(0)
    s_barrier
    ds_read_b64_tr_b16 a[40:41], v12 offset:0
    ds_read_b64_tr_b16 a[42:43], v12 offset:2048
    ds_read_b64_tr_b16 a[120:121], v15 offset:0
    ds_read_b64_tr_b16 a[122:123], v15 offset:2048
    ds_read_b64_tr_b16 a[200:201], v18 offset:0
    ds_read_b64_tr_b16 a[202:203], v18 offset:2048
    ds_read_b64_tr_b16 v[216:217], v21 offset:0
    ds_read_b64_tr_b16 v[218:219], v21 offset:2048
    s_mul_i32 s29, s24, 4096
    s_add_u32 s28, s64, 5898240
    s_add_u32 m0, s29, 73728
    s_nop 0
    buffer_load_dwordx4 v6, s[8:11], s28 offen lds
    s_add_u32 m0, s29, 74752
    s_nop 0
    buffer_load_dwordx4 v7, s[8:11], s28 offen lds
    s_add_u32 s28, s64, 5947392
    s_add_u32 m0, s29, 75776
    s_nop 0
    buffer_load_dwordx4 v6, s[8:11], s28 offen lds
    s_add_u32 m0, s29, 76800
    s_nop 0
    buffer_load_dwordx4 v7, s[8:11], s28 offen lds
    s_waitcnt vmcnt(16)
    s_waitcnt lgkmcnt(0)
    s_barrier
    ds_read_b64_tr_b16 a[44:45], v12 offset:24576
    ds_read_b64_tr_b16 a[46:47], v12 offset:26624
    ds_read_b64_tr_b16 a[124:125], v15 offset:24576
    ds_read_b64_tr_b16 a[126:127], v15 offset:26624
    ds_read_b64_tr_b16 a[204:205], v18 offset:24576
    ds_read_b64_tr_b16 a[206:207], v18 offset:26624
    ds_read_b64_tr_b16 v[220:221], v21 offset:24576
    ds_read_b64_tr_b16 v[222:223], v21 offset:26624
    s_mul_i32 s29, s24, 4096
    s_add_u32 s28, s64, 6291456
    s_add_u32 m0, s29, 98304
    s_nop 0
    buffer_load_dwordx4 v6, s[8:11], s28 offen lds
    s_add_u32 m0, s29, 99328
    s_nop 0
    buffer_load_dwordx4 v7, s[8:11], s28 offen lds
    s_add_u32 s28, s64, 6340608
    s_add_u32 m0, s29, 100352
    s_nop 0
    buffer_load_dwordx4 v6, s[8:11], s28 offen lds
    s_add_u32 m0, s29, 101376
    s_nop 0
    buffer_load_dwordx4 v7, s[8:11], s28 offen lds
    s_waitcnt vmcnt(16)
    s_waitcnt lgkmcnt(0)
    s_barrier
    ds_read_b64_tr_b16 a[48:49], v10 offset:0
    ds_read_b64_tr_b16 a[50:51], v10 offset:2048
    ds_read_b64_tr_b16 a[128:129], v13 offset:0
    ds_read_b64_tr_b16 a[130:131], v13 offset:2048
    ds_read_b64_tr_b16 a[208:209], v16 offset:0
    ds_read_b64_tr_b16 a[210:211], v16 offset:2048
    ds_read_b64_tr_b16 v[224:225], v19 offset:0
    ds_read_b64_tr_b16 v[226:227], v19 offset:2048
    s_mul_i32 s29, s24, 4096
    s_add_u32 s28, s64, 6684672
    s_add_u32 m0, s29, 122880
    s_nop 0
    buffer_load_dwordx4 v6, s[8:11], s28 offen lds
    s_add_u32 m0, s29, 123904
    s_nop 0
    buffer_load_dwordx4 v7, s[8:11], s28 offen lds
    s_add_u32 s28, s64, 6733824
    s_add_u32 m0, s29, 124928
    s_nop 0
    buffer_load_dwordx4 v6, s[8:11], s28 offen lds
    s_add_u32 m0, s29, 125952
    s_nop 0
    buffer_load_dwordx4 v7, s[8:11], s28 offen lds
    s_waitcnt vmcnt(16)
    s_waitcnt lgkmcnt(0)
    s_barrier
    ds_read_b64_tr_b16 a[52:53], v10 offset:24576
    ds_read_b64_tr_b16 a[54:55], v10 offset:26624
    ds_read_b64_tr_b16 a[132:133], v13 offset:24576
    ds_read_b64_tr_b16 a[134:135], v13 offset:26624
    ds_read_b64_tr_b16 a[212:213], v16 offset:24576
    ds_read_b64_tr_b16 a[214:215], v16 offset:26624
    ds_read_b64_tr_b16 v[228:229], v19 offset:24576
    ds_read_b64_tr_b16 v[230:231], v19 offset:26624
    s_mul_i32 s29, s24, 4096
    s_add_u32 s28, s64, 7077888
    s_add_u32 m0, s29, 0
    s_nop 0
    buffer_load_dwordx4 v6, s[8:11], s28 offen lds
    s_add_u32 m0, s29, 1024
    s_nop 0
    buffer_load_dwordx4 v7, s[8:11], s28 offen lds
    s_add_u32 s28, s64, 7127040
    s_add_u32 m0, s29, 2048
    s_nop 0
    buffer_load_dwordx4 v6, s[8:11], s28 offen lds
    s_add_u32 m0, s29, 3072
    s_nop 0
    buffer_load_dwordx4 v7, s[8:11], s28 offen lds
    s_waitcnt vmcnt(16)
    s_waitcnt lgkmcnt(0)
    s_barrier
    ds_read_b64_tr_b16 a[56:57], v11 offset:0
    ds_read_b64_tr_b16 a[58:59], v11 offset:2048
    ds_read_b64_tr_b16 a[136:137], v14 offset:0
    ds_read_b64_tr_b16 a[138:139], v14 offset:2048
    ds_read_b64_tr_b16 a[216:217], v17 offset:0
    ds_read_b64_tr_b16 a[218:219], v17 offset:2048
    ds_read_b64_tr_b16 v[232:233], v20 offset:0
    ds_read_b64_tr_b16 v[234:235], v20 offset:2048
    s_mul_i32 s29, s24, 4096
    s_add_u32 s28, s64, 7471104
    s_add_u32 m0, s29, 24576
    s_nop 0
    buffer_load_dwordx4 v6, s[8:11], s28 offen lds
    s_add_u32 m0, s29, 25600
    s_nop 0
    buffer_load_dwordx4 v7, s[8:11], s28 offen lds
    s_add_u32 s28, s64, 7520256
    s_add_u32 m0, s29, 26624
    s_nop 0
    buffer_load_dwordx4 v6, s[8:11], s28 offen lds
    s_add_u32 m0, s29, 27648
    s_nop 0
    buffer_load_dwordx4 v7, s[8:11], s28 offen lds
    s_waitcnt vmcnt(16)
    s_waitcnt lgkmcnt(0)
    s_barrier
    ds_read_b64_tr_b16 a[60:61], v11 offset:24576
    ds_read_b64_tr_b16 a[62:63], v11 offset:26624
    ds_read_b64_tr_b16 a[140:141], v14 offset:24576
    ds_read_b64_tr_b16 a[142:143], v14 offset:26624
    ds_read_b64_tr_b16 a[220:221], v17 offset:24576
    ds_read_b64_tr_b16 a[222:223], v17 offset:26624
    ds_read_b64_tr_b16 v[236:237], v20 offset:24576
    ds_read_b64_tr_b16 v[238:239], v20 offset:26624
    s_waitcnt vmcnt(12)
    s_waitcnt lgkmcnt(0)
    s_barrier
    ds_read_b64_tr_b16 a[64:65], v12 offset:0
    ds_read_b64_tr_b16 a[66:67], v12 offset:2048
    ds_read_b64_tr_b16 a[144:145], v15 offset:0
    ds_read_b64_tr_b16 a[146:147], v15 offset:2048
    ds_read_b64_tr_b16 a[224:225], v18 offset:0
    ds_read_b64_tr_b16 a[226:227], v18 offset:2048
    ds_read_b64_tr_b16 v[240:241], v21 offset:0
    ds_read_b64_tr_b16 v[242:243], v21 offset:2048
    s_waitcnt vmcnt(8)
    s_waitcnt lgkmcnt(0)
    s_barrier
    ds_read_b64_tr_b16 a[68:69], v12 offset:24576
    ds_read_b64_tr_b16 a[70:71], v12 offset:26624
    ds_read_b64_tr_b16 a[148:149], v15 offset:24576
    ds_read_b64_tr_b16 a[150:151], v15 offset:26624
    ds_read_b64_tr_b16 a[228:229], v18 offset:24576
    ds_read_b64_tr_b16 a[230:231], v18 offset:26624
    ds_read_b64_tr_b16 v[244:245], v21 offset:24576
    ds_read_b64_tr_b16 v[246:247], v21 offset:26624
    buffer_load_dwordx2 v[2:3], off, s[16:19], 0 offset:128 sc1
    s_waitcnt vmcnt(5)
    s_waitcnt lgkmcnt(0)
    s_barrier
    ds_read_b64_tr_b16 a[72:73], v10 offset:0
    ds_read_b64_tr_b16 a[74:75], v10 offset:2048
    ds_read_b64_tr_b16 a[152:153], v13 offset:0
    ds_read_b64_tr_b16 a[154:155], v13 offset:2048
    ds_read_b64_tr_b16 a[232:233], v16 offset:0
    ds_read_b64_tr_b16 a[234:235], v16 offset:2048
    ds_read_b64_tr_b16 v[248:249], v19 offset:0
    ds_read_b64_tr_b16 v[250:251], v19 offset:2048
    s_waitcnt vmcnt(1)
    s_waitcnt lgkmcnt(0)
    s_barrier
    ds_read_b64_tr_b16 a[76:77], v10 offset:24576
    ds_read_b64_tr_b16 a[78:79], v10 offset:26624
    ds_read_b64_tr_b16 a[156:157], v13 offset:24576
    ds_read_b64_tr_b16 a[158:159], v13 offset:26624
    ds_read_b64_tr_b16 a[236:237], v16 offset:24576
    ds_read_b64_tr_b16 a[238:239], v16 offset:26624
    ds_read_b64_tr_b16 v[252:253], v19 offset:24576
    ds_read_b64_tr_b16 v[254:255], v19 offset:26624
    s_waitcnt vmcnt(0) lgkmcnt(0)
    s_barrier
    v_lshlrev_b32 v22, 4, v1
    v_mov_b32 v23, v22
    s_mov_b32 s32, 0
Lws_33:
    v_readfirstlane_b32 s28, v2
    s_nop 0
    s_cmp_eq_u32 s28, 0
    s_cbranch_scc1 Lretry_34
    s_mul_i32 s65, s25, 16384
    s_mul_i32 s28, s24, 4096
    s_add_u32 s65, s65, s28
    s_add_u32 s65, s65, 29360128
    s_mov_b32 s67, 536870912
    s_mov_b32 s26, 0
    s_mov_b32 s27, 0
    s_mul_i32 s30, s26, 40960
    s_mul_i32 s31, s24, 10240
    s_add_u32 s30, s30, s31
    s_add_u32 s31, s31, s27
    s_add_u32 m0, s31, 0
    s_nop 0
    buffer_load_dwordx4 v22, s[4:7], s30 offen offset:0 sc1 lds
    buffer_load_dwordx4 v22, s[4:7], s30 offen offset:1024 sc1 lds
    buffer_load_dwordx4 v22, s[4:7], s30 offen offset:2048 sc1 lds
    buffer_load_dwordx4 v22, s[4:7], s30 offen offset:3072 sc1 lds
    s_add_u32 m0, s31, 4096
    s_add_u32 s30, s30, 4096
    buffer_load_dwordx4 v22, s[4:7], s30 offen offset:0 sc1 lds
    buffer_load_dwordx4 v22, s[4:7], s30 offen offset:1024 sc1 lds
    buffer_load_dwordx4 v22, s[4:7], s30 offen offset:2048 sc1 lds
    buffer_load_dwordx4 v22, s[4:7], s30 offen offset:3072 sc1 lds
    s_add_u32 m0, s31, 8192
    s_add_u32 s30, s30, 4096
    buffer_load_dwordx4 v22, s[4:7], s30 offen offset:0 sc1 lds
    buffer_load_dwordx4 v22, s[4:7], s30 offen offset:1024 sc1 lds
    s_waitcnt vmcnt(0)
    s_barrier
    ds_read_b128 v[24:27], v23 offset:0
    ds_read_b128 v[28:31], v23 offset:20480
    ds_read_b128 v[32:35], v23 offset:1024
    ds_read_b128 v[36:39], v23 offset:21504
    ds_read_b128 v[40:43], v23 offset:2048
    ds_read_b128 v[44:47], v23 offset:22528
.p2align 6
LV_top:
    s_add_u32 s66, s26, 1
    s_min_u32 s66, s66, 63
    s_add_u32 s27, s27, 40960
    s_cmp_ge_u32 s27, 122880
    s_cselect_b32 s27, 0, s27
    s_mul_i32 s30, s66, 40960
    s_mul_i32 s31, s24, 10240
    s_add_u32 s30, s30, s31
    s_add_u32 s31, s31, s27
    s_waitcnt lgkmcnt(4)
    v_mfma_f32_16x16x32_bf16 v[56:59], a[0:3], v[24:27], 0
    v_mfma_f32_16x16x32_bf16 v[64:67], a[80:83], v[24:27], 0
    buffer_store_dwordx4 v[88:91], v22, s[4:7], s67 offen offset:0 sc1
    v_mfma_f32_16x16x32_bf16 v[72:75], a[160:163], v[24:27], 0
    v_mfma_f32_16x16x32_bf16 v[80:83], a[240:243], v[24:27], 0
    ds_read_b128 v[48:51], v23 offset:3072
    ds_read_b128 v[52:55], v23 offset:23552
    v_mfma_f32_16x16x32_bf16 v[60:63], a[0:3], v[28:31], 0
    s_add_u32 m0, s31, 0
    s_nop 0
    buffer_load_dwordx4 v22, s[4:7], s30 offen offset:0 sc1 lds
    v_mfma_f32_16x16x32_bf16 v[68:71], a[80:83], v[28:31], 0
    v_mfma_f32_16x16x32_bf16 v[76:79], a[160:163], v[28:31], 0
    v_mfma_f32_16x16x32_bf16 v[84:87], a[240:243], v[28:31], 0
    s_waitcnt lgkmcnt(4)
    v_mfma_f32_16x16x32_bf16 v[56:59], a[4:7], v[32:35], v[56:59]
    v_mfma_f32_16x16x32_bf16 v[64:67], a[84:87], v[32:35], v[64:67]
    buffer_store_dwordx4 v[92:95], v22, s[4:7], s67 offen offset:1024 sc1
    v_mfma_f32_16x16x32_bf16 v[72:75], a[164:167], v[32:35], v[72:75]
    v_mfma_f32_16x16x32_bf16 v[80:83], a[244:247], v[32:35], v[80:83]
    ds_read_b128 v[24:27], v23 offset:4096
    ds_read_b128 v[28:31], v23 offset:24576
    v_mfma_f32_16x16x32_bf16 v[60:63], a[4:7], v[36:39], v[60:63]
    buffer_load_dwordx4 v22, s[4:7], s30 offen offset:1024 sc1 lds
    v_mfma_f32_16x16x32_bf16 v[68:71], a[84:87], v[36:39], v[68:71]
    v_mfma_f32_16x16x32_bf16 v[76:79], a[164:167], v[36:39], v[76:79]
    v_mfma_f32_16x16x32_bf16 v[84:87], a[244:247], v[36:39], v[84:87]
    s_waitcnt lgkmcnt(4)
    v_mfma_f32_16x16x32_bf16 v[56:59], a[8:11], v[40:43], v[56:59]
    v_mfma_f32_16x16x32_bf16 v[64:67], a[88:91], v[40:43], v[64:67]
    buffer_store_dwordx4 v[96:99], v22, s[4:7], s67 offen offset:2048 sc1
    v_mfma_f32_16x16x32_bf16 v[72:75], a[168:171], v[40:43], v[72:75]
    v_mfma_f32_16x16x32_bf16 v[80:83], a[248:251], v[40:43], v[80:83]
    ds_read_b128 v[32:35], v23 offset:5120
    ds_read_b128 v[36:39], v23 offset:25600
    v_mfma_f32_16x16x32_bf16 v[60:63], a[8:11], v[44:47], v[60:63]
    buffer_load_dwordx4 v22, s[4:7], s30 offen offset:2048 sc1 lds
    v_mfma_f32_16x16x32_bf16 v[68:71], a[88:91], v[44:47], v[68:71]
    v_mfma_f32_16x16x32_bf16 v[76:79], a[168:171], v[44:47], v[76:79]
    v_mfma_f32_16x16x32_bf16 v[84:87], a[248:251], v[44:47], v[84:87]
    s_waitcnt lgkmcnt(4)
    v_mfma_f32_16x16x32_bf16 v[56:59], a[12:15], v[48:51], v[56:59]
    v_mfma_f32_16x16x32_bf16 v[64:67], a[92:95], v[48:51], v[64:67]
    buffer_store_dwordx4 v[100:103], v22, s[4:7], s67 offen offset:3072 sc1
    v_mfma_f32_16x16x32_bf16 v[72:75], a[172:175], v[48:51], v[72:75]
    v_mfma_f32_16x16x32_bf16 v[80:83], a[252:255], v[48:51], v[80:83]
    ds_read_b128 v[40:43], v23 offset:6144
    ds_read_b128 v[44:47], v23 offset:26624
    v_mfma_f32_16x16x32_bf16 v[60:63], a[12:15], v[52:55], v[60:63]
    buffer_load_dwordx4 v22, s[4:7], s30 offen offset:3072 sc1 lds
    v_mfma_f32_16x16x32_bf16 v[68:71], a[92:95], v[52:55], v[68:71]
    v_mfma_f32_16x16x32_bf16 v[76:79], a[172:175], v[52:55], v[76:79]
    v_mfma_f32_16x16x32_bf16 v[84:87], a[252:255], v[52:55], v[84:87]
    s_waitcnt lgkmcnt(4)
    v_mfma_f32_16x16x32_bf16 v[56:59], a[16:19], v[24:27], v[56:59]
    v_mfma_f32_16x16x32_bf16 v[64:67], a[96:99], v[24:27], v[64:67]
    v_mfma_f32_16x16x32_bf16 v[72:75], a[176:179], v[24:27], v[72:75]
    v_mfma_f32_16x16x32_bf16 v[80:83], v[192:195], v[24:27], v[80:83]
    ds_read_b128 v[48:51], v23 offset:7168
    ds_read_b128 v[52:55], v23 offset:27648
    v_mfma_f32_16x16x32_bf16 v[60:63], a[16:19], v[28:31], v[60:63]
    s_add_u32 m0, s31, 4096
    s_add_u32 s30, s30, 4096
    buffer_load_dwordx4 v22, s[4:7], s30 offen offset:0 sc1 lds
    v_mfma_f32_16x16x32_bf16 v[68:71], a[96:99], v[28:31], v[68:71]
    v_mfma_f32_16x16x32_bf16 v[76:79], a[176:179], v[28:31], v[76:79]
    v_mfma_f32_16x16x32_bf16 v[84:87], v[192:195], v[28:31], v[84:87]
    s_waitcnt lgkmcnt(4)
    v_mfma_f32_16x16x32_bf16 v[56:59], a[20:23], v[32:35], v[56:59]
    v_mfma_f32_16x16x32_bf16 v[64:67], a[100:103], v[32:35], v[64:67]
    v_mfma_f32_16x16x32_bf16 v[72:75], a[180:183], v[32:35], v[72:75]
    v_mfma_f32_16x16x32_bf16 v[80:83], v[196:199], v[32:35], v[80:83]
    ds_read_b128 v[24:27], v23 offset:8192
    ds_read_b128 v[28:31], v23 offset:28672
    v_mfma_f32_16x16x32_bf16 v[60:63], a[20:23], v[36:39], v[60:63]
    buffer_load_dwordx4 v22, s[4:7], s30 offen offset:1024 sc1 lds
    v_mfma_f32_16x16x32_bf16 v[68:71], a[100:103], v[36:39], v[68:71]
    v_mfma_f32_16x16x32_bf16 v[76:79], a[180:183], v[36:39], v[76:79]
    v_mfma_f32_16x16x32_bf16 v[84:87], v[196:199], v[36:39], v[84:87]
    s_waitcnt lgkmcnt(4)
    v_mfma_f32_16x16x32_bf16 v[56:59], a[24:27], v[40:43], v[56:59]
    v_mfma_f32_16x16x32_bf16 v[64:67], a[104:107], v[40:43], v[64:67]
    v_mfma_f32_16x16x32_bf16 v[72:75], a[184:187], v[40:43], v[72:75]
    v_mfma_f32_16x16x32_bf16 v[80:83], v[200:203], v[40:43], v[80:83]
    ds_read_b128 v[32:35], v23 offset:9216
    ds_read_b128 v[36:39], v23 offset:29696
    v_mfma_f32_16x16x32_bf16 v[60:63], a[24:27], v[44:47], v[60:63]
    buffer_load_dwordx4 v22, s[4:7], s30 offen offset:2048 sc1 lds
    v_mfma_f32_16x16x32_bf16 v[68:71], a[104:107], v[44:47], v[68:71]
    v_mfma_f32_16x16x32_bf16 v[76:79], a[184:187], v[44:47], v[76:79]
    v_mfma_f32_16x16x32_bf16 v[84:87], v[200:203], v[44:47], v[84:87]
    s_waitcnt lgkmcnt(4)
    v_mfma_f32_16x16x32_bf16 v[56:59], a[28:31], v[48:51], v[56:59]
    v_mfma_f32_16x16x32_bf16 v[64:67], a[108:111], v[48:51], v[64:67]
    v_mfma_f32_16x16x32_bf16 v[72:75], a[188:191], v[48:51], v[72:75]
    v_mfma_f32_16x16x32_bf16 v[80:83], v[204:207], v[48:51], v[80:83]
    ds_read_b128 v[40:43], v23 offset:10240
    ds_read_b128 v[44:47], v23 offset:30720
    v_mfma_f32_16x16x32_bf16 v[60:63], a[28:31], v[52:55], v[60:63]
    buffer_load_dwordx4 v22, s[4:7], s30 offen offset:3072 sc1 lds
    v_mfma_f32_16x16x32_bf16 v[68:71], a[108:111], v[52:55], v[68:71]
    v_mfma_f32_16x16x32_bf16 v[76:79], a[188:191], v[52:55], v[76:79]
    v_mfma_f32_16x16x32_bf16 v[84:87], v[204:207], v[52:55], v[84:87]
    s_waitcnt lgkmcnt(4)
    v_mfma_f32_16x16x32_bf16 v[56:59], a[32:35], v[24:27], v[56:59]
    v_mfma_f32_16x16x32_bf16 v[64:67], a[112:115], v[24:27], v[64:67]
    v_mfma_f32_16x16x32_bf16 v[72:75], a[192:195], v[24:27], v[72:75]
    v_mfma_f32_16x16x32_bf16 v[80:83], v[208:211], v[24:27], v[80:83]
    ds_read_b128 v[48:51], v23 offset:11264
    ds_read_b128 v[52:55], v23 offset:31744
    v_mfma_f32_16x16x32_bf16 v[60:63], a[32:35], v[28:31], v[60:63]
    s_add_u32 m0, s31, 8192
    s_add_u32 s30, s30, 4096
    buffer_load_dwordx4 v22, s[4:7], s30 offen offset:0 sc1 lds
    v_mfma_f32_16x16x32_bf16 v[68:71], a[112:115], v[28:31], v[68:71]
    v_mfma_f32_16x16x32_bf16 v[76:79], a[192:195], v[28:31], v[76:79]
    v_mfma_f32_16x16x32_bf16 v[84:87], v[208:211], v[28:31], v[84:87]
    s_waitcnt lgkmcnt(4)
    v_mfma_f32_16x16x32_bf16 v[56:59], a[36:39], v[32:35], v[56:59]
    v_mfma_f32_16x16x32_bf16 v[64:67], a[116:119], v[32:35], v[64:67]
    v_mfma_f32_16x16x32_bf16 v[72:75], a[196:199], v[32:35], v[72:75]
    v_mfma_f32_16x16x32_bf16 v[80:83], v[212:215], v[32:35], v[80:83]
    ds_read_b128 v[24:27], v23 offset:12288
    ds_read_b128 v[28:31], v23 offset:32768
    v_mfma_f32_16x16x32_bf16 v[60:63], a[36:39], v[36:39], v[60:63]
    buffer_load_dwordx4 v22, s[4:7], s30 offen offset:1024 sc1 lds
    v_mfma_f32_16x16x32_bf16 v[68:71], a[116:119], v[36:39], v[68:71]
    v_mfma_f32_16x16x32_bf16 v[76:79], a[196:199], v[36:39], v[76:79]
    v_mfma_f32_16x16x32_bf16 v[84:87], v[212:215], v[36:39], v[84:87]
    s_waitcnt lgkmcnt(4)
    v_mfma_f32_16x16x32_bf16 v[56:59], a[40:43], v[40:43], v[56:59]
    v_mfma_f32_16x16x32_bf16 v[64:67], a[120:123], v[40:43], v[64:67]
    v_mfma_f32_16x16x32_bf16 v[72:75], a[200:203], v[40:43], v[72:75]
    v_mfma_f32_16x16x32_bf16 v[80:83], v[216:219], v[40:43], v[80:83]
    ds_read_b128 v[32:35], v23 offset:13312
    ds_read_b128 v[36:39], v23 offset:33792
    v_mfma_f32_16x16x32_bf16 v[60:63], a[40:43], v[44:47], v[60:63]
    v_mfma_f32_16x16x32_bf16 v[68:71], a[120:123], v[44:47], v[68:71]
    v_mfma_f32_16x16x32_bf16 v[76:79], a[200:203], v[44:47], v[76:79]
    v_mfma_f32_16x16x32_bf16 v[84:87], v[216:219], v[44:47], v[84:87]
    s_waitcnt lgkmcnt(4)
    v_mfma_f32_16x16x32_bf16 v[56:59], a[44:47], v[48:51], v[56:59]
    v_mfma_f32_16x16x32_bf16 v[64:67], a[124:127], v[48:51], v[64:67]
    v_mfma_f32_16x16x32_bf16 v[72:75], a[204:207], v[48:51], v[72:75]
    v_mfma_f32_16x16x32_bf16 v[80:83], v[220:223], v[48:51], v[80:83]
    ds_read_b128 v[40:43], v23 offset:14336
    ds_read_b128 v[44:47], v23 offset:34816
    v_mfma_f32_16x16x32_bf16 v[60:63], a[44:47], v[52:55], v[60:63]
    v_mfma_f32_16x16x32_bf16 v[68:71], a[124:127], v[52:55], v[68:71]
    v_mfma_f32_16x16x32_bf16 v[76:79], a[204:207], v[52:55], v[76:79]
    v_mfma_f32_16x16x32_bf16 v[84:87], v[220:223], v[52:55], v[84:87]
    s_waitcnt lgkmcnt(4)
    v_mfma_f32_16x16x32_bf16 v[56:59], a[48:51], v[24:27], v[56:59]
    v_mfma_f32_16x16x32_bf16 v[64:67], a[128:131], v[24:27], v[64:67]
    v_mfma_f32_16x16x32_bf16 v[72:75], a[208:211], v[24:27], v[72:75]
    v_mfma_f32_16x16x32_bf16 v[80:83], v[224:227], v[24:27], v[80:83]
    ds_read_b128 v[48:51], v23 offset:15360
    ds_read_b128 v[52:55], v23 offset:35840
    v_mfma_f32_16x16x32_bf16 v[60:63], a[48:51], v[28:31], v[60:63]
    v_mfma_f32_16x16x32_bf16 v[68:71], a[128:131], v[28:31], v[68:71]
    v_mfma_f32_16x16x32_bf16 v[76:79], a[208:211], v[28:31], v[76:79]
    v_mfma_f32_16x16x32_bf16 v[84:87], v[224:227], v[28:31], v[84:87]
    s_waitcnt lgkmcnt(4)
    v_mfma_f32_16x16x32_bf16 v[56:59], a[52:55], v[32:35], v[56:59]
    v_mfma_f32_16x16x32_bf16 v[64:67], a[132:135], v[32:35], v[64:67]
    v_mfma_f32_16x16x32_bf16 v[72:75], a[212:215], v[32:35], v[72:75]
    v_mfma_f32_16x16x32_bf16 v[80:83], v[228:231], v[32:35], v[80:83]
    ds_read_b128 v[24:27], v23 offset:16384
    ds_read_b128 v[28:31], v23 offset:36864
    v_mfma_f32_16x16x32_bf16 v[60:63], a[52:55], v[36:39], v[60:63]
    v_mfma_f32_16x16x32_bf16 v[68:71], a[132:135], v[36:39], v[68:71]
    v_mfma_f32_16x16x32_bf16 v[76:79], a[212:215], v[36:39], v[76:79]
    v_mfma_f32_16x16x32_bf16 v[84:87], v[228:231], v[36:39], v[84:87]
    s_waitcnt lgkmcnt(4)
    v_mfma_f32_16x16x32_bf16 v[56:59], a[56:59], v[40:43], v[56:59]
    v_mfma_f32_16x16x32_bf16 v[64:67], a[136:139], v[40:43], v[64:67]
    v_mfma_f32_16x16x32_bf16 v[72:75], a[216:219], v[40:43], v[72:75]
    v_mfma_f32_16x16x32_bf16 v[80:83], v[232:235], v[40:43], v[80:83]
    ds_read_b128 v[32:35], v23 offset:17408
    ds_read_b128 v[36:39], v23 offset:37888
    v_mfma_f32_16x16x32_bf16 v[60:63], a[56:59], v[44:47], v[60:63]
    v_mfma_f32_16x16x32_bf16 v[68:71], a[136:139], v[44:47], v[68:71]
    v_mfma_f32_16x16x32_bf16 v[76:79], a[216:219], v[44:47], v[76:79]
    v_mfma_f32_16x16x32_bf16 v[84:87], v[232:235], v[44:47], v[84:87]
    s_waitcnt lgkmcnt(4)
    v_mfma_f32_16x16x32_bf16 v[56:59], a[60:63], v[48:51], v[56:59]
    v_mfma_f32_16x16x32_bf16 v[64:67], a[140:143], v[48:51], v[64:67]
    v_mfma_f32_16x16x32_bf16 v[72:75], a[220:223], v[48:51], v[72:75]
    v_mfma_f32_16x16x32_bf16 v[80:83], v[236:239], v[48:51], v[80:83]
    ds_read_b128 v[40:43], v23 offset:18432
    ds_read_b128 v[44:47], v23 offset:38912
    v_mfma_f32_16x16x32_bf16 v[60:63], a[60:63], v[52:55], v[60:63]
    v_mfma_f32_16x16x32_bf16 v[68:71], a[140:143], v[52:55], v[68:71]
    v_mfma_f32_16x16x32_bf16 v[76:79], a[220:223], v[52:55], v[76:79]
    v_mfma_f32_16x16x32_bf16 v[84:87], v[236:239], v[52:55], v[84:87]
    s_waitcnt vmcnt(7)
    v_mov_b32 v2, s26
    s_mov_b64 exec, 1
    buffer_store_dword v2, off, s[4:7], s35 sc1
    s_mov_b64 exec, -1
    s_waitcnt lgkmcnt(4)
    v_mfma_f32_16x16x32_bf16 v[56:59], a[64:67], v[24:27], v[56:59]
    v_mfma_f32_16x16x32_bf16 v[64:67], a[144:147], v[24:27], v[64:67]
    v_mfma_f32_16x16x32_bf16 v[72:75], a[224:227], v[24:27], v[72:75]
    v_mfma_f32_16x16x32_bf16 v[80:83], v[240:243], v[24:27], v[80:83]
    ds_read_b128 v[48:51], v23 offset:19456
    ds_read_b128 v[52:55], v23 offset:39936
    v_mfma_f32_16x16x32_bf16 v[60:63], a[64:67], v[28:31], v[60:63]
    v_mfma_f32_16x16x32_bf16 v[68:71], a[144:147], v[28:31], v[68:71]
    v_mfma_f32_16x16x32_bf16 v[76:79], a[224:227], v[28:31], v[76:79]
    v_mfma_f32_16x16x32_bf16 v[84:87], v[240:243], v[28:31], v[84:87]
    s_waitcnt lgkmcnt(4)
    v_mfma_f32_16x16x32_bf16 v[56:59], a[68:71], v[32:35], v[56:59]
    v_mfma_f32_16x16x32_bf16 v[64:67], a[148:151], v[32:35], v[64:67]
    v_mfma_f32_16x16x32_bf16 v[72:75], a[228:231], v[32:35], v[72:75]
    v_mfma_f32_16x16x32_bf16 v[80:83], v[244:247], v[32:35], v[80:83]
    s_waitcnt vmcnt(1)
    s_barrier
    v_add_u32 v23, s27, v22
    ds_read_b128 v[24:27], v23 offset:0
    ds_read_b128 v[28:31], v23 offset:20480
    v_mfma_f32_16x16x32_bf16 v[60:63], a[68:71], v[36:39], v[60:63]
    v_mfma_f32_16x16x32_bf16 v[68:71], a[148:151], v[36:39], v[68:71]
    v_mfma_f32_16x16x32_bf16 v[76:79], a[228:231], v[36:39], v[76:79]
    v_mfma_f32_16x16x32_bf16 v[84:87], v[244:247], v[36:39], v[84:87]
    s_waitcnt lgkmcnt(4)
    v_mfma_f32_16x16x32_bf16 v[56:59], a[72:75], v[40:43], v[56:59]
    v_mfma_f32_16x16x32_bf16 v[64:67], a[152:155], v[40:43], v[64:67]
    v_mfma_f32_16x16x32_bf16 v[72:75], a[232:235], v[40:43], v[72:75]
    v_mfma_f32_16x16x32_bf16 v[80:83], v[248:251], v[40:43], v[80:83]
    ds_read_b128 v[32:35], v23 offset:1024
    ds_read_b128 v[36:39], v23 offset:21504
    v_mfma_f32_16x16x32_bf16 v[60:63], a[72:75], v[44:47], v[60:63]
    v_mfma_f32_16x16x32_bf16 v[68:71], a[152:155], v[44:47], v[68:71]
    v_mfma_f32_16x16x32_bf16 v[76:79], a[232:235], v[44:47], v[76:79]
    v_mfma_f32_16x16x32_bf16 v[84:87], v[248:251], v[44:47], v[84:87]
    s_waitcnt lgkmcnt(4)
    v_mfma_f32_16x16x32_bf16 v[56:59], a[76:79], v[48:51], v[56:59]
    v_mfma_f32_16x16x32_bf16 v[64:67], a[156:159], v[48:51], v[64:67]
    v_mfma_f32_16x16x32_bf16 v[72:75], a[236:239], v[48:51], v[72:75]
    v_mfma_f32_16x16x32_bf16 v[80:83], v[252:255], v[48:51], v[80:83]
    ds_read_b128 v[40:43], v23 offset:2048
    ds_read_b128 v[44:47], v23 offset:22528
    v_mfma_f32_16x16x32_bf16 v[60:63], a[76:79], v[52:55], v[60:63]
    v_mfma_f32_16x16x32_bf16 v[68:71], a[156:159], v[52:55], v[68:71]
    v_mfma_f32_16x16x32_bf16 v[76:79], a[236:239], v[52:55], v[76:79]
    v_mfma_f32_16x16x32_bf16 v[84:87], v[252:255], v[52:55], v[84:87]
    v_cvt_pk_bf16_f32 v88, v56, v57
    v_cvt_pk_bf16_f32 v89, v58, v59
    v_cvt_pk_bf16_f32 v90, v60, v61
    v_cvt_pk_bf16_f32 v91, v62, v63
    v_cvt_pk_bf16_f32 v92, v64, v65
    v_cvt_pk_bf16_f32 v93, v66, v67
    v_cvt_pk_bf16_f32 v94, v68, v69
    v_cvt_pk_bf16_f32 v95, v70, v71
    v_cvt_pk_bf16_f32 v96, v72, v73
    v_cvt_pk_bf16_f32 v97, v74, v75
    v_cvt_pk_bf16_f32 v98, v76, v77
    v_cvt_pk_bf16_f32 v99, v78, v79
    v_cvt_pk_bf16_f32 v100, v80, v81
    v_cvt_pk_bf16_f32 v101, v82, v83
    v_cvt_pk_bf16_f32 v102, v84, v85
    v_cvt_pk_bf16_f32 v103, v86, v87
    s_mov_b32 s67, s65
    s_add_u32 s65, s65, 393216
    s_sub_u32 s28, s26, 1
    s_add_u32 s26, s26, 1
    s_cmp_lt_u32 s28, 62
    s_cbranch_scc1 LV_top
    buffer_store_dwordx4 v[88:91], v22, s[4:7], s67 offen offset:0 sc1
    buffer_store_dwordx4 v[92:95], v22, s[4:7], s67 offen offset:1024 sc1
    buffer_store_dwordx4 v[96:99], v22, s[4:7], s67 offen offset:2048 sc1
    buffer_store_dwordx4 v[100:103], v22, s[4:7], s67 offen offset:3072 sc1
    s_mov_b32 s67, 536870912
    s_waitcnt vmcnt(0)
    v_mov_b32 v2, s26
    s_mov_b64 exec, 1
    buffer_store_dword v2, off, s[4:7], s35 sc1
    s_mov_b64 exec, -1
    s_cmp_lt_u32 s26, 64
    s_cbranch_scc1 LV_top
    s_endpgm
Lretry_34:
    s_sleep 6
    buffer_load_dwordx2 v[2:3], off, s[16:19], 0 offset:128 sc1
    s_waitcnt vmcnt(0)
    s_add_u32 s32, s32, 1
    s_cmp_lt_u32 s32, 200000
    s_cbranch_scc1 Lws_33
    v_mov_b32 v2, 1
    v_mov_b32 v3, 4
    buffer_store_dword v2, v3, s[16:19], 0 offen sc1
    s_endpgm
E_V:
.p2align 6
W_U:
R_U:
    s_lshl_b32 s35, s25, 9
    s_lshl_b32 s28, s24, 7
    s_add_u32 s35, s35, s28
    s_add_u32 s35, s35, 163610624
    v_mov_b32 v2, 0
    s_mov_b64 exec, 1
    buffer_store_dword v2, off, s[4:7], s35 sc1
    s_mov_b64 exec, -1
    s_mov_b32 s12, s46
    s_mov_b32 s13, s47
    s_mov_b32 s14, 7864320
    s_mov_b32 s15, 0x20000
    v_add_u32 v2, 0, v1
    v_mul_u32_u24 v3, 1639, v2
    v_lshrrev_b32 v3, 16, v3
    v_mul_u32_u24 v6, 40, v3
    v_sub_u32 v2, v2, v6
    v_mul_u32_u24 v3, 1280, v3
    v_lshl_add_u32 v6, v2, 4, v3
    v_add_u32 v2, 64, v1
    v_mul_u32_u24 v3, 1639, v2
    v_lshrrev_b32 v3, 16, v3
    v_mul_u32_u24 v7, 40, v3
    v_sub_u32 v2, v2, v7
    v_mul_u32_u24 v3, 1280, v3
    v_lshl_add_u32 v7, v2, 4, v3
    v_add_u32 v2, 128, v1
    v_mul_u32_u24 v3, 1639, v2
    v_lshrrev_b32 v3, 16, v3
    v_mul_u32_u24 v8, 40, v3
    v_sub_u32 v2, v2, v8
    v_mul_u32_u24 v3, 1280, v3
    v_lshl_add_u32 v8, v2, 4, v3
    v_add_u32 v2, 192, v1
    v_mul_u32_u24 v3, 1639, v2
    v_lshrrev_b32 v3, 16, v3
    v_mul_u32_u24 v9, 40, v3
    v_sub_u32 v2, v2, v9
    v_mul_u32_u24 v3, 1280, v3
    v_lshl_add_u32 v9, v2, 4, v3
    v_add_u32 v2, 256, v1
    v_mul_u32_u24 v3, 1639, v2
    v_lshrrev_b32 v3, 16, v3
    v_mul_u32_u24 v10, 40, v3
    v_sub_u32 v2, v2, v10
    v_mul_u32_u24 v3, 1280, v3
    v_lshl_add_u32 v10, v2, 4, v3
    v_and_b32 v12, 3, v1
    v_lshlrev_b32 v12, 3, v12
    v_bfe_u32 v13, v1, 5, 1
    v_mul_u32_u24 v13, 5120, v13
    v_add_u32 v12, v12, v13
    v_bfe_u32 v13, v1, 4, 1
    v_mul_u32_u24 v13, 2560, v13
    v_add_u32 v12, v12, v13
    v_bfe_u32 v13, v1, 3, 1
    v_mul_u32_u24 v13, 1280, v13
    v_add_u32 v12, v12, v13
    v_bfe_u32 v13, v1, 2, 1
    v_mul_u32_u24 v13, 640, v13
    v_add_u32 v12, v12, v13
    s_mul_i32 s28, s24, 160
    v_add_u32 v12, s28, v12
    v_add_u32 v13, 49152, v12
    v_add_u32 v14, 98304, v12
    s_mul_i32 s67, s24, 10240
    s_mul_i32 s28, s25, 245760
    s_add_u32 s67, s67, s28
    s_mul_i32 s29, s24, 5120
    s_add_u32 s28, s67, 0
    s_add_u32 m0, s29, 0
    s_nop 0
    buffer_load_dwordx4 v6, s[12:15], s28 offen lds
    s_add_u32 m0, s29, 1024
    s_nop 0
    buffer_load_dwordx4 v7, s[12:15], s28 offen lds
    s_add_u32 m0, s29, 2048
    s_nop 0
    buffer_load_dwordx4 v8, s[12:15], s28 offen lds
    s_add_u32 m0, s29, 3072
    s_nop 0
    buffer_load_dwordx4 v9, s[12:15], s28 offen lds
    s_add_u32 m0, s29, 4096
    s_nop 0
    buffer_load_dwordx4 v10, s[12:15], s28 offen lds
    s_mul_i32 s29, s24, 5120
    s_add_u32 s28, s67, 640
    s_add_u32 m0, s29, 24576
    s_nop 0
    buffer_load_dwordx4 v6, s[12:15], s28 offen lds
    s_add_u32 m0, s29, 25600
    s_nop 0
    buffer_load_dwordx4 v7, s[12:15], s28 offen lds
    s_add_u32 m0, s29, 26624
    s_nop 0
    buffer_load_dwordx4 v8, s[12:15], s28 offen lds
    s_add_u32 m0, s29, 27648
    s_nop 0
    buffer_load_dwordx4 v9, s[12:15], s28 offen lds
    s_add_u32 m0, s29, 28672
    s_nop 0
    buffer_load_dwordx4 v10, s[12:15], s28 offen lds
    s_waitcnt vmcnt(10)
    s_barrier
    s_cmp_lg_u32 s24, 0
    s_cbranch_scc1 Larr_35
    s_and_b32 s28, s2, 1
    s_lshl_b32 s28, s28, 6
    v_mov_b32 v2, 1
    s_mov_b64 exec, 1
    buffer_atomic_add v2, off, s[16:19], s28 sc1
    s_mov_b64 exec, -1
Larr_35:
    s_mul_i32 s29, s24, 5120
    s_add_u32 s28, s67, 40960
    s_add_u32 m0, s29, 49152
    s_nop 0
    buffer_load_dwordx4 v6, s[12:15], s28 offen lds
    s_add_u32 m0, s29, 50176
    s_nop 0
    buffer_load_dwordx4 v7, s[12:15], s28 offen lds
    s_add_u32 m0, s29, 51200
    s_nop 0
    buffer_load_dwordx4 v8, s[12:15], s28 offen lds
    s_add_u32 m0, s29, 52224
    s_nop 0
    buffer_load_dwordx4 v9, s[12:15], s28 offen lds
    s_add_u32 m0, s29, 53248
    s_nop 0
    buffer_load_dwordx4 v10, s[12:15], s28 offen lds
    s_mul_i32 s29, s24, 5120
    s_add_u32 s28, s67, 41600
    s_add_u32 m0, s29, 73728
    s_nop 0
    buffer_load_dwordx4 v6, s[12:15], s28 offen lds
    s_add_u32 m0, s29, 74752
    s_nop 0
    buffer_load_dwordx4 v7, s[12:15], s28 offen lds
    s_add_u32 m0, s29, 75776
    s_nop 0
    buffer_load_dwordx4 v8, s[12:15], s28 offen lds
    s_add_u32 m0, s29, 76800
    s_nop 0
    buffer_load_dwordx4 v9, s[12:15], s28 offen lds
    s_add_u32 m0, s29, 77824
    s_nop 0
    buffer_load_dwordx4 v10, s[12:15], s28 offen lds
    s_mul_i32 s29, s24, 5120
    s_add_u32 s28, s67, 81920
    s_add_u32 m0, s29, 98304
    s_nop 0
    buffer_load_dwordx4 v6, s[12:15], s28 offen lds
    s_add_u32 m0, s29, 99328
    s_nop 0
    buffer_load_dwordx4 v7, s[12:15], s28 offen lds
    s_add_u32 m0, s29, 100352
    s_nop 0
    buffer_load_dwordx4 v8, s[12:15], s28 offen lds
    s_add_u32 m0, s29, 101376
    s_nop 0
    buffer_load_dwordx4 v9, s[12:15], s28 offen lds
    s_add_u32 m0, s29, 102400
    s_nop 0
    buffer_load_dwordx4 v10, s[12:15], s28 offen lds
    s_mul_i32 s29, s24, 5120
    s_add_u32 s28, s67, 82560
    s_add_u32 m0, s29, 122880
    s_nop 0
    buffer_load_dwordx4 v6, s[12:15], s28 offen lds
    s_add_u32 m0, s29, 123904
    s_nop 0
    buffer_load_dwordx4 v7, s[12:15], s28 offen lds
    s_add_u32 m0, s29, 124928
    s_nop 0
    buffer_load_dwordx4 v8, s[12:15], s28 offen lds
    s_add_u32 m0, s29, 125952
    s_nop 0
    buffer_load_dwordx4 v9, s[12:15], s28 offen lds
    s_add_u32 m0, s29, 126976
    s_nop 0
    buffer_load_dwordx4 v10, s[12:15], s28 offen lds
    s_waitcnt vmcnt(25)
    s_waitcnt lgkmcnt(0)
    s_barrier
    ds_read_b64_tr_b16 a[0:1], v12 offset:0
    ds_read_b64_tr_b16 a[2:3], v12 offset:10240
    ds_read_b64_tr_b16 a[24:25], v12 offset:32
    ds_read_b64_tr_b16 a[26:27], v12 offset:10272
    ds_read_b64_tr_b16 a[48:49], v12 offset:64
    ds_read_b64_tr_b16 a[50:51], v12 offset:10304
    ds_read_b64_tr_b16 a[72:73], v12 offset:96
    ds_read_b64_tr_b16 a[74:75], v12 offset:10336
    ds_read_b64_tr_b16 a[96:97], v12 offset:128
    ds_read_b64_tr_b16 a[98:99], v12 offset:10368
    s_waitcnt vmcnt(20)
    s_waitcnt lgkmcnt(0)
    s_barrier
    ds_read_b64_tr_b16 a[120:121], v12 offset:24576
    ds_read_b64_tr_b16 a[122:123], v12 offset:34816
    ds_read_b64_tr_b16 a[144:145], v12 offset:24608
    ds_read_b64_tr_b16 a[146:147], v12 offset:34848
    ds_read_b64_tr_b16 a[168:169], v12 offset:24640
    ds_read_b64_tr_b16 a[170:171], v12 offset:34880
    ds_read_b64_tr_b16 a[192:193], v12 offset:24672
    ds_read_b64_tr_b16 a[194:195], v12 offset:34912
    ds_read_b64_tr_b16 a[216:217], v12 offset:24704
    ds_read_b64_tr_b16 a[218:219], v12 offset:34944
    s_mul_i32 s29, s24, 5120
    s_add_u32 s28, s67, 122880
    s_add_u32 m0, s29, 0
    s_nop 0
    buffer_load_dwordx4 v6, s[12:15], s28 offen lds
    s_add_u32 m0, s29, 1024
    s_nop 0
    buffer_load_dwordx4 v7, s[12:15], s28 offen lds
    s_add_u32 m0, s29, 2048
    s_nop 0
    buffer_load_dwordx4 v8, s[12:15], s28 offen lds
    s_add_u32 m0, s29, 3072
    s_nop 0
    buffer_load_dwordx4 v9, s[12:15], s28 offen lds
    s_add_u32 m0, s29, 4096
    s_nop 0
    buffer_load_dwordx4 v10, s[12:15], s28 offen lds
    s_waitcnt vmcnt(20)
    s_waitcnt lgkmcnt(0)
    s_barrier
    ds_read_b64_tr_b16 a[4:5], v13 offset:0
    ds_read_b64_tr_b16 a[6:7], v13 offset:10240
    ds_read_b64_tr_b16 a[28:29], v13 offset:32
    ds_read_b64_tr_b16 a[30:31], v13 offset:10272
    ds_read_b64_tr_b16 a[52:53], v13 offset:64
    ds_read_b64_tr_b16 a[54:55], v13 offset:10304
    ds_read_b64_tr_b16 a[76:77], v13 offset:96
    ds_read_b64_tr_b16 a[78:79], v13 offset:10336
    ds_read_b64_tr_b16 a[100:101], v13 offset:128
    ds_read_b64_tr_b16 a[102:103], v13 offset:10368
    s_mul_i32 s29, s24, 5120
    s_add_u32 s28, s67, 123520
    s_add_u32 m0, s29, 24576
    s_nop 0
    buffer_load_dwordx4 v6, s[12:15], s28 offen lds
    s_add_u32 m0, s29, 25600
    s_nop 0
    buffer_load_dwordx4 v7, s[12:15], s28 offen lds
    s_add_u32 m0, s29, 26624
    s_nop 0
    buffer_load_dwordx4 v8, s[12:15], s28 offen lds
    s_add_u32 m0, s29, 27648
    s_nop 0
    buffer_load_dwordx4 v9, s[12:15], s28 offen lds
    s_add_u32 m0, s29, 28672
    s_nop 0
    buffer_load_dwordx4 v10, s[12:15], s28 offen lds
    s_waitcnt vmcnt(20)
    s_waitcnt lgkmcnt(0)
    s_barrier
    ds_read_b64_tr_b16 a[124:125], v13 offset:24576
    ds_read_b64_tr_b16 a[126:127], v13 offset:34816
    ds_read_b64_tr_b16 a[148:149], v13 offset:24608
    ds_read_b64_tr_b16 a[150:151], v13 offset:34848
    ds_read_b64_tr_b16 a[172:173], v13 offset:24640
    ds_read_b64_tr_b16 a[174:175], v13 offset:34880
    ds_read_b64_tr_b16 a[196:197], v13 offset:24672
    ds_read_b64_tr_b16 a[198:199], v13 offset:34912
    ds_read_b64_tr_b16 a[220:221], v13 offset:24704
    ds_read_b64_tr_b16 a[222:223], v13 offset:34944
    s_mul_i32 s29, s24, 5120
    s_add_u32 s28, s67, 163840
    s_add_u32 m0, s29, 49152
    s_nop 0
    buffer_load_dwordx4 v6, s[12:15], s28 offen lds
    s_add_u32 m0, s29, 50176
    s_nop 0
    buffer_load_dwordx4 v7, s[12:15], s28 offen lds
    s_add_u32 m0, s29, 51200
    s_nop 0
    buffer_load_dwordx4 v8, s[12:15], s28 offen lds
    s_add_u32 m0, s29, 52224
    s_nop 0
    buffer_load_dwordx4 v9, s[12:15], s28 offen lds
    s_add_u32 m0, s29, 53248
    s_nop 0
    buffer_load_dwordx4 v10, s[12:15], s28 offen lds
    s_waitcnt vmcnt(20)
    s_waitcnt lgkmcnt(0)
    s_barrier
    ds_read_b64_tr_b16 a[8:9], v14 offset:0
    ds_read_b64_tr_b16 a[10:11], v14 offset:10240
    ds_read_b64_tr_b16 a[32:33], v14 offset:32
    ds_read_b64_tr_b16 a[34:35], v14 offset:10272
    ds_read_b64_tr_b16 a[56:57], v14 offset:64
    ds_read_b64_tr_b16 a[58:59], v14 offset:10304
    ds_read_b64_tr_b16 a[80:81], v14 offset:96
    ds_read_b64_tr_b16 a[82:83], v14 offset:10336
    ds_read_b64_tr_b16 a[104:105], v14 offset:128
    ds_read_b64_tr_b16 a[106:107], v14 offset:10368
    s_mul_i32 s29, s24, 5120
    s_add_u32 s28, s67, 164480
    s_add_u32 m0, s29, 73728
    s_nop 0
    buffer_load_dwordx4 v6, s[12:15], s28 offen lds
    s_add_u32 m0, s29, 74752
    s_nop 0
    buffer_load_dwordx4 v7, s[12:15], s28 offen lds
    s_add_u32 m0, s29, 75776
    s_nop 0
    buffer_load_dwordx4 v8, s[12:15], s28 offen lds
    s_add_u32 m0, s29, 76800
    s_nop 0
    buffer_load_dwordx4 v9, s[12:15], s28 offen lds
    s_add_u32 m0, s29, 77824
    s_nop 0
    buffer_load_dwordx4 v10, s[12:15], s28 offen lds
    s_waitcnt vmcnt(20)
    s_waitcnt lgkmcnt(0)
    s_barrier
    ds_read_b64_tr_b16 a[128:129], v14 offset:24576
    ds_read_b64_tr_b16 a[130:131], v14 offset:34816
    ds_read_b64_tr_b16 a[152:153], v14 offset:24608
    ds_read_b64_tr_b16 a[154:155], v14 offset:34848
    ds_read_b64_tr_b16 a[176:177], v14 offset:24640
    ds_read_b64_tr_b16 a[178:179], v14 offset:34880
    ds_read_b64_tr_b16 a[200:201], v14 offset:24672
    ds_read_b64_tr_b16 a[202:203], v14 offset:34912
    ds_read_b64_tr_b16 a[224:225], v14 offset:24704
    ds_read_b64_tr_b16 a[226:227], v14 offset:34944
    s_mul_i32 s29, s24, 5120
    s_add_u32 s28, s67, 204800
    s_add_u32 m0, s29, 98304
    s_nop 0
    buffer_load_dwordx4 v6, s[12:15], s28 offen lds
    s_add_u32 m0, s29, 99328
    s_nop 0
    buffer_load_dwordx4 v7, s[12:15], s28 offen lds
    s_add_u32 m0, s29, 100352
    s_nop 0
    buffer_load_dwordx4 v8, s[12:15], s28 offen lds
    s_add_u32 m0, s29, 101376
    s_nop 0
    buffer_load_dwordx4 v9, s[12:15], s28 offen lds
    s_add_u32 m0, s29, 102400
    s_nop 0
    buffer_load_dwordx4 v10, s[12:15], s28 offen lds
    s_waitcnt vmcnt(20)
    s_waitcnt lgkmcnt(0)
    s_barrier
    ds_read_b64_tr_b16 a[12:13], v12 offset:0
    ds_read_b64_tr_b16 a[14:15], v12 offset:10240
    ds_read_b64_tr_b16 a[36:37], v12 offset:32
    ds_read_b64_tr_b16 a[38:39], v12 offset:10272
    ds_read_b64_tr_b16 a[60:61], v12 offset:64
    ds_read_b64_tr_b16 a[62:63], v12 offset:10304
    ds_read_b64_tr_b16 a[84:85], v12 offset:96
    ds_read_b64_tr_b16 a[86:87], v12 offset:10336
    ds_read_b64_tr_b16 a[108:109], v12 offset:128
    ds_read_b64_tr_b16 a[110:111], v12 offset:10368
    s_mul_i32 s29, s24, 5120
    s_add_u32 s28, s67, 205440
    s_add_u32 m0, s29, 122880
    s_nop 0
    buffer_load_dwordx4 v6, s[12:15], s28 offen lds
    s_add_u32 m0, s29, 123904
    s_nop 0
    buffer_load_dwordx4 v7, s[12:15], s28 offen lds
    s_add_u32 m0, s29, 124928
    s_nop 0
    buffer_load_dwordx4 v8, s[12:15], s28 offen lds
    s_add_u32 m0, s29, 125952
    s_nop 0
    buffer_load_dwordx4 v9, s[12:15], s28 offen lds
    s_add_u32 m0, s29, 126976
    s_nop 0
    buffer_load_dwordx4 v10, s[12:15], s28 offen lds
    s_waitcnt vmcnt(20)
    s_waitcnt lgkmcnt(0)
    s_barrier
    ds_read_b64_tr_b16 a[132:133], v12 offset:24576
    ds_read_b64_tr_b16 a[134:135], v12 offset:34816
    ds_read_b64_tr_b16 a[156:157], v12 offset:24608
    ds_read_b64_tr_b16 a[158:159], v12 offset:34848
    ds_read_b64_tr_b16 a[180:181], v12 offset:24640
    ds_read_b64_tr_b16 a[182:183], v12 offset:34880
    ds_read_b64_tr_b16 a[204:205], v12 offset:24672
    ds_read_b64_tr_b16 a[206:207], v12 offset:34912
    ds_read_b64_tr_b16 a[228:229], v12 offset:24704
    ds_read_b64_tr_b16 a[230:231], v12 offset:34944
    s_waitcnt vmcnt(15)
    s_waitcnt lgkmcnt(0)
    s_barrier
    ds_read_b64_tr_b16 a[16:17], v13 offset:0
    ds_read_b64_tr_b16 a[18:19], v13 offset:10240
    ds_read_b64_tr_b16 a[40:41], v13 offset:32
    ds_read_b64_tr_b16 a[42:43], v13 offset:10272
    ds_read_b64_tr_b16 a[64:65], v13 offset:64
    ds_read_b64_tr_b16 a[66:67], v13 offset:10304
    ds_read_b64_tr_b16 a[88:89], v13 offset:96
    ds_read_b64_tr_b16 a[90:91], v13 offset:10336
    ds_read_b64_tr_b16 a[112:113], v13 offset:128
    ds_read_b64_tr_b16 a[114:115], v13 offset:10368
    s_waitcnt vmcnt(10)
    s_waitcnt lgkmcnt(0)
    s_barrier
    ds_read_b64_tr_b16 a[136:137], v13 offset:24576
    ds_read_b64_tr_b16 a[138:139], v13 offset:34816
    ds_read_b64_tr_b16 a[160:161], v13 offset:24608
    ds_read_b64_tr_b16 a[162:163], v13 offset:34848
    ds_read_b64_tr_b16 a[184:185], v13 offset:24640
    ds_read_b64_tr_b16 a[186:187], v13 offset:34880
    ds_read_b64_tr_b16 a[208:209], v13 offset:24672
    ds_read_b64_tr_b16 a[210:211], v13 offset:34912
    ds_read_b64_tr_b16 a[232:233], v13 offset:24704
    ds_read_b64_tr_b16 a[234:235], v13 offset:34944
    buffer_load_dwordx2 v[4:5], off, s[16:19], 0 offset:128 sc1
    s_waitcnt vmcnt(6)
    s_waitcnt lgkmcnt(0)
    s_barrier
    ds_read_b64_tr_b16 a[20:21], v14 offset:0
    ds_read_b64_tr_b16 a[22:23], v14 offset:10240
    ds_read_b64_tr_b16 a[44:45], v14 offset:32
    ds_read_b64_tr_b16 a[46:47], v14 offset:10272
    ds_read_b64_tr_b16 a[68:69], v14 offset:64
    ds_read_b64_tr_b16 a[70:71], v14 offset:10304
    ds_read_b64_tr_b16 a[92:93], v14 offset:96
    ds_read_b64_tr_b16 a[94:95], v14 offset:10336
    ds_read_b64_tr_b16 a[116:117], v14 offset:128
    ds_read_b64_tr_b16 a[118:119], v14 offset:10368
    s_waitcnt vmcnt(1)
    s_waitcnt lgkmcnt(0)
    s_barrier
    ds_read_b64_tr_b16 a[140:141], v14 offset:24576
    ds_read_b64_tr_b16 a[142:143], v14 offset:34816
    ds_read_b64_tr_b16 a[164:165], v14 offset:24608
    ds_read_b64_tr_b16 a[166:167], v14 offset:34848
    ds_read_b64_tr_b16 a[188:189], v14 offset:24640
    ds_read_b64_tr_b16 a[190:191], v14 offset:34880
    ds_read_b64_tr_b16 a[212:213], v14 offset:24672
    ds_read_b64_tr_b16 a[214:215], v14 offset:34912
    ds_read_b64_tr_b16 a[236:237], v14 offset:24704
    ds_read_b64_tr_b16 a[238:239], v14 offset:34944
    s_waitcnt vmcnt(0) lgkmcnt(0)
    s_barrier
    v_lshlrev_b32 v15, 4, v1
    s_mul_i32 s28, s25, 12
    v_min_u32 v16, 11, v1
    v_add_u32 v16, s28, v16
    v_lshrrev_b32 v16, 2, v16
    v_lshlrev_b32 v16, 7, v16
    v_add_u32 v16, 163594240, v16
    s_mov_b32 s32, 0
Lws_36:
    v_readfirstlane_b32 s28, v4
    s_nop 0
    s_cmp_eq_u32 s28, 0
    s_cbranch_scc1 Lretry_37
    s_mul_i32 s64, s25, 12288
    s_add_u32 s64, s64, 29360128
    s_lshl_b32 s65, s25, 10
    s_mul_i32 s28, s24, 163840
    s_add_u32 s65, s65, s28
    s_add_u32 s65, s65, 60817408
    s_mov_b32 s26, 0
    s_mov_b32 s68, 0
LU_slow:
    s_add_u32 s66, s26, 1
    s_mov_b32 s32, 0
    buffer_load_dword v2, v16, s[4:7], 0 offen sc1
    s_waitcnt vmcnt(0)
    v_mov_b32 v3, s26
    s_mov_b64 exec, 1
    buffer_store_dword v3, off, s[4:7], s35 sc1
    s_mov_b64 exec, -1
Lwf_38:
    v_cmp_gt_u32 vcc, s66, v2
    s_cbranch_vccnz Lretry_40
Lwfd_39:
    s_add_u32 s28, s64, 0
    buffer_load_dwordx4 v[68:71], v15, s[4:7], s28 offen offset:0
    buffer_load_dwordx4 v[72:75], v15, s[4:7], s28 offen offset:1024
    buffer_load_dwordx4 v[76:79], v15, s[4:7], s28 offen offset:2048
    buffer_load_dwordx4 v[80:83], v15, s[4:7], s28 offen offset:3072
    s_add_u32 s28, s64, 4096
    buffer_load_dwordx4 v[84:87], v15, s[4:7], s28 offen offset:0
    buffer_load_dwordx4 v[88:91], v15, s[4:7], s28 offen offset:1024
    buffer_load_dwordx4 v[92:95], v15, s[4:7], s28 offen offset:2048
    buffer_load_dwordx4 v[96:99], v15, s[4:7], s28 offen offset:3072
    s_add_u32 s28, s64, 8192
    buffer_load_dwordx4 v[100:103], v15, s[4:7], s28 offen offset:0
    buffer_load_dwordx4 v[104:107], v15, s[4:7], s28 offen offset:1024
    buffer_load_dwordx4 v[108:111], v15, s[4:7], s28 offen offset:2048
    buffer_load_dwordx4 v[112:115], v15, s[4:7], s28 offen offset:3072
    s_add_u32 s64, s64, 393216
    s_waitcnt vmcnt(0)
LU_top:
    s_add_u32 s66, s26, 2
    v_cmp_gt_u32 vcc, s66, v2
    v_mov_b64 v[20:21], v[68:69]
    v_mov_b64 v[22:23], v[72:73]
    v_mov_b64 v[24:25], v[70:71]
    v_mov_b64 v[26:27], v[74:75]
    v_mov_b64 v[28:29], v[76:77]
    v_mov_b64 v[30:31], v[80:81]
    v_mov_b64 v[32:33], v[78:79]
    v_mov_b64 v[34:35], v[82:83]
    v_mov_b64 v[36:37], v[84:85]
    v_mov_b64 v[38:39], v[88:89]
    v_mov_b64 v[40:41], v[86:87]
    v_mov_b64 v[42:43], v[90:91]
    v_mov_b64 v[44:45], v[92:93]
    v_mov_b64 v[46:47], v[96:97]
    v_mov_b64 v[48:49], v[94:95]
    v_mov_b64 v[50:51], v[98:99]
    v_mov_b64 v[52:53], v[100:101]
    v_mov_b64 v[54:55], v[104:105]
    v_mov_b64 v[56:57], v[102:103]
    v_mov_b64 v[58:59], v[106:107]
    v_mov_b64 v[60:61], v[108:109]
    v_mov_b64 v[62:63], v[112:113]
    v_mov_b64 v[64:65], v[110:111]
    v_mov_b64 v[66:67], v[114:115]
    s_mov_b32 s68, 0
    s_cbranch_vccnz LU_nopre
    s_add_u32 s28, s64, 0
    buffer_load_dwordx4 v[68:71], v15, s[4:7], s28 offen offset:0
    buffer_load_dwordx4 v[72:75], v15, s[4:7], s28 offen offset:1024
    buffer_load_dwordx4 v[76:79], v15, s[4:7], s28 offen offset:2048
    buffer_load_dwordx4 v[80:83], v15, s[4:7], s28 offen offset:3072
    s_add_u32 s28, s64, 4096
    buffer_load_dwordx4 v[84:87], v15, s[4:7], s28 offen offset:0
    buffer_load_dwordx4 v[88:91], v15, s[4:7], s28 offen offset:1024
    buffer_load_dwordx4 v[92:95], v15, s[4:7], s28 offen offset:2048
    buffer_load_dwordx4 v[96:99], v15, s[4:7], s28 offen offset:3072
    s_add_u32 s28, s64, 8192
    buffer_load_dwordx4 v[100:103], v15, s[4:7], s28 offen offset:0
    buffer_load_dwordx4 v[104:107], v15, s[4:7], s28 offen offset:1024
    buffer_load_dwordx4 v[108:111], v15, s[4:7], s28 offen offset:2048
    buffer_load_dwordx4 v[112:115], v15, s[4:7], s28 offen offset:3072
    s_add_u32 s64, s64, 393216
    s_mov_b32 s68, 1
LU_nopre:
    buffer_load_dword v2, v16, s[4:7], 0 offen sc1
    v_mfma_f32_16x16x32_bf16 v[116:119], v[20:23], a[0:3], 0
    v_mfma_f32_16x16x32_bf16 v[120:123], v[24:27], a[0:3], 0
    v_mfma_f32_16x16x32_bf16 v[116:119], v[28:31], a[4:7], v[116:119]
    v_mfma_f32_16x16x32_bf16 v[120:123], v[32:35], a[4:7], v[120:123]
    v_mfma_f32_16x16x32_bf16 v[116:119], v[36:39], a[8:11], v[116:119]
    v_mfma_f32_16x16x32_bf16 v[120:123], v[40:43], a[8:11], v[120:123]
    v_mfma_f32_16x16x32_bf16 v[116:119], v[44:47], a[12:15], v[116:119]
    v_mfma_f32_16x16x32_bf16 v[120:123], v[48:51], a[12:15], v[120:123]
    v_mfma_f32_16x16x32_bf16 v[116:119], v[52:55], a[16:19], v[116:119]
    v_mfma_f32_16x16x32_bf16 v[120:123], v[56:59], a[16:19], v[120:123]
    v_mfma_f32_16x16x32_bf16 v[116:119], v[60:63], a[20:23], v[116:119]
    v_mfma_f32_16x16x32_bf16 v[120:123], v[64:67], a[20:23], v[120:123]
    v_mfma_f32_16x16x32_bf16 v[124:127], v[20:23], a[24:27], 0
    v_mfma_f32_16x16x32_bf16 v[128:131], v[24:27], a[24:27], 0
    v_mfma_f32_16x16x32_bf16 v[124:127], v[28:31], a[28:31], v[124:127]
    v_mfma_f32_16x16x32_bf16 v[128:131], v[32:35], a[28:31], v[128:131]
    v_mfma_f32_16x16x32_bf16 v[124:127], v[36:39], a[32:35], v[124:127]
    v_mfma_f32_16x16x32_bf16 v[128:131], v[40:43], a[32:35], v[128:131]
    v_cvt_pk_bf16_f32 v132, v116, v117
    v_cvt_pk_bf16_f32 v134, v118, v119
    v_cvt_pk_bf16_f32 v133, v120, v121
    v_cvt_pk_bf16_f32 v135, v122, v123
    s_add_u32 s28, s65, 0
    buffer_store_dwordx4 v[132:135], v15, s[4:7], s28 offen sc1
    v_mfma_f32_16x16x32_bf16 v[124:127], v[44:47], a[36:39], v[124:127]
    v_mfma_f32_16x16x32_bf16 v[128:131], v[48:51], a[36:39], v[128:131]
    v_mfma_f32_16x16x32_bf16 v[124:127], v[52:55], a[40:43], v[124:127]
    v_mfma_f32_16x16x32_bf16 v[128:131], v[56:59], a[40:43], v[128:131]
    v_mfma_f32_16x16x32_bf16 v[124:127], v[60:63], a[44:47], v[124:127]
    v_mfma_f32_16x16x32_bf16 v[128:131], v[64:67], a[44:47], v[128:131]
    v_mfma_f32_16x16x32_bf16 v[116:119], v[20:23], a[48:51], 0
    v_mfma_f32_16x16x32_bf16 v[120:123], v[24:27], a[48:51], 0
    v_mfma_f32_16x16x32_bf16 v[116:119], v[28:31], a[52:55], v[116:119]
    v_mfma_f32_16x16x32_bf16 v[120:123], v[32:35], a[52:55], v[120:123]
    v_mfma_f32_16x16x32_bf16 v[116:119], v[36:39], a[56:59], v[116:119]
    v_mfma_f32_16x16x32_bf16 v[120:123], v[40:43], a[56:59], v[120:123]
    v_cvt_pk_bf16_f32 v136, v124, v125
    v_cvt_pk_bf16_f32 v138, v126, v127
    v_cvt_pk_bf16_f32 v137, v128, v129
    v_cvt_pk_bf16_f32 v139, v130, v131
    s_add_u32 s28, s65, 32768
    buffer_store_dwordx4 v[136:139], v15, s[4:7], s28 offen sc1
    v_mfma_f32_16x16x32_bf16 v[116:119], v[44:47], a[60:63], v[116:119]
    v_mfma_f32_16x16x32_bf16 v[120:123], v[48:51], a[60:63], v[120:123]
    v_mfma_f32_16x16x32_bf16 v[116:119], v[52:55], a[64:67], v[116:119]
    v_mfma_f32_16x16x32_bf16 v[120:123], v[56:59], a[64:67], v[120:123]
    v_mfma_f32_16x16x32_bf16 v[116:119], v[60:63], a[68:71], v[116:119]
    v_mfma_f32_16x16x32_bf16 v[120:123], v[64:67], a[68:71], v[120:123]
    v_mfma_f32_16x16x32_bf16 v[124:127], v[20:23], a[72:75], 0
    v_mfma_f32_16x16x32_bf16 v[128:131], v[24:27], a[72:75], 0
    v_mfma_f32_16x16x32_bf16 v[124:127], v[28:31], a[76:79], v[124:127]
    v_mfma_f32_16x16x32_bf16 v[128:131], v[32:35], a[76:79], v[128:131]
    v_mfma_f32_16x16x32_bf16 v[124:127], v[36:39], a[80:83], v[124:127]
    v_mfma_f32_16x16x32_bf16 v[128:131], v[40:43], a[80:83], v[128:131]
    v_cvt_pk_bf16_f32 v140, v116, v117
    v_cvt_pk_bf16_f32 v142, v118, v119
    v_cvt_pk_bf16_f32 v141, v120, v121
    v_cvt_pk_bf16_f32 v143, v122, v123
    s_add_u32 s28, s65, 65536
    buffer_store_dwordx4 v[140:143], v15, s[4:7], s28 offen sc1
    v_mfma_f32_16x16x32_bf16 v[124:127], v[44:47], a[84:87], v[124:127]
    v_mfma_f32_16x16x32_bf16 v[128:131], v[48:51], a[84:87], v[128:131]
    v_mfma_f32_16x16x32_bf16 v[124:127], v[52:55], a[88:91], v[124:127]
    v_mfma_f32_16x16x32_bf16 v[128:131], v[56:59], a[88:91], v[128:131]
    v_mfma_f32_16x16x32_bf16 v[124:127], v[60:63], a[92:95], v[124:127]
    v_mfma_f32_16x16x32_bf16 v[128:131], v[64:67], a[92:95], v[128:131]
    v_mfma_f32_16x16x32_bf16 v[116:119], v[20:23], a[96:99], 0
    v_mfma_f32_16x16x32_bf16 v[120:123], v[24:27], a[96:99], 0
    v_mfma_f32_16x16x32_bf16 v[116:119], v[28:31], a[100:103], v[116:119]
    v_mfma_f32_16x16x32_bf16 v[120:123], v[32:35], a[100:103], v[120:123]
    v_mfma_f32_16x16x32_bf16 v[116:119], v[36:39], a[104:107], v[116:119]
    v_mfma_f32_16x16x32_bf16 v[120:123], v[40:43], a[104:107], v[120:123]
    v_cvt_pk_bf16_f32 v144, v124, v125
    v_cvt_pk_bf16_f32 v146, v126, v127
    v_cvt_pk_bf16_f32 v145, v128, v129
    v_cvt_pk_bf16_f32 v147, v130, v131
    s_add_u32 s28, s65, 98304
    buffer_store_dwordx4 v[144:147], v15, s[4:7], s28 offen sc1
    v_mfma_f32_16x16x32_bf16 v[116:119], v[44:47], a[108:111], v[116:119]
    v_mfma_f32_16x16x32_bf16 v[120:123], v[48:51], a[108:111], v[120:123]
    v_mfma_f32_16x16x32_bf16 v[116:119], v[52:55], a[112:115], v[116:119]
    v_mfma_f32_16x16x32_bf16 v[120:123], v[56:59], a[112:115], v[120:123]
    s_cmp_lg_u32 s68, 0
    s_cbranch_scc1 LU_s1
    buffer_load_dword v4, v16, s[4:7], 0 offen sc1
LU_s1:
    v_mfma_f32_16x16x32_bf16 v[116:119], v[60:63], a[116:119], v[116:119]
    v_mfma_f32_16x16x32_bf16 v[120:123], v[64:67], a[116:119], v[120:123]
    v_mfma_f32_16x16x32_bf16 v[124:127], v[20:23], a[120:123], 0
    v_mfma_f32_16x16x32_bf16 v[128:131], v[24:27], a[120:123], 0
    v_mfma_f32_16x16x32_bf16 v[124:127], v[28:31], a[124:127], v[124:127]
    v_mfma_f32_16x16x32_bf16 v[128:131], v[32:35], a[124:127], v[128:131]
    v_mfma_f32_16x16x32_bf16 v[124:127], v[36:39], a[128:131], v[124:127]
    v_mfma_f32_16x16x32_bf16 v[128:131], v[40:43], a[128:131], v[128:131]
    v_cvt_pk_bf16_f32 v148, v116, v117
    v_cvt_pk_bf16_f32 v150, v118, v119
    v_cvt_pk_bf16_f32 v149, v120, v121
    v_cvt_pk_bf16_f32 v151, v122, v123
    s_add_u32 s28, s65, 131072
    buffer_store_dwordx4 v[148:151], v15, s[4:7], s28 offen sc1
    v_mfma_f32_16x16x32_bf16 v[124:127], v[44:47], a[132:135], v[124:127]
    v_mfma_f32_16x16x32_bf16 v[128:131], v[48:51], a[132:135], v[128:131]
    v_mfma_f32_16x16x32_bf16 v[124:127], v[52:55], a[136:139], v[124:127]
    v_mfma_f32_16x16x32_bf16 v[128:131], v[56:59], a[136:139], v[128:131]
    v_mfma_f32_16x16x32_bf16 v[124:127], v[60:63], a[140:143], v[124:127]
    v_mfma_f32_16x16x32_bf16 v[128:131], v[64:67], a[140:143], v[128:131]
    v_mfma_f32_16x16x32_bf16 v[116:119], v[20:23], a[144:147], 0
    v_mfma_f32_16x16x32_bf16 v[120:123], v[24:27], a[144:147], 0
    v_mfma_f32_16x16x32_bf16 v[116:119], v[28:31], a[148:151], v[116:119]
    v_mfma_f32_16x16x32_bf16 v[120:123], v[32:35], a[148:151], v[120:123]
    v_mfma_f32_16x16x32_bf16 v[116:119], v[36:39], a[152:155], v[116:119]
    v_mfma_f32_16x16x32_bf16 v[120:123], v[40:43], a[152:155], v[120:123]
    v_cvt_pk_bf16_f32 v152, v124, v125
    v_cvt_pk_bf16_f32 v154, v126, v127
    v_cvt_pk_bf16_f32 v153, v128, v129
    v_cvt_pk_bf16_f32 v155, v130, v131
    s_add_u32 s28, s65, 655360
    buffer_store_dwordx4 v[152:155], v15, s[4:7], s28 offen sc1
    v_mfma_f32_16x16x32_bf16 v[116:119], v[44:47], a[156:159], v[116:119]
    v_mfma_f32_16x16x32_bf16 v[120:123], v[48:51], a[156:159], v[120:123]
    v_mfma_f32_16x16x32_bf16 v[116:119], v[52:55], a[160:163], v[116:119]
    v_mfma_f32_16x16x32_bf16 v[120:123], v[56:59], a[160:163], v[120:123]
    v_mfma_f32_16x16x32_bf16 v[116:119], v[60:63], a[164:167], v[116:119]
    v_mfma_f32_16x16x32_bf16 v[120:123], v[64:67], a[164:167], v[120:123]
    v_mfma_f32_16x16x32_bf16 v[124:127], v[20:23], a[168:171], 0
    v_mfma_f32_16x16x32_bf16 v[128:131], v[24:27], a[168:171], 0
    v_mfma_f32_16x16x32_bf16 v[124:127], v[28:31], a[172:175], v[124:127]
    v_mfma_f32_16x16x32_bf16 v[128:131], v[32:35], a[172:175], v[128:131]
    v_mfma_f32_16x16x32_bf16 v[124:127], v[36:39], a[176:179], v[124:127]
    v_mfma_f32_16x16x32_bf16 v[128:131], v[40:43], a[176:179], v[128:131]
    v_cvt_pk_bf16_f32 v156, v116, v117
    v_cvt_pk_bf16_f32 v158, v118, v119
    v_cvt_pk_bf16_f32 v157, v120, v121
    v_cvt_pk_bf16_f32 v159, v122, v123
    s_add_u32 s28, s65, 688128
    buffer_store_dwordx4 v[156:159], v15, s[4:7], s28 offen sc1
    v_mfma_f32_16x16x32_bf16 v[124:127], v[44:47], a[180:183], v[124:127]
    v_mfma_f32_16x16x32_bf16 v[128:131], v[48:51], a[180:183], v[128:131]
    v_mfma_f32_16x16x32_bf16 v[124:127], v[52:55], a[184:187], v[124:127]
    v_mfma_f32_16x16x32_bf16 v[128:131], v[56:59], a[184:187], v[128:131]
    s_waitcnt vmcnt(7)
    v_mov_b32 v3, s26
    s_mov_b64 exec, 1
    buffer_store_dword v3, off, s[4:7], s35 sc1
    s_mov_b64 exec, -1
    v_mfma_f32_16x16x32_bf16 v[124:127], v[60:63], a[188:191], v[124:127]
    v_mfma_f32_16x16x32_bf16 v[128:131], v[64:67], a[188:191], v[128:131]
    v_mfma_f32_16x16x32_bf16 v[116:119], v[20:23], a[192:195], 0
    v_mfma_f32_16x16x32_bf16 v[120:123], v[24:27], a[192:195], 0
    v_mfma_f32_16x16x32_bf16 v[116:119], v[28:31], a[196:199], v[116:119]
    v_mfma_f32_16x16x32_bf16 v[120:123], v[32:35], a[196:199], v[120:123]
    v_mfma_f32_16x16x32_bf16 v[116:119], v[36:39], a[200:203], v[116:119]
    v_mfma_f32_16x16x32_bf16 v[120:123], v[40:43], a[200:203], v[120:123]
    v_cvt_pk_bf16_f32 v160, v124, v125
    v_cvt_pk_bf16_f32 v162, v126, v127
    v_cvt_pk_bf16_f32 v161, v128, v129
    v_cvt_pk_bf16_f32 v163, v130, v131
    s_add_u32 s28, s65, 720896
    buffer_store_dwordx4 v[160:163], v15, s[4:7], s28 offen sc1
    v_mfma_f32_16x16x32_bf16 v[116:119], v[44:47], a[204:207], v[116:119]
    v_mfma_f32_16x16x32_bf16 v[120:123], v[48:51], a[204:207], v[120:123]
    v_mfma_f32_16x16x32_bf16 v[116:119], v[52:55], a[208:211], v[116:119]
    v_mfma_f32_16x16x32_bf16 v[120:123], v[56:59], a[208:211], v[120:123]
    v_mfma_f32_16x16x32_bf16 v[116:119], v[60:63], a[212:215], v[116:119]
    v_mfma_f32_16x16x32_bf16 v[120:123], v[64:67], a[212:215], v[120:123]
    v_mfma_f32_16x16x32_bf16 v[124:127], v[20:23], a[216:219], 0
    v_mfma_f32_16x16x32_bf16 v[128:131], v[24:27], a[216:219], 0
    s_cmp_lg_u32 s68, 0
    s_cbranch_scc1 LU_s2
    s_waitcnt vmcnt(5)
    v_cmp_gt_u32 vcc, s66, v4
    v_mov_b32 v2, v4
    s_cbranch_vccnz LU_s2
    s_add_u32 s28, s64, 0
    buffer_load_dwordx4 v[68:71], v15, s[4:7], s28 offen offset:0
    buffer_load_dwordx4 v[72:75], v15, s[4:7], s28 offen offset:1024
    buffer_load_dwordx4 v[76:79], v15, s[4:7], s28 offen offset:2048
    buffer_load_dwordx4 v[80:83], v15, s[4:7], s28 offen offset:3072
    s_add_u32 s28, s64, 4096
    buffer_load_dwordx4 v[84:87], v15, s[4:7], s28 offen offset:0
    buffer_load_dwordx4 v[88:91], v15, s[4:7], s28 offen offset:1024
    buffer_load_dwordx4 v[92:95], v15, s[4:7], s28 offen offset:2048
    buffer_load_dwordx4 v[96:99], v15, s[4:7], s28 offen offset:3072
    s_add_u32 s28, s64, 8192
    buffer_load_dwordx4 v[100:103], v15, s[4:7], s28 offen offset:0
    buffer_load_dwordx4 v[104:107], v15, s[4:7], s28 offen offset:1024
    buffer_load_dwordx4 v[108:111], v15, s[4:7], s28 offen offset:2048
    buffer_load_dwordx4 v[112:115], v15, s[4:7], s28 offen offset:3072
    s_add_u32 s64, s64, 393216
    s_mov_b32 s68, 2
LU_s2:
    v_mfma_f32_16x16x32_bf16 v[124:127], v[28:31], a[220:223], v[124:127]
    v_mfma_f32_16x16x32_bf16 v[128:131], v[32:35], a[220:223], v[128:131]
    v_mfma_f32_16x16x32_bf16 v[124:127], v[36:39], a[224:227], v[124:127]
    v_mfma_f32_16x16x32_bf16 v[128:131], v[40:43], a[224:227], v[128:131]
    v_cvt_pk_bf16_f32 v164, v116, v117
    v_cvt_pk_bf16_f32 v166, v118, v119
    v_cvt_pk_bf16_f32 v165, v120, v121
    v_cvt_pk_bf16_f32 v167, v122, v123
    s_add_u32 s28, s65, 753664
    buffer_store_dwordx4 v[164:167], v15, s[4:7], s28 offen sc1
    v_mfma_f32_16x16x32_bf16 v[124:127], v[44:47], a[228:231], v[124:127]
    v_mfma_f32_16x16x32_bf16 v[128:131], v[48:51], a[228:231], v[128:131]
    v_mfma_f32_16x16x32_bf16 v[124:127], v[52:55], a[232:235], v[124:127]
    v_mfma_f32_16x16x32_bf16 v[128:131], v[56:59], a[232:235], v[128:131]
    v_mfma_f32_16x16x32_bf16 v[124:127], v[60:63], a[236:239], v[124:127]
    v_mfma_f32_16x16x32_bf16 v[128:131], v[64:67], a[236:239], v[128:131]
    s_nop 4
    v_cvt_pk_bf16_f32 v168, v124, v125
    v_cvt_pk_bf16_f32 v170, v126, v127
    s_nop 0
    v_cvt_pk_bf16_f32 v169, v128, v129
    v_cvt_pk_bf16_f32 v171, v130, v131
    s_add_u32 s28, s65, 786432
    buffer_store_dwordx4 v[168:171], v15, s[4:7], s28 offen sc1
    s_add_u32 s65, s65, 1310720
    s_add_u32 s26, s26, 1
    s_cmp_ge_u32 s26, 64
    s_cbranch_scc1 LU_end
    s_cmp_eq_u32 s68, 0
    s_cbranch_scc1 LU_slow
    s_cmp_eq_u32 s68, 1
    s_cbranch_scc1 LU_top
    buffer_load_dword v2, v16, s[4:7], 0 offen sc1
    s_waitcnt vmcnt(0)
    v_mov_b32 v3, s26
    s_mov_b64 exec, 1
    buffer_store_dword v3, off, s[4:7], s35 sc1
    s_mov_b64 exec, -1
    s_branch LU_top
LU_end:
    s_waitcnt vmcnt(0)
    v_mov_b32 v2, s26
    s_mov_b64 exec, 1
    buffer_store_dword v2, off, s[4:7], s35 sc1
    s_mov_b64 exec, -1
    s_endpgm
Lretry_37:
    s_sleep 6
    buffer_load_dwordx2 v[4:5], off, s[16:19], 0 offset:128 sc1
    s_waitcnt vmcnt(0)
    s_add_u32 s32, s32, 1
    s_cmp_lt_u32 s32, 200000
    s_cbranch_scc1 Lws_36
    v_mov_b32 v2, 1
    v_mov_b32 v3, 4
    buffer_store_dword v2, v3, s[16:19], 0 offen sc1
    s_endpgm
Lretry_40:
    s_sleep 2
    buffer_load_dword v2, v16, s[4:7], 0 offen sc1
    s_waitcnt vmcnt(0)
    s_add_u32 s32, s32, 1
    s_cmp_lt_u32 s32, 200000
    s_cbranch_scc1 Lwf_38
    v_mov_b32 v2, 2
    v_mov_b32 v3, 4
    buffer_store_dword v2, v3, s[16:19], 0 offen sc1
    s_endpgm
E_U:
.p2align 6
W_Q:
R_Q:
    s_lshl_b32 s35, s25, 9
    s_lshl_b32 s28, s24, 7
    s_add_u32 s35, s35, s28
    s_add_u32 s35, s35, 163631104
    v_mov_b32 v2, 0
    s_mov_b64 exec, 1
    buffer_store_dword v2, off, s[4:7], s35 sc1
    s_mov_b64 exec, -1
    s_waitcnt vmcnt(0)
    s_barrier
    s_cmp_lg_u32 s24, 0
    s_cbranch_scc1 Larr_41
    s_and_b32 s28, s2, 1
    s_lshl_b32 s28, s28, 6
    v_mov_b32 v2, 1
    s_mov_b64 exec, 1
    buffer_atomic_add v2, off, s[16:19], s28 sc1
    s_mov_b64 exec, -1
Larr_41:
    s_mov_b32 s32, 0
    buffer_load_dwordx2 v[2:3], off, s[16:19], 0 offset:128 sc1
    s_waitcnt vmcnt(0)
Lws_42:
    v_readfirstlane_b32 s28, v2
    s_nop 0
    s_cmp_eq_u32 s28, 0
    s_cbranch_scc1 Lretry_43
    s_and_b32 s28, s25, 15
    s_lshl_b32 s28, s28, 9
    s_add_u32 s28, s28, 163610624
    v_mov_b32 v3, s28
    s_mov_b32 s66, 2
    s_mov_b32 s32, 0
    buffer_load_dword v2, v3, s[4:7], 0 offen sc1
    s_waitcnt vmcnt(0)
Lwf_44:
    v_cmp_gt_u32 vcc, s66, v2
    s_cbranch_vccnz Lretry_46
Lwfd_45:
    s_mov_b32 s8, s40
    s_mov_b32 s9, s41
    s_mov_b32 s10, 7864320
    s_mov_b32 s11, 0x20000
    v_add_u32 v2, 0, v1
    v_mul_u32_u24 v3, 2731, v2
    v_lshrrev_b32 v3, 16, v3
    v_mul_u32_u24 v6, 24, v3
    v_sub_u32 v2, v2, v6
    v_mul_u32_u24 v3, 12288, v3
    v_lshl_add_u32 v6, v2, 4, v3
    v_add_u32 v2, 64, v1
    v_mul_u32_u24 v3, 2731, v2
    v_lshrrev_b32 v3, 16, v3
    v_mul_u32_u24 v7, 24, v3
    v_sub_u32 v2, v2, v7
    v_mul_u32_u24 v3, 12288, v3
    v_lshl_add_u32 v7, v2, 4, v3
    v_add_u32 v2, 128, v1
    v_mul_u32_u24 v3, 2731, v2
    v_lshrrev_b32 v3, 16, v3
    v_mul_u32_u24 v8, 24, v3
    v_sub_u32 v2, v2, v8
    v_mul_u32_u24 v3, 12288, v3
    v_lshl_add_u32 v8, v2, 4, v3
    v_and_b32 v10, 3, v1
    v_lshlrev_b32 v10, 3, v10
    v_bfe_u32 v11, v1, 5, 1
    v_mul_u32_u24 v11, 6144, v11
    v_add_u32 v10, v10, v11
    v_bfe_u32 v11, v1, 4, 1
    v_mul_u32_u24 v11, 3072, v11
    v_add_u32 v10, v10, v11
    v_bfe_u32 v11, v1, 3, 1
    v_mul_u32_u24 v11, 768, v11
    v_add_u32 v10, v10, v11
    v_bfe_u32 v11, v1, 2, 1
    v_mul_u32_u24 v11, 384, v11
    v_add_u32 v10, v10, v11
    s_mul_i32 s28, s24, 96
    v_add_u32 v10, s28, v10
    v_add_u32 v11, 49152, v10
    v_add_u32 v12, 98304, v10
    s_mul_i32 s64, s24, 196608
    s_mul_i32 s28, s25, 384
    s_add_u32 s64, s64, s28
    s_mul_i32 s29, s24, 6144
    s_add_u32 s28, s64, 7077888
    s_add_u32 m0, s29, 0
    s_nop 0
    buffer_load_dwordx4 v6, s[8:11], s28 offen lds
    s_add_u32 m0, s29, 1024
    s_nop 0
    buffer_load_dwordx4 v7, s[8:11], s28 offen lds
    s_add_u32 m0, s29, 2048
    s_nop 0
    buffer_load_dwordx4 v8, s[8:11], s28 offen lds
    s_add_u32 s28, s64, 7176192
    s_add_u32 m0, s29, 3072
    s_nop 0
    buffer_load_dwordx4 v6, s[8:11], s28 offen lds
    s_add_u32 m0, s29, 4096
    s_nop 0
    buffer_load_dwordx4 v7, s[8:11], s28 offen lds
    s_add_u32 m0, s29, 5120
    s_nop 0
    buffer_load_dwordx4 v8, s[8:11], s28 offen lds
    s_mul_i32 s29, s24, 6144
    s_add_u32 s28, s64, 6291456
    s_add_u32 m0, s29, 24576
    s_nop 0
    buffer_load_dwordx4 v6, s[8:11], s28 offen lds
    s_add_u32 m0, s29, 25600
    s_nop 0
    buffer_load_dwordx4 v7, s[8:11], s28 offen lds
    s_add_u32 m0, s29, 26624
    s_nop 0
    buffer_load_dwordx4 v8, s[8:11], s28 offen lds
    s_add_u32 s28, s64, 6389760
    s_add_u32 m0, s29, 27648
    s_nop 0
    buffer_load_dwordx4 v6, s[8:11], s28 offen lds
    s_add_u32 m0, s29, 28672
    s_nop 0
    buffer_load_dwordx4 v7, s[8:11], s28 offen lds
    s_add_u32 m0, s29, 29696
    s_nop 0
    buffer_load_dwordx4 v8, s[8:11], s28 offen lds
    s_mul_i32 s29, s24, 6144
    s_add_u32 s28, s64, 5505024
    s_add_u32 m0, s29, 49152
    s_nop 0
    buffer_load_dwordx4 v6, s[8:11], s28 offen lds
    s_add_u32 m0, s29, 50176
    s_nop 0
    buffer_load_dwordx4 v7, s[8:11], s28 offen lds
    s_add_u32 m0, s29, 51200
    s_nop 0
    buffer_load_dwordx4 v8, s[8:11], s28 offen lds
    s_add_u32 s28, s64, 5603328
    s_add_u32 m0, s29, 52224
    s_nop 0
    buffer_load_dwordx4 v6, s[8:11], s28 offen lds
    s_add_u32 m0, s29, 53248
    s_nop 0
    buffer_load_dwordx4 v7, s[8:11], s28 offen lds
    s_add_u32 m0, s29, 54272
    s_nop 0
    buffer_load_dwordx4 v8, s[8:11], s28 offen lds
    s_mul_i32 s29, s24, 6144
    s_add_u32 s28, s64, 4718592
    s_add_u32 m0, s29, 73728
    s_nop 0
    buffer_load_dwordx4 v6, s[8:11], s28 offen lds
    s_add_u32 m0, s29, 74752
    s_nop 0
    buffer_load_dwordx4 v7, s[8:11], s28 offen lds
    s_add_u32 m0, s29, 75776
    s_nop 0
    buffer_load_dwordx4 v8, s[8:11], s28 offen lds
    s_add_u32 s28, s64, 4816896
    s_add_u32 m0, s29, 76800
    s_nop 0
    buffer_load_dwordx4 v6, s[8:11], s28 offen lds
    s_add_u32 m0, s29, 77824
    s_nop 0
    buffer_load_dwordx4 v7, s[8:11], s28 offen lds
    s_add_u32 m0, s29, 78848
    s_nop 0
    buffer_load_dwordx4 v8, s[8:11], s28 offen lds
    s_mul_i32 s29, s24, 6144
    s_add_u32 s28, s64, 3932160
    s_add_u32 m0, s29, 98304
    s_nop 0
    buffer_load_dwordx4 v6, s[8:11], s28 offen lds
    s_add_u32 m0, s29, 99328
    s_nop 0
    buffer_load_dwordx4 v7, s[8:11], s28 offen lds
    s_add_u32 m0, s29, 100352
    s_nop 0
    buffer_load_dwordx4 v8, s[8:11], s28 offen lds
    s_add_u32 s28, s64, 4030464
    s_add_u32 m0, s29, 101376
    s_nop 0
    buffer_load_dwordx4 v6, s[8:11], s28 offen lds
    s_add_u32 m0, s29, 102400
    s_nop 0
    buffer_load_dwordx4 v7, s[8:11], s28 offen lds
    s_add_u32 m0, s29, 103424
    s_nop 0
    buffer_load_dwordx4 v8, s[8:11], s28 offen lds
    s_mul_i32 s29, s24, 6144
    s_add_u32 s28, s64, 3145728
    s_add_u32 m0, s29, 122880
    s_nop 0
    buffer_load_dwordx4 v6, s[8:11], s28 offen lds
    s_add_u32 m0, s29, 123904
    s_nop 0
    buffer_load_dwordx4 v7, s[8:11], s28 offen lds
    s_add_u32 m0, s29, 124928
    s_nop 0
    buffer_load_dwordx4 v8, s[8:11], s28 offen lds
    s_add_u32 s28, s64, 3244032
    s_add_u32 m0, s29, 125952
    s_nop 0
    buffer_load_dwordx4 v6, s[8:11], s28 offen lds
    s_add_u32 m0, s29, 126976
    s_nop 0
    buffer_load_dwordx4 v7, s[8:11], s28 offen lds
    s_add_u32 m0, s29, 128000
    s_nop 0
    buffer_load_dwordx4 v8, s[8:11], s28 offen lds
    s_waitcnt vmcnt(30)
    s_waitcnt lgkmcnt(0)
    s_barrier
    ds_read_b64_tr_b16 a[72:73], v10 offset:0
    ds_read_b64_tr_b16 a[74:75], v10 offset:1536
    ds_read_b64_tr_b16 a[152:153], v10 offset:32
    ds_read_b64_tr_b16 a[154:155], v10 offset:1568
    ds_read_b64_tr_b16 a[232:233], v10 offset:64
    ds_read_b64_tr_b16 a[234:235], v10 offset:1600
    ds_read_b64_tr_b16 a[76:77], v10 offset:12288
    ds_read_b64_tr_b16 a[78:79], v10 offset:13824
    ds_read_b64_tr_b16 a[156:157], v10 offset:12320
    ds_read_b64_tr_b16 a[158:159], v10 offset:13856
    ds_read_b64_tr_b16 a[236:237], v10 offset:12352
    ds_read_b64_tr_b16 a[238:239], v10 offset:13888
    s_waitcnt vmcnt(24)
    s_waitcnt lgkmcnt(0)
    s_barrier
    ds_read_b64_tr_b16 a[64:65], v10 offset:24576
    ds_read_b64_tr_b16 a[66:67], v10 offset:26112
    ds_read_b64_tr_b16 a[144:145], v10 offset:24608
    ds_read_b64_tr_b16 a[146:147], v10 offset:26144
    ds_read_b64_tr_b16 a[224:225], v10 offset:24640
    ds_read_b64_tr_b16 a[226:227], v10 offset:26176
    ds_read_b64_tr_b16 a[68:69], v10 offset:36864
    ds_read_b64_tr_b16 a[70:71], v10 offset:38400
    ds_read_b64_tr_b16 a[148:149], v10 offset:36896
    ds_read_b64_tr_b16 a[150:151], v10 offset:38432
    ds_read_b64_tr_b16 a[228:229], v10 offset:36928
    ds_read_b64_tr_b16 a[230:231], v10 offset:38464
    s_mul_i32 s29, s24, 6144
    s_add_u32 s28, s64, 2359296
    s_add_u32 m0, s29, 0
    s_nop 0
    buffer_load_dwordx4 v6, s[8:11], s28 offen lds
    s_add_u32 m0, s29, 1024
    s_nop 0
    buffer_load_dwordx4 v7, s[8:11], s28 offen lds
    s_add_u32 m0, s29, 2048
    s_nop 0
    buffer_load_dwordx4 v8, s[8:11], s28 offen lds
    s_add_u32 s28, s64, 2457600
    s_add_u32 m0, s29, 3072
    s_nop 0
    buffer_load_dwordx4 v6, s[8:11], s28 offen lds
    s_add_u32 m0, s29, 4096
    s_nop 0
    buffer_load_dwordx4 v7, s[8:11], s28 offen lds
    s_add_u32 m0, s29, 5120
    s_nop 0
    buffer_load_dwordx4 v8, s[8:11], s28 offen lds
    s_waitcnt vmcnt(24)
    s_waitcnt lgkmcnt(0)
    s_barrier
    ds_read_b64_tr_b16 a[56:57], v11 offset:0
    ds_read_b64_tr_b16 a[58:59], v11 offset:1536
    ds_read_b64_tr_b16 a[136:137], v11 offset:32
    ds_read_b64_tr_b16 a[138:139], v11 offset:1568
    ds_read_b64_tr_b16 a[216:217], v11 offset:64
    ds_read_b64_tr_b16 a[218:219], v11 offset:1600
    ds_read_b64_tr_b16 a[60:61], v11 offset:12288
    ds_read_b64_tr_b16 a[62:63], v11 offset:13824
    ds_read_b64_tr_b16 a[140:141], v11 offset:12320
    ds_read_b64_tr_b16 a[142:143], v11 offset:13856
    ds_read_b64_tr_b16 a[220:221], v11 offset:12352
    ds_read_b64_tr_b16 a[222:223], v11 offset:13888
    s_mul_i32 s29, s24, 6144
    s_add_u32 s28, s64, 1572864
    s_add_u32 m0, s29, 24576
    s_nop 0
    buffer_load_dwordx4 v6, s[8:11], s28 offen lds
    s_add_u32 m0, s29, 25600
    s_nop 0
    buffer_load_dwordx4 v7, s[8:11], s28 offen lds
    s_add_u32 m0, s29, 26624
    s_nop 0
    buffer_load_dwordx4 v8, s[8:11], s28 offen lds
    s_add_u32 s28, s64, 1671168
    s_add_u32 m0, s29, 27648
    s_nop 0
    buffer_load_dwordx4 v6, s[8:11], s28 offen lds
    s_add_u32 m0, s29, 28672
    s_nop 0
    buffer_load_dwordx4 v7, s[8:11], s28 offen lds
    s_add_u32 m0, s29, 29696
    s_nop 0
    buffer_load_dwordx4 v8, s[8:11], s28 offen lds
    s_waitcnt vmcnt(24)
    s_waitcnt lgkmcnt(0)
    s_barrier
    ds_read_b64_tr_b16 a[48:49], v11 offset:24576
    ds_read_b64_tr_b16 a[50:51], v11 offset:26112
    ds_read_b64_tr_b16 a[128:129], v11 offset:24608
    ds_read_b64_tr_b16 a[130:131], v11 offset:26144
    ds_read_b64_tr_b16 a[208:209], v11 offset:24640
    ds_read_b64_tr_b16 a[210:211], v11 offset:26176
    ds_read_b64_tr_b16 a[52:53], v11 offset:36864
    ds_read_b64_tr_b16 a[54:55], v11 offset:38400
    ds_read_b64_tr_b16 a[132:133], v11 offset:36896
    ds_read_b64_tr_b16 a[134:135], v11 offset:38432
    ds_read_b64_tr_b16 a[212:213], v11 offset:36928
    ds_read_b64_tr_b16 a[214:215], v11 offset:38464
    s_mul_i32 s29, s24, 6144
    s_add_u32 s28, s64, 786432
    s_add_u32 m0, s29, 49152
    s_nop 0
    buffer_load_dwordx4 v6, s[8:11], s28 offen lds
    s_add_u32 m0, s29, 50176
    s_nop 0
    buffer_load_dwordx4 v7, s[8:11], s28 offen lds
    s_add_u32 m0, s29, 51200
    s_nop 0
    buffer_load_dwordx4 v8, s[8:11], s28 offen lds
    s_add_u32 s28, s64, 884736
    s_add_u32 m0, s29, 52224
    s_nop 0
    buffer_load_dwordx4 v6, s[8:11], s28 offen lds
    s_add_u32 m0, s29, 53248
    s_nop 0
    buffer_load_dwordx4 v7, s[8:11], s28 offen lds
    s_add_u32 m0, s29, 54272
    s_nop 0
    buffer_load_dwordx4 v8, s[8:11], s28 offen lds
    s_waitcnt vmcnt(24)
    s_waitcnt lgkmcnt(0)
    s_barrier
    ds_read_b64_tr_b16 a[40:41], v12 offset:0
    ds_read_b64_tr_b16 a[42:43], v12 offset:1536
    ds_read_b64_tr_b16 a[120:121], v12 offset:32
    ds_read_b64_tr_b16 a[122:123], v12 offset:1568
    ds_read_b64_tr_b16 a[200:201], v12 offset:64
    ds_read_b64_tr_b16 a[202:203], v12 offset:1600
    ds_read_b64_tr_b16 a[44:45], v12 offset:12288
    ds_read_b64_tr_b16 a[46:47], v12 offset:13824
    ds_read_b64_tr_b16 a[124:125], v12 offset:12320
    ds_read_b64_tr_b16 a[126:127], v12 offset:13856
    ds_read_b64_tr_b16 a[204:205], v12 offset:12352
    ds_read_b64_tr_b16 a[206:207], v12 offset:13888
    s_mul_i32 s29, s24, 6144
    s_add_u32 s28, s64, 0
    s_add_u32 m0, s29, 73728
    s_nop 0
    buffer_load_dwordx4 v6, s[8:11], s28 offen lds
    s_add_u32 m0, s29, 74752
    s_nop 0
    buffer_load_dwordx4 v7, s[8:11], s28 offen lds
    s_add_u32 m0, s29, 75776
    s_nop 0
    buffer_load_dwordx4 v8, s[8:11], s28 offen lds
    s_add_u32 s28, s64, 98304
    s_add_u32 m0, s29, 76800
    s_nop 0
    buffer_load_dwordx4 v6, s[8:11], s28 offen lds
    s_add_u32 m0, s29, 77824
    s_nop 0
    buffer_load_dwordx4 v7, s[8:11], s28 offen lds
    s_add_u32 m0, s29, 78848
    s_nop 0
    buffer_load_dwordx4 v8, s[8:11], s28 offen lds
    s_waitcnt vmcnt(24)
    s_waitcnt lgkmcnt(0)
    s_barrier
    ds_read_b64_tr_b16 a[32:33], v12 offset:24576
    ds_read_b64_tr_b16 a[34:35], v12 offset:26112
    ds_read_b64_tr_b16 a[112:113], v12 offset:24608
    ds_read_b64_tr_b16 a[114:115], v12 offset:26144
    ds_read_b64_tr_b16 a[192:193], v12 offset:24640
    ds_read_b64_tr_b16 a[194:195], v12 offset:26176
    ds_read_b64_tr_b16 a[36:37], v12 offset:36864
    ds_read_b64_tr_b16 a[38:39], v12 offset:38400
    ds_read_b64_tr_b16 a[116:117], v12 offset:36896
    ds_read_b64_tr_b16 a[118:119], v12 offset:38432
    ds_read_b64_tr_b16 a[196:197], v12 offset:36928
    ds_read_b64_tr_b16 a[198:199], v12 offset:38464
    s_waitcnt vmcnt(18)
    s_waitcnt lgkmcnt(0)
    s_barrier
    ds_read_b64_tr_b16 a[24:25], v10 offset:0
    ds_read_b64_tr_b16 a[26:27], v10 offset:1536
    ds_read_b64_tr_b16 a[104:105], v10 offset:32
    ds_read_b64_tr_b16 a[106:107], v10 offset:1568
    ds_read_b64_tr_b16 a[184:185], v10 offset:64
    ds_read_b64_tr_b16 a[186:187], v10 offset:1600
    ds_read_b64_tr_b16 a[28:29], v10 offset:12288
    ds_read_b64_tr_b16 a[30:31], v10 offset:13824
    ds_read_b64_tr_b16 a[108:109], v10 offset:12320
    ds_read_b64_tr_b16 a[110:111], v10 offset:13856
    ds_read_b64_tr_b16 a[188:189], v10 offset:12352
    ds_read_b64_tr_b16 a[190:191], v10 offset:13888
    s_waitcnt vmcnt(12)
    s_waitcnt lgkmcnt(0)
    s_barrier
    ds_read_b64_tr_b16 a[16:17], v10 offset:24576
    ds_read_b64_tr_b16 a[18:19], v10 offset:26112
    ds_read_b64_tr_b16 a[96:97], v10 offset:24608
    ds_read_b64_tr_b16 a[98:99], v10 offset:26144
    ds_read_b64_tr_b16 a[176:177], v10 offset:24640
    ds_read_b64_tr_b16 a[178:179], v10 offset:26176
    ds_read_b64_tr_b16 a[20:21], v10 offset:36864
    ds_read_b64_tr_b16 a[22:23], v10 offset:38400
    ds_read_b64_tr_b16 a[100:101], v10 offset:36896
    ds_read_b64_tr_b16 a[102:103], v10 offset:38432
    ds_read_b64_tr_b16 a[180:181], v10 offset:36928
    ds_read_b64_tr_b16 a[182:183], v10 offset:38464
    s_waitcnt vmcnt(6)
    s_waitcnt lgkmcnt(0)
    s_barrier
    ds_read_b64_tr_b16 a[8:9], v11 offset:0
    ds_read_b64_tr_b16 a[10:11], v11 offset:1536
    ds_read_b64_tr_b16 a[88:89], v11 offset:32
    ds_read_b64_tr_b16 a[90:91], v11 offset:1568
    ds_read_b64_tr_b16 a[168:169], v11 offset:64
    ds_read_b64_tr_b16 a[170:171], v11 offset:1600
    ds_read_b64_tr_b16 a[12:13], v11 offset:12288
    ds_read_b64_tr_b16 a[14:15], v11 offset:13824
    ds_read_b64_tr_b16 a[92:93], v11 offset:12320
    ds_read_b64_tr_b16 a[94:95], v11 offset:13856
    ds_read_b64_tr_b16 a[172:173], v11 offset:12352
    ds_read_b64_tr_b16 a[174:175], v11 offset:13888
    s_waitcnt vmcnt(0)
    s_waitcnt lgkmcnt(0)
    s_barrier
    ds_read_b64_tr_b16 a[0:1], v11 offset:24576
    ds_read_b64_tr_b16 a[2:3], v11 offset:26112
    ds_read_b64_tr_b16 a[80:81], v11 offset:24608
    ds_read_b64_tr_b16 a[82:83], v11 offset:26144
    ds_read_b64_tr_b16 a[160:161], v11 offset:24640
    ds_read_b64_tr_b16 a[162:163], v11 offset:26176
    ds_read_b64_tr_b16 a[4:5], v11 offset:36864
    ds_read_b64_tr_b16 a[6:7], v11 offset:38400
    ds_read_b64_tr_b16 a[84:85], v11 offset:36896
    ds_read_b64_tr_b16 a[86:87], v11 offset:38432
    ds_read_b64_tr_b16 a[164:165], v11 offset:36928
    ds_read_b64_tr_b16 a[166:167], v11 offset:38464
    s_waitcnt vmcnt(0) lgkmcnt(0)
    s_barrier
    v_lshlrev_b32 v19, 4, v1
    v_mov_b32 v20, v19
    s_mul_i32 s65, s25, 12288
    s_mul_i32 s28, s24, 3072
    s_add_u32 s65, s65, s28
    s_add_u32 s65, s65, 0
    v_and_b32 v93, 7, v1
    v_lshlrev_b32 v93, 3, v93
    v_lshrrev_b32 v148, 4, v1
    v_lshl_add_u32 v93, v148, 6, v93
    v_lshlrev_b32 v94, 4, v1
    s_lshr_b32 s28, s65, 10
    v_min_u32 v92, 2, v1
    v_add_u32 v92, s28, v92
    v_lshrrev_b32 v92, 2, v92
    v_lshlrev_b32 v92, 7, v92
    v_add_u32 v92, 163577856, v92
    v_lshrrev_b32 v148, 4, v1
    v_lshlrev_b32 v148, 1, v148
    v_xor_b32 v148, v148, v1
    v_lshlrev_b32 v148, 4, v148
    s_mul_i32 s28, s24, 6144
    s_add_u32 s28, s28, 122880
    v_add_u32 v95, s28, v148
    s_and_b32 s29, s24, 1
    s_lshl_b32 s29, s29, 3
    v_lshrrev_b32 v148, 3, v1
    v_add_u32 v148, s29, v148
    s_lshr_b32 s29, s24, 1
    s_mul_i32 s28, s29, 3072
    s_add_u32 s28, s28, 122880
    v_and_b32 v149, 6, v1
    v_xor_b32 v150, v149, v148
    v_lshl_add_u32 v150, v149, 3, v150
    v_lshlrev_b32 v150, 4, v150
    v_and_b32 v151, 1, v1
    v_lshl_add_u32 v150, v151, 10, v150
    v_add_u32 v96, s28, v150
    v_bfe_u32 v150, v1, 2, 1
    v_lshlrev_b32 v151, 1, v150
    v_xor_b32 v151, v151, v148
    v_lshl_add_u32 v151, v150, 4, v151
    v_lshlrev_b32 v151, 4, v151
    v_and_b32 v150, 3, v1
    v_lshl_add_u32 v151, v150, 2, v151
    s_add_u32 s28, s28, 2048
    v_add_u32 v97, s28, v151
    v_lshl_add_u32 v98, v149, 3, v148
    v_lshlrev_b32 v98, 4, v98
    v_and_b32 v151, 1, v1
    v_lshl_add_u32 v98, v151, 3, v98
    v_lshlrev_b32 v99, 4, v148
    v_and_or_b32 v99, v1, 4, v99
    v_and_b32 v150, 2, v1
    v_lshl_add_u32 v99, v150, 2, v99
    v_lshl_add_u32 v99, v151, 30, v99
    s_lshl_b32 s28, s29, 4
    v_add_u32 v148, s28, v148
    v_lshlrev_b32 v149, 1, v149
    v_sub_u32 v148, v148, v149
    v_lshlrev_b32 v151, 4, v151
    v_sub_u32 v148, v148, v151
    v_cmp_le_i32 s[76:77], 0, v148
    v_cmp_le_i32 s[78:79], 1, v148
    v_cmp_le_i32 s[80:81], 2, v148
    v_cmp_le_i32 s[82:83], 3, v148
    v_cmp_eq_u32 s[84:85], 0, v151
    v_mov_b32 v100, 0xff800000
    v_mov_b32 v101, 0
    s_add_u32 s65, s65, 4194304
    s_mul_i32 s68, s25, 3072
    s_mul_i32 s28, s24, 768
    s_add_u32 s68, s68, s28
    s_add_u32 s68, s68, 2818048
    s_add_u32 s68, s68, s33
    s_lshl_b32 s29, s29, 10
    s_lshl_b32 s69, s25, 11
    s_add_u32 s69, s69, s29
    s_add_u32 s69, s69, 144703488
    s_lshr_b32 s70, s25, 2
    s_lshl_b32 s70, s70, 11
    s_and_b32 s28, s25, 3
    s_lshl_b32 s28, s28, 8
    s_add_u32 s70, s70, s28
    s_add_u32 s70, s70, s29
    s_add_u32 s70, s70, 148897792
    s_mov_b32 s67, 0x3dd53b95
    s_mov_b32 s96, 536870912
    s_mov_b32 s97, 536870912
    s_mov_b32 s26, 0
    s_mov_b32 s27, 0
    s_mul_i32 s30, s26, 40960
    s_mul_i32 s31, s24, 10240
    s_add_u32 s30, s30, s31
    s_add_u32 s31, s31, s27
    s_add_u32 m0, s31, 0
    s_nop 0
    buffer_load_dwordx4 v19, s[4:7], s30 offen offset:0 sc1 lds
    buffer_load_dwordx4 v19, s[4:7], s30 offen offset:1024 sc1 lds
    buffer_load_dwordx4 v19, s[4:7], s30 offen offset:2048 sc1 lds
    buffer_load_dwordx4 v19, s[4:7], s30 offen offset:3072 sc1 lds
    s_add_u32 m0, s31, 4096
    s_add_u32 s30, s30, 4096
    buffer_load_dwordx4 v19, s[4:7], s30 offen offset:0 sc1 lds
    buffer_load_dwordx4 v19, s[4:7], s30 offen offset:1024 sc1 lds
    buffer_load_dwordx4 v19, s[4:7], s30 offen offset:2048 sc1 lds
    buffer_load_dwordx4 v19, s[4:7], s30 offen offset:3072 sc1 lds
    s_add_u32 m0, s31, 8192
    s_add_u32 s30, s30, 4096
    buffer_load_dwordx4 v19, s[4:7], s30 offen offset:0 sc1 lds
    buffer_load_dwordx4 v19, s[4:7], s30 offen offset:1024 sc1 lds
    s_waitcnt vmcnt(0)
    s_barrier
    ds_read_b128 v[24:27], v20 offset:0
    ds_read_b128 v[28:31], v20 offset:20480
    ds_read_b128 v[32:35], v20 offset:1024
    ds_read_b128 v[36:39], v20 offset:21504
    ds_read_b128 v[40:43], v20 offset:2048
    ds_read_b128 v[44:47], v20 offset:22528
.p2align 6
LQ_top:
    s_add_u32 s66, s26, 1
    s_mov_b32 s32, 0
Lcf_47:
    v_cmp_gt_u32 vcc, s66, v101
    s_cbranch_vccnz Lcf1_48
    buffer_load_dwordx4 v[104:107], v94, s[4:7], s65 offen offset:0 sc1
    buffer_load_dwordx4 v[108:111], v94, s[4:7], s65 offen offset:1024 sc1
    buffer_load_dwordx4 v[112:115], v94, s[4:7], s65 offen offset:2048 sc1
    buffer_load_dwordx2 v[116:117], v93, s[4:7], s68 offen offset:0 sc1
    buffer_load_dwordx2 v[118:119], v93, s[4:7], s68 offen offset:256 sc1
    buffer_load_dwordx2 v[120:121], v93, s[4:7], s68 offen offset:512 sc1
    v_cmp_ge_u32 vcc, s66, v101
    s_cbranch_vccz Lff_49
    buffer_load_dword v101, v92, s[4:7], 0 offen sc1
Lff_49:
    s_add_u32 s66, s26, 1
    s_min_u32 s66, s66, 63
    s_add_u32 s27, s27, 40960
    s_cmp_ge_u32 s27, 122880
    s_cselect_b32 s27, 0, s27
    s_mul_i32 s30, s66, 40960
    s_mul_i32 s31, s24, 10240
    s_add_u32 s30, s30, s31
    s_add_u32 s31, s31, s27
    s_waitcnt lgkmcnt(4)
    v_mfma_f32_16x16x32_bf16 v[56:59], a[0:3], v[24:27], 0
    v_mfma_f32_16x16x32_bf16 v[64:67], a[80:83], v[24:27], 0
    v_mfma_f32_16x16x32_bf16 v[72:75], a[160:163], v[24:27], 0
    ds_read_b128 v[48:51], v20 offset:3072
    ds_read_b128 v[52:55], v20 offset:23552
    v_mfma_f32_16x16x32_bf16 v[60:63], a[0:3], v[28:31], 0
    s_add_u32 m0, s31, 0
    s_nop 0
    buffer_load_dwordx4 v19, s[4:7], s30 offen offset:0 sc1 lds
    v_mfma_f32_16x16x32_bf16 v[68:71], a[80:83], v[28:31], 0
    ds_write_b128 v95, v[152:155] offset:0
    v_mfma_f32_16x16x32_bf16 v[76:79], a[160:163], v[28:31], 0
    s_waitcnt lgkmcnt(5)
    v_mfma_f32_16x16x32_bf16 v[56:59], a[4:7], v[32:35], v[56:59]
    v_mfma_f32_16x16x32_bf16 v[64:67], a[84:87], v[32:35], v[64:67]
    v_mfma_f32_16x16x32_bf16 v[72:75], a[164:167], v[32:35], v[72:75]
    ds_read_b128 v[24:27], v20 offset:4096
    ds_read_b128 v[28:31], v20 offset:24576
    v_mfma_f32_16x16x32_bf16 v[60:63], a[4:7], v[36:39], v[60:63]
    buffer_load_dwordx4 v19, s[4:7], s30 offen offset:1024 sc1 lds
    v_mfma_f32_16x16x32_bf16 v[68:71], a[84:87], v[36:39], v[68:71]
    ds_write_b128 v95, v[164:167] offset:3072
    v_mfma_f32_16x16x32_bf16 v[76:79], a[164:167], v[36:39], v[76:79]
    s_waitcnt lgkmcnt(6)
    v_mfma_f32_16x16x32_bf16 v[56:59], a[8:11], v[40:43], v[56:59]
    v_mfma_f32_16x16x32_bf16 v[64:67], a[88:91], v[40:43], v[64:67]
    v_mfma_f32_16x16x32_bf16 v[72:75], a[168:171], v[40:43], v[72:75]
    ds_read_b128 v[32:35], v20 offset:5120
    ds_read_b128 v[36:39], v20 offset:25600
    v_mfma_f32_16x16x32_bf16 v[60:63], a[8:11], v[44:47], v[60:63]
    buffer_load_dwordx4 v19, s[4:7], s30 offen offset:2048 sc1 lds
    v_mfma_f32_16x16x32_bf16 v[68:71], a[88:91], v[44:47], v[68:71]
    ds_write_b128 v95, v[168:171] offset:4096
    v_mfma_f32_16x16x32_bf16 v[76:79], a[168:171], v[44:47], v[76:79]
    s_waitcnt lgkmcnt(7)
    v_mfma_f32_16x16x32_bf16 v[56:59], a[12:15], v[48:51], v[56:59]
    v_mfma_f32_16x16x32_bf16 v[64:67], a[92:95], v[48:51], v[64:67]
    v_mfma_f32_16x16x32_bf16 v[72:75], a[172:175], v[48:51], v[72:75]
    ds_read_b128 v[40:43], v20 offset:6144
    ds_read_b128 v[44:47], v20 offset:26624
    v_mfma_f32_16x16x32_bf16 v[60:63], a[12:15], v[52:55], v[60:63]
    buffer_load_dwordx4 v19, s[4:7], s30 offen offset:3072 sc1 lds
    v_mfma_f32_16x16x32_bf16 v[68:71], a[92:95], v[52:55], v[68:71]
    ds_write_b128 v95, v[160:163] offset:2048
    v_mfma_f32_16x16x32_bf16 v[76:79], a[172:175], v[52:55], v[76:79]
    s_waitcnt lgkmcnt(7)
    v_mfma_f32_16x16x32_bf16 v[56:59], a[16:19], v[24:27], v[56:59]
    v_mfma_f32_16x16x32_bf16 v[64:67], a[96:99], v[24:27], v[64:67]
    v_mfma_f32_16x16x32_bf16 v[72:75], a[176:179], v[24:27], v[72:75]
    ds_read_b128 v[48:51], v20 offset:7168
    ds_read_b128 v[52:55], v20 offset:27648
    v_mfma_f32_16x16x32_bf16 v[60:63], a[16:19], v[28:31], v[60:63]
    s_add_u32 m0, s31, 4096
    s_add_u32 s30, s30, 4096
    buffer_load_dwordx4 v19, s[4:7], s30 offen offset:0 sc1 lds
    v_mfma_f32_16x16x32_bf16 v[68:71], a[96:99], v[28:31], v[68:71]
    ds_write_b128 v95, v[172:175] offset:5120
    v_mfma_f32_16x16x32_bf16 v[76:79], a[176:179], v[28:31], v[76:79]
    s_waitcnt lgkmcnt(7)
    v_mfma_f32_16x16x32_bf16 v[56:59], a[20:23], v[32:35], v[56:59]
    v_mfma_f32_16x16x32_bf16 v[64:67], a[100:103], v[32:35], v[64:67]
    v_mfma_f32_16x16x32_bf16 v[72:75], a[180:183], v[32:35], v[72:75]
    ds_read_b128 v[24:27], v20 offset:8192
    ds_read_b128 v[28:31], v20 offset:28672
    v_mfma_f32_16x16x32_bf16 v[60:63], a[20:23], v[36:39], v[60:63]
    buffer_load_dwordx4 v19, s[4:7], s30 offen offset:1024 sc1 lds
    v_mfma_f32_16x16x32_bf16 v[68:71], a[100:103], v[36:39], v[68:71]
    v_mfma_f32_16x16x32_bf16 v[76:79], a[180:183], v[36:39], v[76:79]
    s_waitcnt lgkmcnt(6)
    v_mfma_f32_16x16x32_bf16 v[56:59], a[24:27], v[40:43], v[56:59]
    s_waitcnt lgkmcnt(2)
    s_barrier
    v_mfma_f32_16x16x32_bf16 v[64:67], a[104:107], v[40:43], v[64:67]
    ds_read_b128 v[124:127], v96 offset:0
    v_mfma_f32_16x16x32_bf16 v[72:75], a[184:187], v[40:43], v[72:75]
    ds_read_b128 v[32:35], v20 offset:9216
    ds_read_b128 v[36:39], v20 offset:29696
    v_mfma_f32_16x16x32_bf16 v[60:63], a[24:27], v[44:47], v[60:63]
    buffer_load_dwordx4 v19, s[4:7], s30 offen offset:2048 sc1 lds
    v_mfma_f32_16x16x32_bf16 v[68:71], a[104:107], v[44:47], v[68:71]
    ds_read_b128 v[128:131], v96 offset:6144
    v_mfma_f32_16x16x32_bf16 v[76:79], a[184:187], v[44:47], v[76:79]
    ds_read_b128 v[132:135], v96 offset:12288
    s_waitcnt lgkmcnt(8)
    v_mfma_f32_16x16x32_bf16 v[56:59], a[28:31], v[48:51], v[56:59]
    ds_read_b128 v[136:139], v96 offset:18432
    v_mfma_f32_16x16x32_bf16 v[64:67], a[108:111], v[48:51], v[64:67]
    ds_read2st64_b32 v[140:141], v97 offset0:0 offset1:24
    v_mfma_f32_16x16x32_bf16 v[72:75], a[188:191], v[48:51], v[72:75]
    ds_read_b128 v[40:43], v20 offset:10240
    ds_read_b128 v[44:47], v20 offset:30720
    v_mfma_f32_16x16x32_bf16 v[60:63], a[28:31], v[52:55], v[60:63]
    buffer_load_dwordx4 v19, s[4:7], s30 offen offset:3072 sc1 lds
    v_mfma_f32_16x16x32_bf16 v[68:71], a[108:111], v[52:55], v[68:71]
    ds_read2st64_b32 v[142:143], v97 offset0:48 offset1:72
    v_mfma_f32_16x16x32_bf16 v[76:79], a[188:191], v[52:55], v[76:79]
    s_waitcnt lgkmcnt(10)
    v_mfma_f32_16x16x32_bf16 v[56:59], a[32:35], v[24:27], v[56:59]
    v_mfma_f32_16x16x32_bf16 v[64:67], a[112:115], v[24:27], v[64:67]
    v_mfma_f32_16x16x32_bf16 v[72:75], a[192:195], v[24:27], v[72:75]
    ds_read_b128 v[48:51], v20 offset:11264
    ds_read_b128 v[52:55], v20 offset:31744
    v_mfma_f32_16x16x32_bf16 v[60:63], a[32:35], v[28:31], v[60:63]
    s_add_u32 m0, s31, 8192
    s_add_u32 s30, s30, 4096
    buffer_load_dwordx4 v19, s[4:7], s30 offen offset:0 sc1 lds
    v_mfma_f32_16x16x32_bf16 v[68:71], a[112:115], v[28:31], v[68:71]
    s_waitcnt lgkmcnt(2)
    v_mfma_f32_16x16x32_bf16 v[76:79], a[192:195], v[28:31], v[76:79]
    v_add_f32 v124, v124, v128
    v_add_f32 v125, v125, v129
    s_waitcnt lgkmcnt(9)
    v_mfma_f32_16x16x32_bf16 v[56:59], a[36:39], v[32:35], v[56:59]
    v_add_f32 v126, v126, v130
    v_add_f32 v127, v127, v131
    v_mfma_f32_16x16x32_bf16 v[64:67], a[116:119], v[32:35], v[64:67]
    v_add_f32 v132, v132, v136
    v_add_f32 v133, v133, v137
    v_mfma_f32_16x16x32_bf16 v[72:75], a[196:199], v[32:35], v[72:75]
    ds_read_b128 v[24:27], v20 offset:12288
    ds_read_b128 v[28:31], v20 offset:32768
    v_add_f32 v134, v134, v138
    v_mfma_f32_16x16x32_bf16 v[60:63], a[36:39], v[36:39], v[60:63]
    buffer_load_dwordx4 v19, s[4:7], s30 offen offset:1024 sc1 lds
    v_add_f32 v135, v135, v139
    v_mfma_f32_16x16x32_bf16 v[68:71], a[116:119], v[36:39], v[68:71]
    v_add_f32 v124, v124, v132
    v_add_f32 v125, v125, v133
    v_mfma_f32_16x16x32_bf16 v[76:79], a[196:199], v[36:39], v[76:79]
    v_add_f32 v126, v126, v134
    v_add_f32 v127, v127, v135
    s_waitcnt lgkmcnt(5)
    v_mfma_f32_16x16x32_bf16 v[56:59], a[40:43], v[40:43], v[56:59]
    v_cndmask_b32 v124, v100, v124, s[76:77]
    v_cndmask_b32 v125, v100, v125, s[78:79]
    v_mfma_f32_16x16x32_bf16 v[64:67], a[120:123], v[40:43], v[64:67]
    v_cndmask_b32 v126, v100, v126, s[80:81]
    v_cndmask_b32 v127, v100, v127, s[82:83]
    v_mfma_f32_16x16x32_bf16 v[72:75], a[200:203], v[40:43], v[72:75]
    ds_read_b128 v[32:35], v20 offset:13312
    ds_read_b128 v[36:39], v20 offset:33792
    v_add_f32 v140, v140, v141
    v_mfma_f32_16x16x32_bf16 v[60:63], a[40:43], v[44:47], v[60:63]
    v_add_f32 v142, v142, v143
    v_add_f32 v128, v140, v142
    v_mfma_f32_16x16x32_bf16 v[68:71], a[120:123], v[44:47], v[68:71]
    v_max3_f32 v176, v124, v125, v126
    v_max3_f32 v176, v176, v127, v128
    v_mfma_f32_16x16x32_bf16 v[76:79], a[200:203], v[44:47], v[76:79]
    s_waitcnt vmcnt(10)
    s_sub_u32 s28, s26, 1
    s_max_i32 s28, s28, 0
    v_mov_b32 v2, s28
    s_mov_b64 exec, 1
    buffer_store_dword v2, off, s[4:7], s35 sc1
    s_mov_b64 exec, -1
    s_waitcnt lgkmcnt(4)
    v_mfma_f32_16x16x32_bf16 v[56:59], a[44:47], v[48:51], v[56:59]
    v_max_f32_dpp v176, v176, v176 quad_perm:[1,0,3,2] row_mask:0xf bank_mask:0xf
    v_mfma_f32_16x16x32_bf16 v[64:67], a[124:127], v[48:51], v[64:67]
    v_mfma_f32_16x16x32_bf16 v[72:75], a[204:207], v[48:51], v[72:75]
    ds_read_b128 v[40:43], v20 offset:14336
    ds_read_b128 v[44:47], v20 offset:34816
    v_max_f32_dpp v176, v176, v176 quad_perm:[2,3,0,1] row_mask:0xf bank_mask:0xf
    v_mfma_f32_16x16x32_bf16 v[60:63], a[44:47], v[52:55], v[60:63]
    v_mfma_f32_16x16x32_bf16 v[68:71], a[124:127], v[52:55], v[68:71]
    v_max_f32_dpp v176, v176, v176 row_half_mirror row_mask:0xf bank_mask:0xf
    v_mul_f32 v176, s67, v176
    v_mfma_f32_16x16x32_bf16 v[76:79], a[204:207], v[52:55], v[76:79]
    v_fma_f32 v124, v124, s67, -v176
    v_fma_f32 v125, v125, s67, -v176
    s_waitcnt lgkmcnt(4)
    v_mfma_f32_16x16x32_bf16 v[56:59], a[48:51], v[24:27], v[56:59]
    v_fma_f32 v126, v126, s67, -v176
    v_fma_f32 v127, v127, s67, -v176
    v_mfma_f32_16x16x32_bf16 v[64:67], a[128:131], v[24:27], v[64:67]
    v_fma_f32 v128, v128, s67, -v176
    v_exp_f32 v124, v124
    v_mfma_f32_16x16x32_bf16 v[72:75], a[208:211], v[24:27], v[72:75]
    ds_read_b128 v[48:51], v20 offset:15360
    ds_read_b128 v[52:55], v20 offset:35840
    v_exp_f32 v125, v125
    v_mfma_f32_16x16x32_bf16 v[60:63], a[48:51], v[28:31], v[60:63]
    v_exp_f32 v126, v126
    v_exp_f32 v127, v127
    v_mfma_f32_16x16x32_bf16 v[68:71], a[128:131], v[28:31], v[68:71]
    v_exp_f32 v128, v128
    v_add_f32 v176, v124, v125
    v_mfma_f32_16x16x32_bf16 v[76:79], a[208:211], v[28:31], v[76:79]
    v_add_f32 v177, v126, v127
    v_add_f32 v176, v176, v128
    s_waitcnt lgkmcnt(4)
    v_mfma_f32_16x16x32_bf16 v[56:59], a[52:55], v[32:35], v[56:59]
    v_add_f32 v176, v176, v177
    v_mfma_f32_16x16x32_bf16 v[64:67], a[132:135], v[32:35], v[64:67]
    v_mfma_f32_16x16x32_bf16 v[72:75], a[212:215], v[32:35], v[72:75]
    ds_read_b128 v[24:27], v20 offset:16384
    ds_read_b128 v[28:31], v20 offset:36864
    v_add_f32_dpp v176, v176, v176 quad_perm:[1,0,3,2] row_mask:0xf bank_mask:0xf
    v_mfma_f32_16x16x32_bf16 v[60:63], a[52:55], v[36:39], v[60:63]
    v_mfma_f32_16x16x32_bf16 v[68:71], a[132:135], v[36:39], v[68:71]
    v_add_f32_dpp v176, v176, v176 quad_perm:[2,3,0,1] row_mask:0xf bank_mask:0xf
    v_mfma_f32_16x16x32_bf16 v[76:79], a[212:215], v[36:39], v[76:79]
    s_waitcnt lgkmcnt(4)
    v_mfma_f32_16x16x32_bf16 v[56:59], a[56:59], v[40:43], v[56:59]
    v_add_f32_dpp v176, v176, v176 row_half_mirror row_mask:0xf bank_mask:0xf
    v_rcp_f32 v176, v176
    v_mfma_f32_16x16x32_bf16 v[64:67], a[136:139], v[40:43], v[64:67]
    v_mul_f32 v128, v128, v176
    v_mul_f32 v124, v124, v176
    v_mfma_f32_16x16x32_bf16 v[72:75], a[216:219], v[40:43], v[72:75]
    ds_read_b128 v[32:35], v20 offset:17408
    ds_read_b128 v[36:39], v20 offset:37888
    v_mul_f32 v125, v125, v176
    v_mfma_f32_16x16x32_bf16 v[60:63], a[56:59], v[44:47], v[60:63]
    v_mul_f32 v126, v126, v176
    v_mul_f32 v127, v127, v176
    v_mfma_f32_16x16x32_bf16 v[68:71], a[136:139], v[44:47], v[68:71]
    v_cvt_pk_bf16_f32 v130, v124, v125
    v_cvt_pk_bf16_f32 v131, v126, v127
    v_mfma_f32_16x16x32_bf16 v[76:79], a[216:219], v[44:47], v[76:79]
    s_waitcnt lgkmcnt(4)
    v_mfma_f32_16x16x32_bf16 v[56:59], a[60:63], v[48:51], v[56:59]
    v_mov_b32_dpp v129, v128 quad_perm:[1,0,3,2] row_mask:0xf bank_mask:0xf
    v_mfma_f32_16x16x32_bf16 v[64:67], a[140:143], v[48:51], v[64:67]
    v_mfma_f32_16x16x32_bf16 v[72:75], a[220:223], v[48:51], v[72:75]
    ds_read_b128 v[40:43], v20 offset:18432
    ds_read_b128 v[44:47], v20 offset:38912
    v_mov_b32_dpp v132, v130 quad_perm:[1,0,3,2] row_mask:0xf bank_mask:0xf
    v_mfma_f32_16x16x32_bf16 v[60:63], a[60:63], v[52:55], v[60:63]
    v_mfma_f32_16x16x32_bf16 v[68:71], a[140:143], v[52:55], v[68:71]
    v_mov_b32_dpp v133, v131 quad_perm:[1,0,3,2] row_mask:0xf bank_mask:0xf
    v_cvt_pk_bf16_f32 v128, v128, v129
    v_mfma_f32_16x16x32_bf16 v[76:79], a[220:223], v[52:55], v[76:79]
    v_cndmask_b32 v130, v133, v130, s[84:85]
    v_cndmask_b32 v131, v131, v132, s[84:85]
    s_waitcnt lgkmcnt(4)
    v_mfma_f32_16x16x32_bf16 v[56:59], a[64:67], v[24:27], v[56:59]
    buffer_store_dwordx2 v[130:131], v98, s[4:7], s96 offen sc1
    v_mfma_f32_16x16x32_bf16 v[64:67], a[144:147], v[24:27], v[64:67]
    buffer_store_dword v128, v99, s[4:7], s97 offen sc1
    v_mfma_f32_16x16x32_bf16 v[72:75], a[224:227], v[24:27], v[72:75]
    ds_read_b128 v[48:51], v20 offset:19456
    ds_read_b128 v[52:55], v20 offset:39936
    v_mfma_f32_16x16x32_bf16 v[60:63], a[64:67], v[28:31], v[60:63]
    v_mfma_f32_16x16x32_bf16 v[68:71], a[144:147], v[28:31], v[68:71]
    v_mfma_f32_16x16x32_bf16 v[76:79], a[224:227], v[28:31], v[76:79]
    s_waitcnt lgkmcnt(4)
    v_mfma_f32_16x16x32_bf16 v[56:59], a[68:71], v[32:35], v[56:59]
    v_mfma_f32_16x16x32_bf16 v[64:67], a[148:151], v[32:35], v[64:67]
    v_mfma_f32_16x16x32_bf16 v[72:75], a[228:231], v[32:35], v[72:75]
    s_waitcnt vmcnt(3)
    s_barrier
    v_add_u32 v20, s27, v19
    ds_read_b128 v[24:27], v20 offset:0
    ds_read_b128 v[28:31], v20 offset:20480
    v_max3_u32 v148, v116, v118, v120
    v_cmp_eq_u32 vcc, -1, v148
    s_mov_b32 s71, 0
    s_cbranch_vccz LQ_have
    buffer_load_dwordx2 v[116:117], v93, s[4:7], s68 offen offset:0 sc1
    buffer_load_dwordx2 v[118:119], v93, s[4:7], s68 offen offset:256 sc1
    buffer_load_dwordx2 v[120:121], v93, s[4:7], s68 offen offset:512 sc1
    s_mov_b32 s71, 1
LQ_have:
    v_mfma_f32_16x16x32_bf16 v[60:63], a[68:71], v[36:39], v[60:63]
    v_mfma_f32_16x16x32_bf16 v[68:71], a[148:151], v[36:39], v[68:71]
    v_mfma_f32_16x16x32_bf16 v[76:79], a[228:231], v[36:39], v[76:79]
    s_waitcnt lgkmcnt(4)
    v_mfma_f32_16x16x32_bf16 v[56:59], a[72:75], v[40:43], v[56:59]
    v_mfma_f32_16x16x32_bf16 v[64:67], a[152:155], v[40:43], v[64:67]
    v_mfma_f32_16x16x32_bf16 v[72:75], a[232:235], v[40:43], v[72:75]
    ds_read_b128 v[32:35], v20 offset:1024
    ds_read_b128 v[36:39], v20 offset:21504
    v_mfma_f32_16x16x32_bf16 v[60:63], a[72:75], v[44:47], v[60:63]
    v_mfma_f32_16x16x32_bf16 v[68:71], a[152:155], v[44:47], v[68:71]
    v_mfma_f32_16x16x32_bf16 v[76:79], a[232:235], v[44:47], v[76:79]
    s_waitcnt lgkmcnt(4)
    v_mfma_f32_16x16x32_bf16 v[56:59], a[76:79], v[48:51], v[56:59]
    v_mfma_f32_16x16x32_bf16 v[64:67], a[156:159], v[48:51], v[64:67]
    v_mfma_f32_16x16x32_bf16 v[72:75], a[236:239], v[48:51], v[72:75]
    ds_read_b128 v[40:43], v20 offset:2048
    ds_read_b128 v[44:47], v20 offset:22528
    v_mfma_f32_16x16x32_bf16 v[60:63], a[76:79], v[52:55], v[60:63]
    v_mfma_f32_16x16x32_bf16 v[68:71], a[156:159], v[52:55], v[68:71]
    v_mfma_f32_16x16x32_bf16 v[76:79], a[236:239], v[52:55], v[76:79]
    v_cvt_pk_bf16_f32 v80, v56, v57
    v_cvt_pk_bf16_f32 v81, v58, v59
    v_cvt_pk_bf16_f32 v82, v60, v61
    v_cvt_pk_bf16_f32 v83, v62, v63
    v_cvt_pk_bf16_f32 v84, v64, v65
    v_cvt_pk_bf16_f32 v85, v66, v67
    v_cvt_pk_bf16_f32 v86, v68, v69
    v_cvt_pk_bf16_f32 v87, v70, v71
    v_cvt_pk_bf16_f32 v88, v72, v73
    v_cvt_pk_bf16_f32 v89, v74, v75
    v_cvt_pk_bf16_f32 v90, v76, v77
    v_cvt_pk_bf16_f32 v91, v78, v79
    v_mfma_f32_16x16x16_bf16 v[152:155], v[104:105], v[80:81], 0
    v_mfma_f32_16x16x16_bf16 v[164:167], v[104:105], v[82:83], 0
    v_mfma_f32_16x16x16_bf16 v[168:171], v[106:107], v[82:83], 0
    v_mfma_f32_16x16x16_bf16 v[152:155], v[108:109], v[84:85], v[152:155]
    v_mfma_f32_16x16x16_bf16 v[164:167], v[108:109], v[86:87], v[164:167]
    v_mfma_f32_16x16x16_bf16 v[168:171], v[110:111], v[86:87], v[168:171]
    v_mfma_f32_16x16x16_bf16 v[152:155], v[112:113], v[88:89], v[152:155]
    v_mfma_f32_16x16x16_bf16 v[164:167], v[112:113], v[90:91], v[164:167]
    v_mfma_f32_16x16x16_bf16 v[168:171], v[114:115], v[90:91], v[168:171]
    s_mov_b32 s32, 0
    s_cmp_eq_u32 s71, 0
    s_cbranch_scc0 LQ_late
LQ_go:
    v_mfma_f32_16x16x16_bf16 v[160:163], v[116:117], v[80:81], 0
    v_mfma_f32_16x16x16_bf16 v[172:175], v[116:117], v[82:83], 0
    v_mfma_f32_16x16x16_bf16 v[160:163], v[118:119], v[84:85], v[160:163]
    v_mfma_f32_16x16x16_bf16 v[172:175], v[118:119], v[86:87], v[172:175]
    v_mfma_f32_16x16x16_bf16 v[160:163], v[120:121], v[88:89], v[160:163]
    v_mfma_f32_16x16x16_bf16 v[172:175], v[120:121], v[90:91], v[172:175]
    s_add_u32 s65, s65, 393216
    s_add_u32 s68, s68, 1048576
    s_mov_b32 s96, s69
    s_mov_b32 s97, s70
    s_add_u32 s69, s69, 65536
    s_add_u32 s70, s70, 16384
    s_mov_b32 s71, 0
    s_add_u32 s26, s26, 1
    s_cmp_lt_u32 s26, 64
    s_cbranch_scc1 LQ_top
    ds_write_b128 v95, v[152:155] offset:0
    ds_write_b128 v95, v[164:167] offset:3072
    ds_write_b128 v95, v[168:171] offset:4096
    ds_write_b128 v95, v[160:163] offset:2048
    ds_write_b128 v95, v[172:175] offset:5120
    s_waitcnt lgkmcnt(0)
    s_barrier
    ds_read_b128 v[124:127], v96 offset:0
    ds_read_b128 v[128:131], v96 offset:6144
    ds_read_b128 v[132:135], v96 offset:12288
    ds_read_b128 v[136:139], v96 offset:18432
    ds_read2st64_b32 v[140:141], v97 offset0:0 offset1:24
    ds_read2st64_b32 v[142:143], v97 offset0:48 offset1:72
    s_waitcnt lgkmcnt(0)
    v_add_f32 v124, v124, v128
    v_add_f32 v125, v125, v129
    v_add_f32 v126, v126, v130
    v_add_f32 v127, v127, v131
    v_add_f32 v132, v132, v136
    v_add_f32 v133, v133, v137
    v_add_f32 v134, v134, v138
    v_add_f32 v135, v135, v139
    v_add_f32 v124, v124, v132
    v_add_f32 v125, v125, v133
    v_add_f32 v126, v126, v134
    v_add_f32 v127, v127, v135
    v_cndmask_b32 v124, v100, v124, s[76:77]
    v_cndmask_b32 v125, v100, v125, s[78:79]
    v_cndmask_b32 v126, v100, v126, s[80:81]
    v_cndmask_b32 v127, v100, v127, s[82:83]
    v_add_f32 v140, v140, v141
    v_add_f32 v142, v142, v143
    v_add_f32 v128, v140, v142
    v_max3_f32 v176, v124, v125, v126
    v_max3_f32 v176, v176, v127, v128
    s_nop 1
    v_max_f32_dpp v176, v176, v176 quad_perm:[1,0,3,2] row_mask:0xf bank_mask:0xf
    s_nop 1
    v_max_f32_dpp v176, v176, v176 quad_perm:[2,3,0,1] row_mask:0xf bank_mask:0xf
    s_nop 1
    v_max_f32_dpp v176, v176, v176 row_half_mirror row_mask:0xf bank_mask:0xf
    v_mul_f32 v176, s67, v176
    v_fma_f32 v124, v124, s67, -v176
    v_fma_f32 v125, v125, s67, -v176
    v_fma_f32 v126, v126, s67, -v176
    v_fma_f32 v127, v127, s67, -v176
    v_fma_f32 v128, v128, s67, -v176
    v_exp_f32 v124, v124
    v_exp_f32 v125, v125
    v_exp_f32 v126, v126
    v_exp_f32 v127, v127
    v_exp_f32 v128, v128
    v_add_f32 v176, v124, v125
    v_add_f32 v177, v126, v127
    v_add_f32 v176, v176, v128
    v_add_f32 v176, v176, v177
    s_nop 1
    v_add_f32_dpp v176, v176, v176 quad_perm:[1,0,3,2] row_mask:0xf bank_mask:0xf
    s_nop 1
    v_add_f32_dpp v176, v176, v176 quad_perm:[2,3,0,1] row_mask:0xf bank_mask:0xf
    s_nop 1
    v_add_f32_dpp v176, v176, v176 row_half_mirror row_mask:0xf bank_mask:0xf
    v_rcp_f32 v176, v176
    s_nop 0
    v_mul_f32 v128, v128, v176
    v_mul_f32 v124, v124, v176
    v_mul_f32 v125, v125, v176
    v_mul_f32 v126, v126, v176
    v_mul_f32 v127, v127, v176
    v_cvt_pk_bf16_f32 v130, v124, v125
    v_cvt_pk_bf16_f32 v131, v126, v127
    v_mov_b32_dpp v129, v128 quad_perm:[1,0,3,2] row_mask:0xf bank_mask:0xf
    v_mov_b32_dpp v132, v130 quad_perm:[1,0,3,2] row_mask:0xf bank_mask:0xf
    v_mov_b32_dpp v133, v131 quad_perm:[1,0,3,2] row_mask:0xf bank_mask:0xf
    v_cvt_pk_bf16_f32 v128, v128, v129
    v_cndmask_b32 v130, v133, v130, s[84:85]
    v_cndmask_b32 v131, v131, v132, s[84:85]
    buffer_store_dwordx2 v[130:131], v98, s[4:7], s96 offen sc1
    buffer_store_dword v128, v99, s[4:7], s97 offen sc1
    s_waitcnt vmcnt(0)
    v_mov_b32 v2, s26
    s_mov_b64 exec, 1
    buffer_store_dword v2, off, s[4:7], s35 sc1
    s_mov_b64 exec, -1
    s_endpgm
LQ_late:
    s_waitcnt vmcnt(0)
    v_mov_b32 v2, s26
    s_mov_b64 exec, 1
    buffer_store_dword v2, off, s[4:7], s35 sc1
    s_mov_b64 exec, -1
LQ_chk:
    v_max3_u32 v148, v116, v118, v120
    v_cmp_eq_u32 vcc, -1, v148
    s_cbranch_vccnz Lretry_50
    s_branch LQ_go
Lretry_43:
    s_sleep 6
    buffer_load_dwordx2 v[2:3], off, s[16:19], 0 offset:128 sc1
    s_waitcnt vmcnt(0)
    s_add_u32 s32, s32, 1
    s_cmp_lt_u32 s32, 200000
    s_cbranch_scc1 Lws_42
    v_mov_b32 v2, 1
    v_mov_b32 v3, 4
    buffer_store_dword v2, v3, s[16:19], 0 offen sc1
    s_endpgm
Lretry_46:
    s_sleep 24
    buffer_load_dword v2, v3, s[4:7], 0 offen sc1
    s_waitcnt vmcnt(0)
    s_add_u32 s32, s32, 1
    s_cmp_lt_u32 s32, 200000
    s_cbranch_scc1 Lwf_44
    v_mov_b32 v2, 3
    v_mov_b32 v3, 4
    buffer_store_dword v2, v3, s[16:19], 0 offen sc1
    s_endpgm
Lcf1_48:
    s_cmp_eq_u32 s32, 0
    s_cbranch_scc1 Lcf1_48s
    s_sleep 8
Lcf1_48s:
    buffer_load_dword v101, v92, s[4:7], 0 offen sc1
    s_waitcnt vmcnt(0)
    s_add_u32 s32, s32, 1
    s_cmp_lt_u32 s32, 200000
    s_cbranch_scc1 Lcf_47
    v_mov_b32 v2, 30
    v_mov_b32 v3, 4
    buffer_store_dword v2, v3, s[16:19], 0 offen sc1
    s_endpgm
Lretry_50:
    s_cmp_ge_u32 s26, 63
    s_cbranch_scc1 Lretry_50n
    s_sleep 4
Lretry_50n:
    s_sleep 1
    buffer_load_dwordx2 v[116:117], v93, s[4:7], s68 offen offset:0 sc1
    buffer_load_dwordx2 v[118:119], v93, s[4:7], s68 offen offset:256 sc1
    buffer_load_dwordx2 v[120:121], v93, s[4:7], s68 offen offset:512 sc1
    s_waitcnt vmcnt(0)
    s_add_u32 s32, s32, 1
    s_cmp_lt_u32 s32, 200000
    s_cbranch_scc1 LQ_chk
    v_mov_b32 v2, 31
    v_mov_b32 v3, 4
    buffer_store_dword v2, v3, s[16:19], 0 offen sc1
    s_endpgm
E_Q:
.p2align 6
W_H:
R_H:
    s_lshl_b32 s35, s25, 9
    s_lshl_b32 s28, s24, 7
    s_add_u32 s35, s35, s28
    s_add_u32 s35, s35, 163627008
    v_mov_b32 v2, 0
    s_mov_b64 exec, 1
    buffer_store_dword v2, off, s[4:7], s35 sc1
    s_mov_b64 exec, -1
    s_waitcnt vmcnt(0)
    s_barrier
    s_cmp_lg_u32 s24, 0
    s_cbranch_scc1 Larr_51
    s_and_b32 s28, s2, 1
    s_lshl_b32 s28, s28, 6
    v_mov_b32 v2, 1
    s_mov_b64 exec, 1
    buffer_atomic_add v2, off, s[16:19], s28 sc1
    s_mov_b64 exec, -1
Larr_51:
    s_mov_b32 s32, 0
    buffer_load_dwordx2 v[2:3], off, s[16:19], 0 offset:128 sc1
    s_waitcnt vmcnt(0)
Lws_52:
    v_readfirstlane_b32 s28, v2
    s_nop 0
    s_cmp_eq_u32 s28, 0
    s_cbranch_scc1 Lretry_53
    s_and_b32 s28, s25, 15
    s_lshl_b32 s28, s28, 9
    s_add_u32 s28, s28, 163594240
    v_mov_b32 v3, s28
    s_mov_b32 s66, 1
    s_mov_b32 s32, 0
    buffer_load_dword v2, v3, s[4:7], 0 offen sc1
    s_waitcnt vmcnt(0)
Lwf_54:
    v_cmp_gt_u32 vcc, s66, v2
    s_cbranch_vccnz Lretry_56
Lwfd_55:
    s_mov_b32 s8, s52
    s_mov_b32 s9, s53
    s_mov_b32 s10, 1966080
    s_mov_b32 s11, 0x20000
    s_and_b32 s28, s24, 1
    s_lshl_b32 s28, s28, 2
    v_lshrrev_b32 v2, 5, v1
    v_add_u32 v2, 0, v2
    v_or_b32 v3, s28, v2
    v_lshlrev_b32 v3, 1, v3
    v_and_b32 v4, 31, v1
    v_xor_b32 v4, v4, v3
    v_mul_u32_u24 v2, 3072, v2
    v_lshl_add_u32 v6, v4, 4, v2
    v_lshrrev_b32 v2, 5, v1
    v_add_u32 v2, 2, v2
    v_or_b32 v3, s28, v2
    v_lshlrev_b32 v3, 1, v3
    v_and_b32 v4, 31, v1
    v_xor_b32 v4, v4, v3
    v_mul_u32_u24 v2, 3072, v2
    v_lshl_add_u32 v7, v4, 4, v2
    v_bfe_u32 v2, v1, 2, 3
    v_lshrrev_b32 v3, 4, v1
    v_lshlrev_b32 v3, 3, v3
    v_bfe_u32 v4, v1, 2, 2
    v_add_u32 v3, v3, v4
    v_lshlrev_b32 v3, 9, v3
    v_and_b32 v4, 3, v1
    v_lshl_add_u32 v3, v4, 3, v3
    s_lshl_b32 s28, s24, 2
    s_add_u32 s28, s28, 0
    v_xor_b32 v10, s28, v2
    v_lshl_add_u32 v10, v10, 5, v3
    v_add_u32 v11, 49152, v10
    v_add_u32 v12, 98304, v10
    s_lshl_b32 s28, s24, 2
    s_add_u32 s28, s28, 1
    v_xor_b32 v13, s28, v2
    v_lshl_add_u32 v13, v13, 5, v3
    v_add_u32 v14, 49152, v13
    v_add_u32 v15, 98304, v13
    s_lshl_b32 s28, s24, 2
    s_add_u32 s28, s28, 2
    v_xor_b32 v16, s28, v2
    v_lshl_add_u32 v16, v16, 5, v3
    v_add_u32 v17, 49152, v16
    v_add_u32 v18, 98304, v16
    s_lshl_b32 s28, s24, 2
    s_add_u32 s28, s28, 3
    v_xor_b32 v19, s28, v2
    v_lshl_add_u32 v19, v19, 5, v3
    v_add_u32 v20, 49152, v19
    v_add_u32 v21, 98304, v19
    s_mul_i32 s64, s24, 24576
    s_lshl_b32 s28, s25, 9
    s_add_u32 s64, s64, s28
    s_mul_i32 s29, s24, 4096
    s_add_u32 s28, s64, 0
    s_add_u32 m0, s29, 0
    s_nop 0
    buffer_load_dwordx4 v6, s[8:11], s28 offen lds
    s_add_u32 m0, s29, 1024
    s_nop 0
    buffer_load_dwordx4 v7, s[8:11], s28 offen lds
    s_add_u32 s28, s64, 12288
    s_add_u32 m0, s29, 2048
    s_nop 0
    buffer_load_dwordx4 v6, s[8:11], s28 offen lds
    s_add_u32 m0, s29, 3072
    s_nop 0
    buffer_load_dwordx4 v7, s[8:11], s28 offen lds
    s_mul_i32 s29, s24, 4096
    s_add_u32 s28, s64, 98304
    s_add_u32 m0, s29, 24576
    s_nop 0
    buffer_load_dwordx4 v6, s[8:11], s28 offen lds
    s_add_u32 m0, s29, 25600
    s_nop 0
    buffer_load_dwordx4 v7, s[8:11], s28 offen lds
    s_add_u32 s28, s64, 110592
    s_add_u32 m0, s29, 26624
    s_nop 0
    buffer_load_dwordx4 v6, s[8:11], s28 offen lds
    s_add_u32 m0, s29, 27648
    s_nop 0
    buffer_load_dwordx4 v7, s[8:11], s28 offen lds
    s_mul_i32 s29, s24, 4096
    s_add_u32 s28, s64, 196608
    s_add_u32 m0, s29, 49152
    s_nop 0
    buffer_load_dwordx4 v6, s[8:11], s28 offen lds
    s_add_u32 m0, s29, 50176
    s_nop 0
    buffer_load_dwordx4 v7, s[8:11], s28 offen lds
    s_add_u32 s28, s64, 208896
    s_add_u32 m0, s29, 51200
    s_nop 0
    buffer_load_dwordx4 v6, s[8:11], s28 offen lds
    s_add_u32 m0, s29, 52224
    s_nop 0
    buffer_load_dwordx4 v7, s[8:11], s28 offen lds
    s_mul_i32 s29, s24, 4096
    s_add_u32 s28, s64, 294912
    s_add_u32 m0, s29, 73728
    s_nop 0
    buffer_load_dwordx4 v6, s[8:11], s28 offen lds
    s_add_u32 m0, s29, 74752
    s_nop 0
    buffer_load_dwordx4 v7, s[8:11], s28 offen lds
    s_add_u32 s28, s64, 307200
    s_add_u32 m0, s29, 75776
    s_nop 0
    buffer_load_dwordx4 v6, s[8:11], s28 offen lds
    s_add_u32 m0, s29, 76800
    s_nop 0
    buffer_load_dwordx4 v7, s[8:11], s28 offen lds
    s_mul_i32 s29, s24, 4096
    s_add_u32 s28, s64, 393216
    s_add_u32 m0, s29, 98304
    s_nop 0
    buffer_load_dwordx4 v6, s[8:11], s28 offen lds
    s_add_u32 m0, s29, 99328
    s_nop 0
    buffer_load_dwordx4 v7, s[8:11], s28 offen lds
    s_add_u32 s28, s64, 405504
    s_add_u32 m0, s29, 100352
    s_nop 0
    buffer_load_dwordx4 v6, s[8:11], s28 offen lds
    s_add_u32 m0, s29, 101376
    s_nop 0
    buffer_load_dwordx4 v7, s[8:11], s28 offen lds
    s_mul_i32 s29, s24, 4096
    s_add_u32 s28, s64, 491520
    s_add_u32 m0, s29, 122880
    s_nop 0
    buffer_load_dwordx4 v6, s[8:11], s28 offen lds
    s_add_u32 m0, s29, 123904
    s_nop 0
    buffer_load_dwordx4 v7, s[8:11], s28 offen lds
    s_add_u32 s28, s64, 503808
    s_add_u32 m0, s29, 124928
    s_nop 0
    buffer_load_dwordx4 v6, s[8:11], s28 offen lds
    s_add_u32 m0, s29, 125952
    s_nop 0
    buffer_load_dwordx4 v7, s[8:11], s28 offen lds
    s_waitcnt vmcnt(20)
    s_waitcnt lgkmcnt(0)
    s_barrier
    ds_read_b64_tr_b16 a[0:1], v10 offset:0
    ds_read_b64_tr_b16 a[2:3], v10 offset:2048
    ds_read_b64_tr_b16 a[80:81], v13 offset:0
    ds_read_b64_tr_b16 a[82:83], v13 offset:2048
    ds_read_b64_tr_b16 a[160:161], v16 offset:0
    ds_read_b64_tr_b16 a[162:163], v16 offset:2048
    ds_read_b64_tr_b16 a[240:241], v19 offset:0
    ds_read_b64_tr_b16 a[242:243], v19 offset:2048
    s_waitcnt vmcnt(16)
    s_waitcnt lgkmcnt(0)
    s_barrier
    ds_read_b64_tr_b16 a[4:5], v10 offset:24576
    ds_read_b64_tr_b16 a[6:7], v10 offset:26624
    ds_read_b64_tr_b16 a[84:85], v13 offset:24576
    ds_read_b64_tr_b16 a[86:87], v13 offset:26624
    ds_read_b64_tr_b16 a[164:165], v16 offset:24576
    ds_read_b64_tr_b16 a[166:167], v16 offset:26624
    ds_read_b64_tr_b16 a[244:245], v19 offset:24576
    ds_read_b64_tr_b16 a[246:247], v19 offset:26624
    s_mul_i32 s29, s24, 4096
    s_add_u32 s28, s64, 589824
    s_add_u32 m0, s29, 0
    s_nop 0
    buffer_load_dwordx4 v6, s[8:11], s28 offen lds
    s_add_u32 m0, s29, 1024
    s_nop 0
    buffer_load_dwordx4 v7, s[8:11], s28 offen lds
    s_add_u32 s28, s64, 602112
    s_add_u32 m0, s29, 2048
    s_nop 0
    buffer_load_dwordx4 v6, s[8:11], s28 offen lds
    s_add_u32 m0, s29, 3072
    s_nop 0
    buffer_load_dwordx4 v7, s[8:11], s28 offen lds
    s_waitcnt vmcnt(16)
    s_waitcnt lgkmcnt(0)
    s_barrier
    ds_read_b64_tr_b16 a[8:9], v11 offset:0
    ds_read_b64_tr_b16 a[10:11], v11 offset:2048
    ds_read_b64_tr_b16 a[88:89], v14 offset:0
    ds_read_b64_tr_b16 a[90:91], v14 offset:2048
    ds_read_b64_tr_b16 a[168:169], v17 offset:0
    ds_read_b64_tr_b16 a[170:171], v17 offset:2048
    ds_read_b64_tr_b16 a[248:249], v20 offset:0
    ds_read_b64_tr_b16 a[250:251], v20 offset:2048
    s_mul_i32 s29, s24, 4096
    s_add_u32 s28, s64, 688128
    s_add_u32 m0, s29, 24576
    s_nop 0
    buffer_load_dwordx4 v6, s[8:11], s28 offen lds
    s_add_u32 m0, s29, 25600
    s_nop 0
    buffer_load_dwordx4 v7, s[8:11], s28 offen lds
    s_add_u32 s28, s64, 700416
    s_add_u32 m0, s29, 26624
    s_nop 0
    buffer_load_dwordx4 v6, s[8:11], s28 offen lds
    s_add_u32 m0, s29, 27648
    s_nop 0
    buffer_load_dwordx4 v7, s[8:11], s28 offen lds
    s_waitcnt vmcnt(16)
    s_waitcnt lgkmcnt(0)
    s_barrier
    ds_read_b64_tr_b16 a[12:13], v11 offset:24576
    ds_read_b64_tr_b16 a[14:15], v11 offset:26624
    ds_read_b64_tr_b16 a[92:93], v14 offset:24576
    ds_read_b64_tr_b16 a[94:95], v14 offset:26624
    ds_read_b64_tr_b16 a[172:173], v17 offset:24576
    ds_read_b64_tr_b16 a[174:175], v17 offset:26624
    ds_read_b64_tr_b16 a[252:253], v20 offset:24576
    ds_read_b64_tr_b16 a[254:255], v20 offset:26624
    s_mul_i32 s29, s24, 4096
    s_add_u32 s28, s64, 786432
    s_add_u32 m0, s29, 49152
    s_nop 0
    buffer_load_dwordx4 v6, s[8:11], s28 offen lds
    s_add_u32 m0, s29, 50176
    s_nop 0
    buffer_load_dwordx4 v7, s[8:11], s28 offen lds
    s_add_u32 s28, s64, 798720
    s_add_u32 m0, s29, 51200
    s_nop 0
    buffer_load_dwordx4 v6, s[8:11], s28 offen lds
    s_add_u32 m0, s29, 52224
    s_nop 0
    buffer_load_dwordx4 v7, s[8:11], s28 offen lds
    s_waitcnt vmcnt(16)
    s_waitcnt lgkmcnt(0)
    s_barrier
    ds_read_b64_tr_b16 a[16:17], v12 offset:0
    ds_read_b64_tr_b16 a[18:19], v12 offset:2048
    ds_read_b64_tr_b16 a[96:97], v15 offset:0
    ds_read_b64_tr_b16 a[98:99], v15 offset:2048
    ds_read_b64_tr_b16 a[176:177], v18 offset:0
    ds_read_b64_tr_b16 a[178:179], v18 offset:2048
    ds_read_b64_tr_b16 v[192:193], v21 offset:0
    ds_read_b64_tr_b16 v[194:195], v21 offset:2048
    s_mul_i32 s29, s24, 4096
    s_add_u32 s28, s64, 884736
    s_add_u32 m0, s29, 73728
    s_nop 0
    buffer_load_dwordx4 v6, s[8:11], s28 offen lds
    s_add_u32 m0, s29, 74752
    s_nop 0
    buffer_load_dwordx4 v7, s[8:11], s28 offen lds
    s_add_u32 s28, s64, 897024
    s_add_u32 m0, s29, 75776
    s_nop 0
    buffer_load_dwordx4 v6, s[8:11], s28 offen lds
    s_add_u32 m0, s29, 76800
    s_nop 0
    buffer_load_dwordx4 v7, s[8:11], s28 offen lds
    s_waitcnt vmcnt(16)
    s_waitcnt lgkmcnt(0)
    s_barrier
    ds_read_b64_tr_b16 a[20:21], v12 offset:24576
    ds_read_b64_tr_b16 a[22:23], v12 offset:26624
    ds_read_b64_tr_b16 a[100:101], v15 offset:24576
    ds_read_b64_tr_b16 a[102:103], v15 offset:26624
    ds_read_b64_tr_b16 a[180:181], v18 offset:24576
    ds_read_b64_tr_b16 a[182:183], v18 offset:26624
    ds_read_b64_tr_b16 v[196:197], v21 offset:24576
    ds_read_b64_tr_b16 v[198:199], v21 offset:26624
    s_mul_i32 s29, s24, 4096
    s_add_u32 s28, s64, 983040
    s_add_u32 m0, s29, 98304
    s_nop 0
    buffer_load_dwordx4 v6, s[8:11], s28 offen lds
    s_add_u32 m0, s29, 99328
    s_nop 0
    buffer_load_dwordx4 v7, s[8:11], s28 offen lds
    s_add_u32 s28, s64, 995328
    s_add_u32 m0, s29, 100352
    s_nop 0
    buffer_load_dwordx4 v6, s[8:11], s28 offen lds
    s_add_u32 m0, s29, 101376
    s_nop 0
    buffer_load_dwordx4 v7, s[8:11], s28 offen lds
    s_waitcnt vmcnt(16)
    s_waitcnt lgkmcnt(0)
    s_barrier
    ds_read_b64_tr_b16 a[24:25], v10 offset:0
    ds_read_b64_tr_b16 a[26:27], v10 offset:2048
    ds_read_b64_tr_b16 a[104:105], v13 offset:0
    ds_read_b64_tr_b16 a[106:107], v13 offset:2048
    ds_read_b64_tr_b16 a[184:185], v16 offset:0
    ds_read_b64_tr_b16 a[186:187], v16 offset:2048
    ds_read_b64_tr_b16 v[200:201], v19 offset:0
    ds_read_b64_tr_b16 v[202:203], v19 offset:2048
    s_mul_i32 s29, s24, 4096
    s_add_u32 s28, s64, 1081344
    s_add_u32 m0, s29, 122880
    s_nop 0
    buffer_load_dwordx4 v6, s[8:11], s28 offen lds
    s_add_u32 m0, s29, 123904
    s_nop 0
    buffer_load_dwordx4 v7, s[8:11], s28 offen lds
    s_add_u32 s28, s64, 1093632
    s_add_u32 m0, s29, 124928
    s_nop 0
    buffer_load_dwordx4 v6, s[8:11], s28 offen lds
    s_add_u32 m0, s29, 125952
    s_nop 0
    buffer_load_dwordx4 v7, s[8:11], s28 offen lds
    s_waitcnt vmcnt(16)
    s_waitcnt lgkmcnt(0)
    s_barrier
    ds_read_b64_tr_b16 a[28:29], v10 offset:24576
    ds_read_b64_tr_b16 a[30:31], v10 offset:26624
    ds_read_b64_tr_b16 a[108:109], v13 offset:24576
    ds_read_b64_tr_b16 a[110:111], v13 offset:26624
    ds_read_b64_tr_b16 a[188:189], v16 offset:24576
    ds_read_b64_tr_b16 a[190:191], v16 offset:26624
    ds_read_b64_tr_b16 v[204:205], v19 offset:24576
    ds_read_b64_tr_b16 v[206:207], v19 offset:26624
    s_mul_i32 s29, s24, 4096
    s_add_u32 s28, s64, 1179648
    s_add_u32 m0, s29, 0
    s_nop 0
    buffer_load_dwordx4 v6, s[8:11], s28 offen lds
    s_add_u32 m0, s29, 1024
    s_nop 0
    buffer_load_dwordx4 v7, s[8:11], s28 offen lds
    s_add_u32 s28, s64, 1191936
    s_add_u32 m0, s29, 2048
    s_nop 0
    buffer_load_dwordx4 v6, s[8:11], s28 offen lds
    s_add_u32 m0, s29, 3072
    s_nop 0
    buffer_load_dwordx4 v7, s[8:11], s28 offen lds
    s_waitcnt vmcnt(16)
    s_waitcnt lgkmcnt(0)
    s_barrier
    ds_read_b64_tr_b16 a[32:33], v11 offset:0
    ds_read_b64_tr_b16 a[34:35], v11 offset:2048
    ds_read_b64_tr_b16 a[112:113], v14 offset:0
    ds_read_b64_tr_b16 a[114:115], v14 offset:2048
    ds_read_b64_tr_b16 a[192:193], v17 offset:0
    ds_read_b64_tr_b16 a[194:195], v17 offset:2048
    ds_read_b64_tr_b16 v[208:209], v20 offset:0
    ds_read_b64_tr_b16 v[210:211], v20 offset:2048
    s_mul_i32 s29, s24, 4096
    s_add_u32 s28, s64, 1277952
    s_add_u32 m0, s29, 24576
    s_nop 0
    buffer_load_dwordx4 v6, s[8:11], s28 offen lds
    s_add_u32 m0, s29, 25600
    s_nop 0
    buffer_load_dwordx4 v7, s[8:11], s28 offen lds
    s_add_u32 s28, s64, 1290240
    s_add_u32 m0, s29, 26624
    s_nop 0
    buffer_load_dwordx4 v6, s[8:11], s28 offen lds
    s_add_u32 m0, s29, 27648
    s_nop 0
    buffer_load_dwordx4 v7, s[8:11], s28 offen lds
    s_waitcnt vmcnt(16)
    s_waitcnt lgkmcnt(0)
    s_barrier
    ds_read_b64_tr_b16 a[36:37], v11 offset:24576
    ds_read_b64_tr_b16 a[38:39], v11 offset:26624
    ds_read_b64_tr_b16 a[116:117], v14 offset:24576
    ds_read_b64_tr_b16 a[118:119], v14 offset:26624
    ds_read_b64_tr_b16 a[196:197], v17 offset:24576
    ds_read_b64_tr_b16 a[198:199], v17 offset:26624
    ds_read_b64_tr_b16 v[212:213], v20 offset:24576
    ds_read_b64_tr_b16 v[214:215], v20 offset:26624
    s_mul_i32 s29, s24, 4096
    s_add_u32 s28, s64, 1376256
    s_add_u32 m0, s29, 49152
    s_nop 0
    buffer_load_dwordx4 v6, s[8:11], s28 offen lds
    s_add_u32 m0, s29, 50176
    s_nop 0
    buffer_load_dwordx4 v7, s[8:11], s28 offen lds
    s_add_u32 s28, s64, 1388544
    s_add_u32 m0, s29, 51200
    s_nop 0
    buffer_load_dwordx4 v6, s[8:11], s28 offen lds
    s_add_u32 m0, s29, 52224
    s_nop 0
    buffer_load_dwordx4 v7, s[8:11], s28 offen lds
    s_waitcnt vmcnt(16)
    s_waitcnt lgkmcnt(0)
    s_barrier
    ds_read_b64_tr_b16 a[40:41], v12 offset:0
    ds_read_b64_tr_b16 a[42:43], v12 offset:2048
    ds_read_b64_tr_b16 a[120:121], v15 offset:0
    ds_read_b64_tr_b16 a[122:123], v15 offset:2048
    ds_read_b64_tr_b16 a[200:201], v18 offset:0
    ds_read_b64_tr_b16 a[202:203], v18 offset:2048
    ds_read_b64_tr_b16 v[216:217], v21 offset:0
    ds_read_b64_tr_b16 v[218:219], v21 offset:2048
    s_mul_i32 s29, s24, 4096
    s_add_u32 s28, s64, 1474560
    s_add_u32 m0, s29, 73728
    s_nop 0
    buffer_load_dwordx4 v6, s[8:11], s28 offen lds
    s_add_u32 m0, s29, 74752
    s_nop 0
    buffer_load_dwordx4 v7, s[8:11], s28 offen lds
    s_add_u32 s28, s64, 1486848
    s_add_u32 m0, s29, 75776
    s_nop 0
    buffer_load_dwordx4 v6, s[8:11], s28 offen lds
    s_add_u32 m0, s29, 76800
    s_nop 0
    buffer_load_dwordx4 v7, s[8:11], s28 offen lds
    s_waitcnt vmcnt(16)
    s_waitcnt lgkmcnt(0)
    s_barrier
    ds_read_b64_tr_b16 a[44:45], v12 offset:24576
    ds_read_b64_tr_b16 a[46:47], v12 offset:26624
    ds_read_b64_tr_b16 a[124:125], v15 offset:24576
    ds_read_b64_tr_b16 a[126:127], v15 offset:26624
    ds_read_b64_tr_b16 a[204:205], v18 offset:24576
    ds_read_b64_tr_b16 a[206:207], v18 offset:26624
    ds_read_b64_tr_b16 v[220:221], v21 offset:24576
    ds_read_b64_tr_b16 v[222:223], v21 offset:26624
    s_mul_i32 s29, s24, 4096
    s_add_u32 s28, s64, 1572864
    s_add_u32 m0, s29, 98304
    s_nop 0
    buffer_load_dwordx4 v6, s[8:11], s28 offen lds
    s_add_u32 m0, s29, 99328
    s_nop 0
    buffer_load_dwordx4 v7, s[8:11], s28 offen lds
    s_add_u32 s28, s64, 1585152
    s_add_u32 m0, s29, 100352
    s_nop 0
    buffer_load_dwordx4 v6, s[8:11], s28 offen lds
    s_add_u32 m0, s29, 101376
    s_nop 0
    buffer_load_dwordx4 v7, s[8:11], s28 offen lds
    s_waitcnt vmcnt(16)
    s_waitcnt lgkmcnt(0)
    s_barrier
    ds_read_b64_tr_b16 a[48:49], v10 offset:0
    ds_read_b64_tr_b16 a[50:51], v10 offset:2048
    ds_read_b64_tr_b16 a[128:129], v13 offset:0
    ds_read_b64_tr_b16 a[130:131], v13 offset:2048
    ds_read_b64_tr_b16 a[208:209], v16 offset:0
    ds_read_b64_tr_b16 a[210:211], v16 offset:2048
    ds_read_b64_tr_b16 v[224:225], v19 offset:0
    ds_read_b64_tr_b16 v[226:227], v19 offset:2048
    s_mul_i32 s29, s24, 4096
    s_add_u32 s28, s64, 1671168
    s_add_u32 m0, s29, 122880
    s_nop 0
    buffer_load_dwordx4 v6, s[8:11], s28 offen lds
    s_add_u32 m0, s29, 123904
    s_nop 0
    buffer_load_dwordx4 v7, s[8:11], s28 offen lds
    s_add_u32 s28, s64, 1683456
    s_add_u32 m0, s29, 124928
    s_nop 0
    buffer_load_dwordx4 v6, s[8:11], s28 offen lds
    s_add_u32 m0, s29, 125952
    s_nop 0
    buffer_load_dwordx4 v7, s[8:11], s28 offen lds
    s_waitcnt vmcnt(16)
    s_waitcnt lgkmcnt(0)
    s_barrier
    ds_read_b64_tr_b16 a[52:53], v10 offset:24576
    ds_read_b64_tr_b16 a[54:55], v10 offset:26624
    ds_read_b64_tr_b16 a[132:133], v13 offset:24576
    ds_read_b64_tr_b16 a[134:135], v13 offset:26624
    ds_read_b64_tr_b16 a[212:213], v16 offset:24576
    ds_read_b64_tr_b16 a[214:215], v16 offset:26624
    ds_read_b64_tr_b16 v[228:229], v19 offset:24576
    ds_read_b64_tr_b16 v[230:231], v19 offset:26624
    s_mul_i32 s29, s24, 4096
    s_add_u32 s28, s64, 1769472
    s_add_u32 m0, s29, 0
    s_nop 0
    buffer_load_dwordx4 v6, s[8:11], s28 offen lds
    s_add_u32 m0, s29, 1024
    s_nop 0
    buffer_load_dwordx4 v7, s[8:11], s28 offen lds
    s_add_u32 s28, s64, 1781760
    s_add_u32 m0, s29, 2048
    s_nop 0
    buffer_load_dwordx4 v6, s[8:11], s28 offen lds
    s_add_u32 m0, s29, 3072
    s_nop 0
    buffer_load_dwordx4 v7, s[8:11], s28 offen lds
    s_waitcnt vmcnt(16)
    s_waitcnt lgkmcnt(0)
    s_barrier
    ds_read_b64_tr_b16 a[56:57], v11 offset:0
    ds_read_b64_tr_b16 a[58:59], v11 offset:2048
    ds_read_b64_tr_b16 a[136:137], v14 offset:0
    ds_read_b64_tr_b16 a[138:139], v14 offset:2048
    ds_read_b64_tr_b16 a[216:217], v17 offset:0
    ds_read_b64_tr_b16 a[218:219], v17 offset:2048
    ds_read_b64_tr_b16 v[232:233], v20 offset:0
    ds_read_b64_tr_b16 v[234:235], v20 offset:2048
    s_mul_i32 s29, s24, 4096
    s_add_u32 s28, s64, 1867776
    s_add_u32 m0, s29, 24576
    s_nop 0
    buffer_load_dwordx4 v6, s[8:11], s28 offen lds
    s_add_u32 m0, s29, 25600
    s_nop 0
    buffer_load_dwordx4 v7, s[8:11], s28 offen lds
    s_add_u32 s28, s64, 1880064
    s_add_u32 m0, s29, 26624
    s_nop 0
    buffer_load_dwordx4 v6, s[8:11], s28 offen lds
    s_add_u32 m0, s29, 27648
    s_nop 0
    buffer_load_dwordx4 v7, s[8:11], s28 offen lds
    s_waitcnt vmcnt(16)
    s_waitcnt lgkmcnt(0)
    s_barrier
    ds_read_b64_tr_b16 a[60:61], v11 offset:24576
    ds_read_b64_tr_b16 a[62:63], v11 offset:26624
    ds_read_b64_tr_b16 a[140:141], v14 offset:24576
    ds_read_b64_tr_b16 a[142:143], v14 offset:26624
    ds_read_b64_tr_b16 a[220:221], v17 offset:24576
    ds_read_b64_tr_b16 a[222:223], v17 offset:26624
    ds_read_b64_tr_b16 v[236:237], v20 offset:24576
    ds_read_b64_tr_b16 v[238:239], v20 offset:26624
    s_waitcnt vmcnt(12)
    s_waitcnt lgkmcnt(0)
    s_barrier
    ds_read_b64_tr_b16 a[64:65], v12 offset:0
    ds_read_b64_tr_b16 a[66:67], v12 offset:2048
    ds_read_b64_tr_b16 a[144:145], v15 offset:0
    ds_read_b64_tr_b16 a[146:147], v15 offset:2048
    ds_read_b64_tr_b16 a[224:225], v18 offset:0
    ds_read_b64_tr_b16 a[226:227], v18 offset:2048
    ds_read_b64_tr_b16 v[240:241], v21 offset:0
    ds_read_b64_tr_b16 v[242:243], v21 offset:2048
    s_waitcnt vmcnt(8)
    s_waitcnt lgkmcnt(0)
    s_barrier
    ds_read_b64_tr_b16 a[68:69], v12 offset:24576
    ds_read_b64_tr_b16 a[70:71], v12 offset:26624
    ds_read_b64_tr_b16 a[148:149], v15 offset:24576
    ds_read_b64_tr_b16 a[150:151], v15 offset:26624
    ds_read_b64_tr_b16 a[228:229], v18 offset:24576
    ds_read_b64_tr_b16 a[230:231], v18 offset:26624
    ds_read_b64_tr_b16 v[244:245], v21 offset:24576
    ds_read_b64_tr_b16 v[246:247], v21 offset:26624
    s_waitcnt vmcnt(4)
    s_waitcnt lgkmcnt(0)
    s_barrier
    ds_read_b64_tr_b16 a[72:73], v10 offset:0
    ds_read_b64_tr_b16 a[74:75], v10 offset:2048
    ds_read_b64_tr_b16 a[152:153], v13 offset:0
    ds_read_b64_tr_b16 a[154:155], v13 offset:2048
    ds_read_b64_tr_b16 a[232:233], v16 offset:0
    ds_read_b64_tr_b16 a[234:235], v16 offset:2048
    ds_read_b64_tr_b16 v[248:249], v19 offset:0
    ds_read_b64_tr_b16 v[250:251], v19 offset:2048
    s_waitcnt vmcnt(0)
    s_waitcnt lgkmcnt(0)
    s_barrier
    ds_read_b64_tr_b16 a[76:77], v10 offset:24576
    ds_read_b64_tr_b16 a[78:79], v10 offset:26624
    ds_read_b64_tr_b16 a[156:157], v13 offset:24576
    ds_read_b64_tr_b16 a[158:159], v13 offset:26624
    ds_read_b64_tr_b16 a[236:237], v16 offset:24576
    ds_read_b64_tr_b16 a[238:239], v16 offset:26624
    ds_read_b64_tr_b16 v[252:253], v19 offset:24576
    ds_read_b64_tr_b16 v[254:255], v19 offset:26624
    s_waitcnt vmcnt(0) lgkmcnt(0)
    s_barrier
    v_lshlrev_b32 v22, 4, v1
    v_mov_b32 v23, v22
    s_mul_i32 s65, s25, 16384
    s_mul_i32 s28, s24, 4096
    s_add_u32 s65, s65, s28
    s_add_u32 s65, s65, 54525952
    s_mov_b32 s67, 536870912
    s_mov_b32 s26, 0
    s_mov_b32 s27, 0
    s_mul_i32 s30, s26, 40960
    s_mul_i32 s31, s24, 10240
    s_add_u32 s30, s30, s31
    s_add_u32 s31, s31, s27
    s_add_u32 m0, s31, 0
    s_nop 0
    buffer_load_dwordx4 v22, s[4:7], s30 offen offset:0 sc1 lds
    buffer_load_dwordx4 v22, s[4:7], s30 offen offset:1024 sc1 lds
    buffer_load_dwordx4 v22, s[4:7], s30 offen offset:2048 sc1 lds
    buffer_load_dwordx4 v22, s[4:7], s30 offen offset:3072 sc1 lds
    s_add_u32 m0, s31, 4096
    s_add_u32 s30, s30, 4096
    buffer_load_dwordx4 v22, s[4:7], s30 offen offset:0 sc1 lds
    buffer_load_dwordx4 v22, s[4:7], s30 offen offset:1024 sc1 lds
    buffer_load_dwordx4 v22, s[4:7], s30 offen offset:2048 sc1 lds
    buffer_load_dwordx4 v22, s[4:7], s30 offen offset:3072 sc1 lds
    s_add_u32 m0, s31, 8192
    s_add_u32 s30, s30, 4096
    buffer_load_dwordx4 v22, s[4:7], s30 offen offset:0 sc1 lds
    buffer_load_dwordx4 v22, s[4:7], s30 offen offset:1024 sc1 lds
    s_waitcnt vmcnt(0)
    s_barrier
    ds_read_b128 v[24:27], v23 offset:0
    ds_read_b128 v[28:31], v23 offset:20480
    ds_read_b128 v[32:35], v23 offset:1024
    ds_read_b128 v[36:39], v23 offset:21504
    ds_read_b128 v[40:43], v23 offset:2048
    ds_read_b128 v[44:47], v23 offset:22528
.p2align 6
LH_top:
    s_add_u32 s66, s26, 1
    s_min_u32 s66, s66, 63
    s_add_u32 s27, s27, 40960
    s_cmp_ge_u32 s27, 122880
    s_cselect_b32 s27, 0, s27
    s_mul_i32 s30, s66, 40960
    s_mul_i32 s31, s24, 10240
    s_add_u32 s30, s30, s31
    s_add_u32 s31, s31, s27
    s_waitcnt lgkmcnt(4)
    v_mfma_f32_16x16x32_bf16 v[56:59], a[0:3], v[24:27], 0
    v_mfma_f32_16x16x32_bf16 v[64:67], a[80:83], v[24:27], 0
    buffer_store_dwordx4 v[88:91], v22, s[4:7], s67 offen offset:0 sc1
    v_mfma_f32_16x16x32_bf16 v[72:75], a[160:163], v[24:27], 0
    v_mfma_f32_16x16x32_bf16 v[80:83], a[240:243], v[24:27], 0
    ds_read_b128 v[48:51], v23 offset:3072
    ds_read_b128 v[52:55], v23 offset:23552
    v_mfma_f32_16x16x32_bf16 v[60:63], a[0:3], v[28:31], 0
    s_add_u32 m0, s31, 0
    s_nop 0
    buffer_load_dwordx4 v22, s[4:7], s30 offen offset:0 sc1 lds
    v_mfma_f32_16x16x32_bf16 v[68:71], a[80:83], v[28:31], 0
    v_mfma_f32_16x16x32_bf16 v[76:79], a[160:163], v[28:31], 0
    v_mfma_f32_16x16x32_bf16 v[84:87], a[240:243], v[28:31], 0
    s_waitcnt lgkmcnt(4)
    v_mfma_f32_16x16x32_bf16 v[56:59], a[4:7], v[32:35], v[56:59]
    v_mfma_f32_16x16x32_bf16 v[64:67], a[84:87], v[32:35], v[64:67]
    buffer_store_dwordx4 v[92:95], v22, s[4:7], s67 offen offset:1024 sc1
    v_mfma_f32_16x16x32_bf16 v[72:75], a[164:167], v[32:35], v[72:75]
    v_mfma_f32_16x16x32_bf16 v[80:83], a[244:247], v[32:35], v[80:83]
    ds_read_b128 v[24:27], v23 offset:4096
    ds_read_b128 v[28:31], v23 offset:24576
    v_mfma_f32_16x16x32_bf16 v[60:63], a[4:7], v[36:39], v[60:63]
    buffer_load_dwordx4 v22, s[4:7], s30 offen offset:1024 sc1 lds
    v_mfma_f32_16x16x32_bf16 v[68:71], a[84:87], v[36:39], v[68:71]
    v_mfma_f32_16x16x32_bf16 v[76:79], a[164:167], v[36:39], v[76:79]
    v_mfma_f32_16x16x32_bf16 v[84:87], a[244:247], v[36:39], v[84:87]
    s_waitcnt lgkmcnt(4)
    v_mfma_f32_16x16x32_bf16 v[56:59], a[8:11], v[40:43], v[56:59]
    v_mfma_f32_16x16x32_bf16 v[64:67], a[88:91], v[40:43], v[64:67]
    buffer_store_dwordx4 v[96:99], v22, s[4:7], s67 offen offset:2048 sc1
    v_mfma_f32_16x16x32_bf16 v[72:75], a[168:171], v[40:43], v[72:75]
    v_mfma_f32_16x16x32_bf16 v[80:83], a[248:251], v[40:43], v[80:83]
    ds_read_b128 v[32:35], v23 offset:5120
    ds_read_b128 v[36:39], v23 offset:25600
    v_mfma_f32_16x16x32_bf16 v[60:63], a[8:11], v[44:47], v[60:63]
    buffer_load_dwordx4 v22, s[4:7], s30 offen offset:2048 sc1 lds
    v_mfma_f32_16x16x32_bf16 v[68:71], a[88:91], v[44:47], v[68:71]
    v_mfma_f32_16x16x32_bf16 v[76:79], a[168:171], v[44:47], v[76:79]
    v_mfma_f32_16x16x32_bf16 v[84:87], a[248:251], v[44:47], v[84:87]
    s_waitcnt lgkmcnt(4)
    v_mfma_f32_16x16x32_bf16 v[56:59], a[12:15], v[48:51], v[56:59]
    v_mfma_f32_16x16x32_bf16 v[64:67], a[92:95], v[48:51], v[64:67]
    buffer_store_dwordx4 v[100:103], v22, s[4:7], s67 offen offset:3072 sc1
    v_mfma_f32_16x16x32_bf16 v[72:75], a[172:175], v[48:51], v[72:75]
    v_mfma_f32_16x16x32_bf16 v[80:83], a[252:255], v[48:51], v[80:83]
    ds_read_b128 v[40:43], v23 offset:6144
    ds_read_b128 v[44:47], v23 offset:26624
    v_mfma_f32_16x16x32_bf16 v[60:63], a[12:15], v[52:55], v[60:63]
    buffer_load_dwordx4 v22, s[4:7], s30 offen offset:3072 sc1 lds
    v_mfma_f32_16x16x32_bf16 v[68:71], a[92:95], v[52:55], v[68:71]
    v_mfma_f32_16x16x32_bf16 v[76:79], a[172:175], v[52:55], v[76:79]
    v_mfma_f32_16x16x32_bf16 v[84:87], a[252:255], v[52:55], v[84:87]
    s_waitcnt lgkmcnt(4)
    v_mfma_f32_16x16x32_bf16 v[56:59], a[16:19], v[24:27], v[56:59]
    v_mfma_f32_16x16x32_bf16 v[64:67], a[96:99], v[24:27], v[64:67]
    v_mfma_f32_16x16x32_bf16 v[72:75], a[176:179], v[24:27], v[72:75]
    v_mfma_f32_16x16x32_bf16 v[80:83], v[192:195], v[24:27], v[80:83]
    ds_read_b128 v[48:51], v23 offset:7168
    ds_read_b128 v[52:55], v23 offset:27648
    v_mfma_f32_16x16x32_bf16 v[60:63], a[16:19], v[28:31], v[60:63]
    s_add_u32 m0, s31, 4096
    s_add_u32 s30, s30, 4096
    buffer_load_dwordx4 v22, s[4:7], s30 offen offset:0 sc1 lds
    v_mfma_f32_16x16x32_bf16 v[68:71], a[96:99], v[28:31], v[68:71]
    v_mfma_f32_16x16x32_bf16 v[76:79], a[176:179], v[28:31], v[76:79]
    v_mfma_f32_16x16x32_bf16 v[84:87], v[192:195], v[28:31], v[84:87]
    s_waitcnt lgkmcnt(4)
    v_mfma_f32_16x16x32_bf16 v[56:59], a[20:23], v[32:35], v[56:59]
    v_mfma_f32_16x16x32_bf16 v[64:67], a[100:103], v[32:35], v[64:67]
    v_mfma_f32_16x16x32_bf16 v[72:75], a[180:183], v[32:35], v[72:75]
    v_mfma_f32_16x16x32_bf16 v[80:83], v[196:199], v[32:35], v[80:83]
    ds_read_b128 v[24:27], v23 offset:8192
    ds_read_b128 v[28:31], v23 offset:28672
    v_mfma_f32_16x16x32_bf16 v[60:63], a[20:23], v[36:39], v[60:63]
    buffer_load_dwordx4 v22, s[4:7], s30 offen offset:1024 sc1 lds
    v_mfma_f32_16x16x32_bf16 v[68:71], a[100:103], v[36:39], v[68:71]
    v_mfma_f32_16x16x32_bf16 v[76:79], a[180:183], v[36:39], v[76:79]
    v_mfma_f32_16x16x32_bf16 v[84:87], v[196:199], v[36:39], v[84:87]
    s_waitcnt lgkmcnt(4)
    v_mfma_f32_16x16x32_bf16 v[56:59], a[24:27], v[40:43], v[56:59]
    v_mfma_f32_16x16x32_bf16 v[64:67], a[104:107], v[40:43], v[64:67]
    v_mfma_f32_16x16x32_bf16 v[72:75], a[184:187], v[40:43], v[72:75]
    v_mfma_f32_16x16x32_bf16 v[80:83], v[200:203], v[40:43], v[80:83]
    ds_read_b128 v[32:35], v23 offset:9216
    ds_read_b128 v[36:39], v23 offset:29696
    v_mfma_f32_16x16x32_bf16 v[60:63], a[24:27], v[44:47], v[60:63]
    buffer_load_dwordx4 v22, s[4:7], s30 offen offset:2048 sc1 lds
    v_mfma_f32_16x16x32_bf16 v[68:71], a[104:107], v[44:47], v[68:71]
    v_mfma_f32_16x16x32_bf16 v[76:79], a[184:187], v[44:47], v[76:79]
    v_mfma_f32_16x16x32_bf16 v[84:87], v[200:203], v[44:47], v[84:87]
    s_waitcnt lgkmcnt(4)
    v_mfma_f32_16x16x32_bf16 v[56:59], a[28:31], v[48:51], v[56:59]
    v_mfma_f32_16x16x32_bf16 v[64:67], a[108:111], v[48:51], v[64:67]
    v_mfma_f32_16x16x32_bf16 v[72:75], a[188:191], v[48:51], v[72:75]
    v_mfma_f32_16x16x32_bf16 v[80:83], v[204:207], v[48:51], v[80:83]
    ds_read_b128 v[40:43], v23 offset:10240
    ds_read_b128 v[44:47], v23 offset:30720
    v_mfma_f32_16x16x32_bf16 v[60:63], a[28:31], v[52:55], v[60:63]
    buffer_load_dwordx4 v22, s[4:7], s30 offen offset:3072 sc1 lds
    v_mfma_f32_16x16x32_bf16 v[68:71], a[108:111], v[52:55], v[68:71]
    v_mfma_f32_16x16x32_bf16 v[76:79], a[188:191], v[52:55], v[76:79]
    v_mfma_f32_16x16x32_bf16 v[84:87], v[204:207], v[52:55], v[84:87]
    s_waitcnt lgkmcnt(4)
    v_mfma_f32_16x16x32_bf16 v[56:59], a[32:35], v[24:27], v[56:59]
    v_mfma_f32_16x16x32_bf16 v[64:67], a[112:115], v[24:27], v[64:67]
    v_mfma_f32_16x16x32_bf16 v[72:75], a[192:195], v[24:27], v[72:75]
    v_mfma_f32_16x16x32_bf16 v[80:83], v[208:211], v[24:27], v[80:83]
    ds_read_b128 v[48:51], v23 offset:11264
    ds_read_b128 v[52:55], v23 offset:31744
    v_mfma_f32_16x16x32_bf16 v[60:63], a[32:35], v[28:31], v[60:63]
    s_add_u32 m0, s31, 8192
    s_add_u32 s30, s30, 4096
    buffer_load_dwordx4 v22, s[4:7], s30 offen offset:0 sc1 lds
    v_mfma_f32_16x16x32_bf16 v[68:71], a[112:115], v[28:31], v[68:71]
    v_mfma_f32_16x16x32_bf16 v[76:79], a[192:195], v[28:31], v[76:79]
    v_mfma_f32_16x16x32_bf16 v[84:87], v[208:211], v[28:31], v[84:87]
    s_waitcnt lgkmcnt(4)
    v_mfma_f32_16x16x32_bf16 v[56:59], a[36:39], v[32:35], v[56:59]
    v_mfma_f32_16x16x32_bf16 v[64:67], a[116:119], v[32:35], v[64:67]
    v_mfma_f32_16x16x32_bf16 v[72:75], a[196:199], v[32:35], v[72:75]
    v_mfma_f32_16x16x32_bf16 v[80:83], v[212:215], v[32:35], v[80:83]
    ds_read_b128 v[24:27], v23 offset:12288
    ds_read_b128 v[28:31], v23 offset:32768
    v_mfma_f32_16x16x32_bf16 v[60:63], a[36:39], v[36:39], v[60:63]
    buffer_load_dwordx4 v22, s[4:7], s30 offen offset:1024 sc1 lds
    v_mfma_f32_16x16x32_bf16 v[68:71], a[116:119], v[36:39], v[68:71]
    v_mfma_f32_16x16x32_bf16 v[76:79], a[196:199], v[36:39], v[76:79]
    v_mfma_f32_16x16x32_bf16 v[84:87], v[212:215], v[36:39], v[84:87]
    s_waitcnt lgkmcnt(4)
    v_mfma_f32_16x16x32_bf16 v[56:59], a[40:43], v[40:43], v[56:59]
    v_mfma_f32_16x16x32_bf16 v[64:67], a[120:123], v[40:43], v[64:67]
    v_mfma_f32_16x16x32_bf16 v[72:75], a[200:203], v[40:43], v[72:75]
    v_mfma_f32_16x16x32_bf16 v[80:83], v[216:219], v[40:43], v[80:83]
    ds_read_b128 v[32:35], v23 offset:13312
    ds_read_b128 v[36:39], v23 offset:33792
    v_mfma_f32_16x16x32_bf16 v[60:63], a[40:43], v[44:47], v[60:63]
    v_mfma_f32_16x16x32_bf16 v[68:71], a[120:123], v[44:47], v[68:71]
    v_mfma_f32_16x16x32_bf16 v[76:79], a[200:203], v[44:47], v[76:79]
    v_mfma_f32_16x16x32_bf16 v[84:87], v[216:219], v[44:47], v[84:87]
    s_waitcnt lgkmcnt(4)
    v_mfma_f32_16x16x32_bf16 v[56:59], a[44:47], v[48:51], v[56:59]
    v_mfma_f32_16x16x32_bf16 v[64:67], a[124:127], v[48:51], v[64:67]
    v_mfma_f32_16x16x32_bf16 v[72:75], a[204:207], v[48:51], v[72:75]
    v_mfma_f32_16x16x32_bf16 v[80:83], v[220:223], v[48:51], v[80:83]
    ds_read_b128 v[40:43], v23 offset:14336
    ds_read_b128 v[44:47], v23 offset:34816
    v_mfma_f32_16x16x32_bf16 v[60:63], a[44:47], v[52:55], v[60:63]
    v_mfma_f32_16x16x32_bf16 v[68:71], a[124:127], v[52:55], v[68:71]
    v_mfma_f32_16x16x32_bf16 v[76:79], a[204:207], v[52:55], v[76:79]
    v_mfma_f32_16x16x32_bf16 v[84:87], v[220:223], v[52:55], v[84:87]
    s_waitcnt lgkmcnt(4)
    v_mfma_f32_16x16x32_bf16 v[56:59], a[48:51], v[24:27], v[56:59]
    v_mfma_f32_16x16x32_bf16 v[64:67], a[128:131], v[24:27], v[64:67]
    v_mfma_f32_16x16x32_bf16 v[72:75], a[208:211], v[24:27], v[72:75]
    v_mfma_f32_16x16x32_bf16 v[80:83], v[224:227], v[24:27], v[80:83]
    ds_read_b128 v[48:51], v23 offset:15360
    ds_read_b128 v[52:55], v23 offset:35840
    v_mfma_f32_16x16x32_bf16 v[60:63], a[48:51], v[28:31], v[60:63]
    v_mfma_f32_16x16x32_bf16 v[68:71], a[128:131], v[28:31], v[68:71]
    v_mfma_f32_16x16x32_bf16 v[76:79], a[208:211], v[28:31], v[76:79]
    v_mfma_f32_16x16x32_bf16 v[84:87], v[224:227], v[28:31], v[84:87]
    s_waitcnt lgkmcnt(4)
    v_mfma_f32_16x16x32_bf16 v[56:59], a[52:55], v[32:35], v[56:59]
    v_mfma_f32_16x16x32_bf16 v[64:67], a[132:135], v[32:35], v[64:67]
    v_mfma_f32_16x16x32_bf16 v[72:75], a[212:215], v[32:35], v[72:75]
    v_mfma_f32_16x16x32_bf16 v[80:83], v[228:231], v[32:35], v[80:83]
    ds_read_b128 v[24:27], v23 offset:16384
    ds_read_b128 v[28:31], v23 offset:36864
    v_mfma_f32_16x16x32_bf16 v[60:63], a[52:55], v[36:39], v[60:63]
    v_mfma_f32_16x16x32_bf16 v[68:71], a[132:135], v[36:39], v[68:71]
    v_mfma_f32_16x16x32_bf16 v[76:79], a[212:215], v[36:39], v[76:79]
    v_mfma_f32_16x16x32_bf16 v[84:87], v[228:231], v[36:39], v[84:87]
    s_waitcnt lgkmcnt(4)
    v_mfma_f32_16x16x32_bf16 v[56:59], a[56:59], v[40:43], v[56:59]
    v_mfma_f32_16x16x32_bf16 v[64:67], a[136:139], v[40:43], v[64:67]
    v_mfma_f32_16x16x32_bf16 v[72:75], a[216:219], v[40:43], v[72:75]
    v_mfma_f32_16x16x32_bf16 v[80:83], v[232:235], v[40:43], v[80:83]
    ds_read_b128 v[32:35], v23 offset:17408
    ds_read_b128 v[36:39], v23 offset:37888
    v_mfma_f32_16x16x32_bf16 v[60:63], a[56:59], v[44:47], v[60:63]
    v_mfma_f32_16x16x32_bf16 v[68:71], a[136:139], v[44:47], v[68:71]
    v_mfma_f32_16x16x32_bf16 v[76:79], a[216:219], v[44:47], v[76:79]
    v_mfma_f32_16x16x32_bf16 v[84:87], v[232:235], v[44:47], v[84:87]
    s_waitcnt lgkmcnt(4)
    v_mfma_f32_16x16x32_bf16 v[56:59], a[60:63], v[48:51], v[56:59]
    v_mfma_f32_16x16x32_bf16 v[64:67], a[140:143], v[48:51], v[64:67]
    v_mfma_f32_16x16x32_bf16 v[72:75], a[220:223], v[48:51], v[72:75]
    v_mfma_f32_16x16x32_bf16 v[80:83], v[236:239], v[48:51], v[80:83]
    ds_read_b128 v[40:43], v23 offset:18432
    ds_read_b128 v[44:47], v23 offset:38912
    v_mfma_f32_16x16x32_bf16 v[60:63], a[60:63], v[52:55], v[60:63]
    v_mfma_f32_16x16x32_bf16 v[68:71], a[140:143], v[52:55], v[68:71]
    v_mfma_f32_16x16x32_bf16 v[76:79], a[220:223], v[52:55], v[76:79]
    v_mfma_f32_16x16x32_bf16 v[84:87], v[236:239], v[52:55], v[84:87]
    s_waitcnt vmcnt(7)
    v_mov_b32 v2, s26
    s_mov_b64 exec, 1
    buffer_store_dword v2, off, s[4:7], s35 sc1
    s_mov_b64 exec, -1
    s_waitcnt lgkmcnt(4)
    v_mfma_f32_16x16x32_bf16 v[56:59], a[64:67], v[24:27], v[56:59]
    v_mfma_f32_16x16x32_bf16 v[64:67], a[144:147], v[24:27], v[64:67]
    v_mfma_f32_16x16x32_bf16 v[72:75], a[224:227], v[24:27], v[72:75]
    v_mfma_f32_16x16x32_bf16 v[80:83], v[240:243], v[24:27], v[80:83]
    ds_read_b128 v[48:51], v23 offset:19456
    ds_read_b128 v[52:55], v23 offset:39936
    v_mfma_f32_16x16x32_bf16 v[60:63], a[64:67], v[28:31], v[60:63]
    v_mfma_f32_16x16x32_bf16 v[68:71], a[144:147], v[28:31], v[68:71]
    v_mfma_f32_16x16x32_bf16 v[76:79], a[224:227], v[28:31], v[76:79]
    v_mfma_f32_16x16x32_bf16 v[84:87], v[240:243], v[28:31], v[84:87]
    s_waitcnt lgkmcnt(4)
    v_mfma_f32_16x16x32_bf16 v[56:59], a[68:71], v[32:35], v[56:59]
    v_mfma_f32_16x16x32_bf16 v[64:67], a[148:151], v[32:35], v[64:67]
    v_mfma_f32_16x16x32_bf16 v[72:75], a[228:231], v[32:35], v[72:75]
    v_mfma_f32_16x16x32_bf16 v[80:83], v[244:247], v[32:35], v[80:83]
    s_waitcnt vmcnt(1)
    s_barrier
    v_add_u32 v23, s27, v22
    ds_read_b128 v[24:27], v23 offset:0
    ds_read_b128 v[28:31], v23 offset:20480
    v_mfma_f32_16x16x32_bf16 v[60:63], a[68:71], v[36:39], v[60:63]
    v_mfma_f32_16x16x32_bf16 v[68:71], a[148:151], v[36:39], v[68:71]
    v_mfma_f32_16x16x32_bf16 v[76:79], a[228:231], v[36:39], v[76:79]
    v_mfma_f32_16x16x32_bf16 v[84:87], v[244:247], v[36:39], v[84:87]
    s_waitcnt lgkmcnt(4)
    v_mfma_f32_16x16x32_bf16 v[56:59], a[72:75], v[40:43], v[56:59]
    v_mfma_f32_16x16x32_bf16 v[64:67], a[152:155], v[40:43], v[64:67]
    v_mfma_f32_16x16x32_bf16 v[72:75], a[232:235], v[40:43], v[72:75]
    v_mfma_f32_16x16x32_bf16 v[80:83], v[248:251], v[40:43], v[80:83]
    ds_read_b128 v[32:35], v23 offset:1024
    ds_read_b128 v[36:39], v23 offset:21504
    v_mfma_f32_16x16x32_bf16 v[60:63], a[72:75], v[44:47], v[60:63]
    v_mfma_f32_16x16x32_bf16 v[68:71], a[152:155], v[44:47], v[68:71]
    v_mfma_f32_16x16x32_bf16 v[76:79], a[232:235], v[44:47], v[76:79]
    v_mfma_f32_16x16x32_bf16 v[84:87], v[248:251], v[44:47], v[84:87]
    s_waitcnt lgkmcnt(4)
    v_mfma_f32_16x16x32_bf16 v[56:59], a[76:79], v[48:51], v[56:59]
    v_mfma_f32_16x16x32_bf16 v[64:67], a[156:159], v[48:51], v[64:67]
    v_mfma_f32_16x16x32_bf16 v[72:75], a[236:239], v[48:51], v[72:75]
    v_mfma_f32_16x16x32_bf16 v[80:83], v[252:255], v[48:51], v[80:83]
    ds_read_b128 v[40:43], v23 offset:2048
    ds_read_b128 v[44:47], v23 offset:22528
    v_mfma_f32_16x16x32_bf16 v[60:63], a[76:79], v[52:55], v[60:63]
    v_mfma_f32_16x16x32_bf16 v[68:71], a[156:159], v[52:55], v[68:71]
    v_mfma_f32_16x16x32_bf16 v[76:79], a[236:239], v[52:55], v[76:79]
    v_mfma_f32_16x16x32_bf16 v[84:87], v[252:255], v[52:55], v[84:87]
    v_cvt_pk_bf16_f32 v88, v56, v57
    v_pk_max_i16 v88, v88, 0
    v_cvt_pk_bf16_f32 v89, v58, v59
    v_pk_max_i16 v89, v89, 0
    v_cvt_pk_bf16_f32 v90, v60, v61
    v_pk_max_i16 v90, v90, 0
    v_cvt_pk_bf16_f32 v91, v62, v63
    v_pk_max_i16 v91, v91, 0
    v_cvt_pk_bf16_f32 v92, v64, v65
    v_pk_max_i16 v92, v92, 0
    v_cvt_pk_bf16_f32 v93, v66, v67
    v_pk_max_i16 v93, v93, 0
    v_cvt_pk_bf16_f32 v94, v68, v69
    v_pk_max_i16 v94, v94, 0
    v_cvt_pk_bf16_f32 v95, v70, v71
    v_pk_max_i16 v95, v95, 0
    v_cvt_pk_bf16_f32 v96, v72, v73
    v_pk_max_i16 v96, v96, 0
    v_cvt_pk_bf16_f32 v97, v74, v75
    v_pk_max_i16 v97, v97, 0
    v_cvt_pk_bf16_f32 v98, v76, v77
    v_pk_max_i16 v98, v98, 0
    v_cvt_pk_bf16_f32 v99, v78, v79
    v_pk_max_i16 v99, v99, 0
    v_cvt_pk_bf16_f32 v100, v80, v81
    v_pk_max_i16 v100, v100, 0
    v_cvt_pk_bf16_f32 v101, v82, v83
    v_pk_max_i16 v101, v101, 0
    v_cvt_pk_bf16_f32 v102, v84, v85
    v_pk_max_i16 v102, v102, 0
    v_cvt_pk_bf16_f32 v103, v86, v87
    v_pk_max_i16 v103, v103, 0
    s_mov_b32 s67, s65
    s_add_u32 s65, s65, 98304
    s_sub_u32 s28, s26, 1
    s_add_u32 s26, s26, 1
    s_cmp_lt_u32 s28, 62
    s_cbranch_scc1 LH_top
    buffer_store_dwordx4 v[88:91], v22, s[4:7], s67 offen offset:0 sc1
    buffer_store_dwordx4 v[92:95], v22, s[4:7], s67 offen offset:1024 sc1
    buffer_store_dwordx4 v[96:99], v22, s[4:7], s67 offen offset:2048 sc1
    buffer_store_dwordx4 v[100:103], v22, s[4:7], s67 offen offset:3072 sc1
    s_mov_b32 s67, 536870912
    s_waitcnt vmcnt(0)
    v_mov_b32 v2, s26
    s_mov_b64 exec, 1
    buffer_store_dword v2, off, s[4:7], s35 sc1
    s_mov_b64 exec, -1
    s_cmp_lt_u32 s26, 64
    s_cbranch_scc1 LH_top
    s_endpgm
Lretry_53:
    s_sleep 6
    buffer_load_dwordx2 v[2:3], off, s[16:19], 0 offset:128 sc1
    s_waitcnt vmcnt(0)
    s_add_u32 s32, s32, 1
    s_cmp_lt_u32 s32, 200000
    s_cbranch_scc1 Lws_52
    v_mov_b32 v2, 1
    v_mov_b32 v3, 4
    buffer_store_dword v2, v3, s[16:19], 0 offen sc1
    s_endpgm
Lretry_56:
    s_sleep 24
    buffer_load_dword v2, v3, s[4:7], 0 offen sc1
    s_waitcnt vmcnt(0)
    s_add_u32 s32, s32, 1
    s_cmp_lt_u32 s32, 200000
    s_cbranch_scc1 Lwf_54
    v_mov_b32 v2, 3
    v_mov_b32 v3, 4
    buffer_store_dword v2, v3, s[16:19], 0 offen sc1
    s_endpgm
E_H:
.p2align 6
W_O:
R_O:
    s_cmp_ge_u32 s25, 24
    s_cbranch_scc1 LO_noln
    s_mov_b32 s12, s36
    s_mov_b32 s13, s37
    s_mov_b32 s14, 2621440
    s_mov_b32 s15, 0x20000
    s_add_u32 s28, s25, 40
    s_mul_i32 s28, s28, 40960
    s_mul_i32 s29, s24, 10240
    s_add_u32 s29, s29, s28
    v_and_b32 v2, 7, v1
    v_mul_u32_u24 v2, 1280, v2
    v_lshrrev_b32 v3, 3, v1
    v_lshl_add_u32 v2, v3, 4, v2
    buffer_load_dwordx4 v[8:11], v2, s[12:15], s29 offen offset:0
    buffer_load_dwordx4 v[12:15], v2, s[12:15], s29 offen offset:128
    buffer_load_dwordx4 v[16:19], v2, s[12:15], s29 offen offset:256
    buffer_load_dwordx4 v[20:23], v2, s[12:15], s29 offen offset:384
    buffer_load_dwordx4 v[24:27], v2, s[12:15], s29 offen offset:512
    buffer_load_dwordx4 v[28:31], v2, s[12:15], s29 offen offset:640
    buffer_load_dwordx4 v[32:35], v2, s[12:15], s29 offen offset:768
    buffer_load_dwordx4 v[36:39], v2, s[12:15], s29 offen offset:896
    buffer_load_dwordx4 v[40:43], v2, s[12:15], s29 offen offset:1024
    buffer_load_dwordx4 v[44:47], v2, s[12:15], s29 offen offset:1152
    v_and_b32 v2, 7, v1
    v_lshlrev_b32 v2, 4, v2
    v_bfe_u32 v3, v1, 3, 2
    v_lshl_add_u32 v2, v3, 8, v2
    v_lshrrev_b32 v3, 5, v1
    v_lshl_add_u32 v2, v3, 10, v2
    s_lshr_b32 s29, s24, 1
    s_mul_i32 s29, s29, 20480
    s_add_u32 s28, s28, s29
    s_and_b32 s29, s24, 1
    s_lshl_b32 s29, s29, 7
    s_add_u32 s29, s29, s28
    v_mov_b32 v4, 0
    v_mov_b32 v5, 0
    s_waitcnt vmcnt(9)
    v_lshlrev_b32 v56, 16, v8
    v_and_b32 v57, 0xffff0000, v8
    v_pk_add_f32 v[4:5], v[4:5], v[56:57]
    v_lshlrev_b32 v58, 16, v9
    v_and_b32 v59, 0xffff0000, v9
    v_pk_add_f32 v[4:5], v[4:5], v[58:59]
    v_lshlrev_b32 v60, 16, v10
    v_and_b32 v61, 0xffff0000, v10
    v_pk_add_f32 v[4:5], v[4:5], v[60:61]
    v_lshlrev_b32 v62, 16, v11
    v_and_b32 v63, 0xffff0000, v11
    v_pk_add_f32 v[4:5], v[4:5], v[62:63]
    s_waitcnt vmcnt(8)
    v_lshlrev_b32 v64, 16, v12
    v_and_b32 v65, 0xffff0000, v12
    v_pk_add_f32 v[4:5], v[4:5], v[64:65]
    v_lshlrev_b32 v66, 16, v13
    v_and_b32 v67, 0xffff0000, v13
    v_pk_add_f32 v[4:5], v[4:5], v[66:67]
    v_lshlrev_b32 v68, 16, v14
    v_and_b32 v69, 0xffff0000, v14
    v_pk_add_f32 v[4:5], v[4:5], v[68:69]
    v_lshlrev_b32 v70, 16, v15
    v_and_b32 v71, 0xffff0000, v15
    v_pk_add_f32 v[4:5], v[4:5], v[70:71]
    s_waitcnt vmcnt(7)
    v_lshlrev_b32 v72, 16, v16
    v_and_b32 v73, 0xffff0000, v16
    v_pk_add_f32 v[4:5], v[4:5], v[72:73]
    v_lshlrev_b32 v74, 16, v17
    v_and_b32 v75, 0xffff0000, v17
    v_pk_add_f32 v[4:5], v[4:5], v[74:75]
    v_lshlrev_b32 v76, 16, v18
    v_and_b32 v77, 0xffff0000, v18
    v_pk_add_f32 v[4:5], v[4:5], v[76:77]
    v_lshlrev_b32 v78, 16, v19
    v_and_b32 v79, 0xffff0000, v19
    v_pk_add_f32 v[4:5], v[4:5], v[78:79]
    s_waitcnt vmcnt(6)
    v_lshlrev_b32 v80, 16, v20
    v_and_b32 v81, 0xffff0000, v20
    v_pk_add_f32 v[4:5], v[4:5], v[80:81]
    v_lshlrev_b32 v82, 16, v21
    v_and_b32 v83, 0xffff0000, v21
    v_pk_add_f32 v[4:5], v[4:5], v[82:83]
    v_lshlrev_b32 v84, 16, v22
    v_and_b32 v85, 0xffff0000, v22
    v_pk_add_f32 v[4:5], v[4:5], v[84:85]
    v_lshlrev_b32 v86, 16, v23
    v_and_b32 v87, 0xffff0000, v23
    v_pk_add_f32 v[4:5], v[4:5], v[86:87]
    s_waitcnt vmcnt(5)
    v_lshlrev_b32 v88, 16, v24
    v_and_b32 v89, 0xffff0000, v24
    v_pk_add_f32 v[4:5], v[4:5], v[88:89]
    v_lshlrev_b32 v90, 16, v25
    v_and_b32 v91, 0xffff0000, v25
    v_pk_add_f32 v[4:5], v[4:5], v[90:91]
    v_lshlrev_b32 v92, 16, v26
    v_and_b32 v93, 0xffff0000, v26
    v_pk_add_f32 v[4:5], v[4:5], v[92:93]
    v_lshlrev_b32 v94, 16, v27
    v_and_b32 v95, 0xffff0000, v27
    v_pk_add_f32 v[4:5], v[4:5], v[94:95]
    s_waitcnt vmcnt(4)
    v_lshlrev_b32 v96, 16, v28
    v_and_b32 v97, 0xffff0000, v28
    v_pk_add_f32 v[4:5], v[4:5], v[96:97]
    v_lshlrev_b32 v98, 16, v29
    v_and_b32 v99, 0xffff0000, v29
    v_pk_add_f32 v[4:5], v[4:5], v[98:99]
    v_lshlrev_b32 v100, 16, v30
    v_and_b32 v101, 0xffff0000, v30
    v_pk_add_f32 v[4:5], v[4:5], v[100:101]
    v_lshlrev_b32 v102, 16, v31
    v_and_b32 v103, 0xffff0000, v31
    v_pk_add_f32 v[4:5], v[4:5], v[102:103]
    s_waitcnt vmcnt(3)
    v_lshlrev_b32 v104, 16, v32
    v_and_b32 v105, 0xffff0000, v32
    v_pk_add_f32 v[4:5], v[4:5], v[104:105]
    v_lshlrev_b32 v106, 16, v33
    v_and_b32 v107, 0xffff0000, v33
    v_pk_add_f32 v[4:5], v[4:5], v[106:107]
    v_lshlrev_b32 v108, 16, v34
    v_and_b32 v109, 0xffff0000, v34
    v_pk_add_f32 v[4:5], v[4:5], v[108:109]
    v_lshlrev_b32 v110, 16, v35
    v_and_b32 v111, 0xffff0000, v35
    v_pk_add_f32 v[4:5], v[4:5], v[110:111]
    s_waitcnt vmcnt(2)
    v_lshlrev_b32 v112, 16, v36
    v_and_b32 v113, 0xffff0000, v36
    v_pk_add_f32 v[4:5], v[4:5], v[112:113]
    v_lshlrev_b32 v114, 16, v37
    v_and_b32 v115, 0xffff0000, v37
    v_pk_add_f32 v[4:5], v[4:5], v[114:115]
    v_lshlrev_b32 v116, 16, v38
    v_and_b32 v117, 0xffff0000, v38
    v_pk_add_f32 v[4:5], v[4:5], v[116:117]
    v_lshlrev_b32 v118, 16, v39
    v_and_b32 v119, 0xffff0000, v39
    v_pk_add_f32 v[4:5], v[4:5], v[118:119]
    s_waitcnt vmcnt(1)
    v_lshlrev_b32 v120, 16, v40
    v_and_b32 v121, 0xffff0000, v40
    v_pk_add_f32 v[4:5], v[4:5], v[120:121]
    v_lshlrev_b32 v122, 16, v41
    v_and_b32 v123, 0xffff0000, v41
    v_pk_add_f32 v[4:5], v[4:5], v[122:123]
    v_lshlrev_b32 v124, 16, v42
    v_and_b32 v125, 0xffff0000, v42
    v_pk_add_f32 v[4:5], v[4:5], v[124:125]
    v_lshlrev_b32 v126, 16, v43
    v_and_b32 v127, 0xffff0000, v43
    v_pk_add_f32 v[4:5], v[4:5], v[126:127]
    s_waitcnt vmcnt(0)
    v_lshlrev_b32 v128, 16, v44
    v_and_b32 v129, 0xffff0000, v44
    v_pk_add_f32 v[4:5], v[4:5], v[128:129]
    v_lshlrev_b32 v130, 16, v45
    v_and_b32 v131, 0xffff0000, v45
    v_pk_add_f32 v[4:5], v[4:5], v[130:131]
    v_lshlrev_b32 v132, 16, v46
    v_and_b32 v133, 0xffff0000, v46
    v_pk_add_f32 v[4:5], v[4:5], v[132:133]
    v_lshlrev_b32 v134, 16, v47
    v_and_b32 v135, 0xffff0000, v47
    v_pk_add_f32 v[4:5], v[4:5], v[134:135]
    v_add_f32 v4, v4, v5
    s_nop 1
    v_add_f32_dpp v4, v4, v4 row_ror:8 row_mask:0xf bank_mask:0xf
    v_mov_b32 v7, v4
    s_nop 1
    v_permlane16_swap_b32 v4, v7
    v_add_f32 v4, v4, v7
    v_mov_b32 v7, v4
    s_nop 1
    v_permlane32_swap_b32 v4, v7
    v_add_f32 v4, v4, v7
    v_mul_f32 v4, 0x3acccccd, v4
    v_mov_b32 v5, v4
    v_mov_b32 v48, 0
    v_mov_b32 v49, 0
    v_pk_add_f32 v[50:51], v[56:57], v[4:5] neg_lo:[0,1] neg_hi:[0,1]
    v_pk_fma_f32 v[48:49], v[50:51], v[50:51], v[48:49]
    v_pk_add_f32 v[50:51], v[58:59], v[4:5] neg_lo:[0,1] neg_hi:[0,1]
    v_pk_fma_f32 v[48:49], v[50:51], v[50:51], v[48:49]
    v_pk_add_f32 v[50:51], v[60:61], v[4:5] neg_lo:[0,1] neg_hi:[0,1]
    v_pk_fma_f32 v[48:49], v[50:51], v[50:51], v[48:49]
    v_pk_add_f32 v[50:51], v[62:63], v[4:5] neg_lo:[0,1] neg_hi:[0,1]
    v_pk_fma_f32 v[48:49], v[50:51], v[50:51], v[48:49]
    v_pk_add_f32 v[50:51], v[64:65], v[4:5] neg_lo:[0,1] neg_hi:[0,1]
    v_pk_fma_f32 v[48:49], v[50:51], v[50:51], v[48:49]
    v_pk_add_f32 v[50:51], v[66:67], v[4:5] neg_lo:[0,1] neg_hi:[0,1]
    v_pk_fma_f32 v[48:49], v[50:51], v[50:51], v[48:49]
    v_pk_add_f32 v[50:51], v[68:69], v[4:5] neg_lo:[0,1] neg_hi:[0,1]
    v_pk_fma_f32 v[48:49], v[50:51], v[50:51], v[48:49]
    v_pk_add_f32 v[50:51], v[70:71], v[4:5] neg_lo:[0,1] neg_hi:[0,1]
    v_pk_fma_f32 v[48:49], v[50:51], v[50:51], v[48:49]
    v_pk_add_f32 v[50:51], v[72:73], v[4:5] neg_lo:[0,1] neg_hi:[0,1]
    v_pk_fma_f32 v[48:49], v[50:51], v[50:51], v[48:49]
    v_pk_add_f32 v[50:51], v[74:75], v[4:5] neg_lo:[0,1] neg_hi:[0,1]
    v_pk_fma_f32 v[48:49], v[50:51], v[50:51], v[48:49]
    v_pk_add_f32 v[50:51], v[76:77], v[4:5] neg_lo:[0,1] neg_hi:[0,1]
    v_pk_fma_f32 v[48:49], v[50:51], v[50:51], v[48:49]
    v_pk_add_f32 v[50:51], v[78:79], v[4:5] neg_lo:[0,1] neg_hi:[0,1]
    v_pk_fma_f32 v[48:49], v[50:51], v[50:51], v[48:49]
    v_pk_add_f32 v[50:51], v[80:81], v[4:5] neg_lo:[0,1] neg_hi:[0,1]
    v_pk_fma_f32 v[48:49], v[50:51], v[50:51], v[48:49]
    v_pk_add_f32 v[50:51], v[82:83], v[4:5] neg_lo:[0,1] neg_hi:[0,1]
    v_pk_fma_f32 v[48:49], v[50:51], v[50:51], v[48:49]
    v_pk_add_f32 v[50:51], v[84:85], v[4:5] neg_lo:[0,1] neg_hi:[0,1]
    v_pk_fma_f32 v[48:49], v[50:51], v[50:51], v[48:49]
    v_pk_add_f32 v[50:51], v[86:87], v[4:5] neg_lo:[0,1] neg_hi:[0,1]
    v_pk_fma_f32 v[48:49], v[50:51], v[50:51], v[48:49]
    v_pk_add_f32 v[50:51], v[88:89], v[4:5] neg_lo:[0,1] neg_hi:[0,1]
    v_pk_fma_f32 v[48:49], v[50:51], v[50:51], v[48:49]
    v_pk_add_f32 v[50:51], v[90:91], v[4:5] neg_lo:[0,1] neg_hi:[0,1]
    v_pk_fma_f32 v[48:49], v[50:51], v[50:51], v[48:49]
    v_pk_add_f32 v[50:51], v[92:93], v[4:5] neg_lo:[0,1] neg_hi:[0,1]
    v_pk_fma_f32 v[48:49], v[50:51], v[50:51], v[48:49]
    v_pk_add_f32 v[50:51], v[94:95], v[4:5] neg_lo:[0,1] neg_hi:[0,1]
    v_pk_fma_f32 v[48:49], v[50:51], v[50:51], v[48:49]
    v_pk_add_f32 v[50:51], v[96:97], v[4:5] neg_lo:[0,1] neg_hi:[0,1]
    v_pk_fma_f32 v[48:49], v[50:51], v[50:51], v[48:49]
    v_pk_add_f32 v[50:51], v[98:99], v[4:5] neg_lo:[0,1] neg_hi:[0,1]
    v_pk_fma_f32 v[48:49], v[50:51], v[50:51], v[48:49]
    v_pk_add_f32 v[50:51], v[100:101], v[4:5] neg_lo:[0,1] neg_hi:[0,1]
    v_pk_fma_f32 v[48:49], v[50:51], v[50:51], v[48:49]
    v_pk_add_f32 v[50:51], v[102:103], v[4:5] neg_lo:[0,1] neg_hi:[0,1]
    v_pk_fma_f32 v[48:49], v[50:51], v[50:51], v[48:49]
    v_pk_add_f32 v[50:51], v[104:105], v[4:5] neg_lo:[0,1] neg_hi:[0,1]
    v_pk_fma_f32 v[48:49], v[50:51], v[50:51], v[48:49]
    v_pk_add_f32 v[50:51], v[106:107], v[4:5] neg_lo:[0,1] neg_hi:[0,1]
    v_pk_fma_f32 v[48:49], v[50:51], v[50:51], v[48:49]
    v_pk_add_f32 v[50:51], v[108:109], v[4:5] neg_lo:[0,1] neg_hi:[0,1]
    v_pk_fma_f32 v[48:49], v[50:51], v[50:51], v[48:49]
    v_pk_add_f32 v[50:51], v[110:111], v[4:5] neg_lo:[0,1] neg_hi:[0,1]
    v_pk_fma_f32 v[48:49], v[50:51], v[50:51], v[48:49]
    v_pk_add_f32 v[50:51], v[112:113], v[4:5] neg_lo:[0,1] neg_hi:[0,1]
    v_pk_fma_f32 v[48:49], v[50:51], v[50:51], v[48:49]
    v_pk_add_f32 v[50:51], v[114:115], v[4:5] neg_lo:[0,1] neg_hi:[0,1]
    v_pk_fma_f32 v[48:49], v[50:51], v[50:51], v[48:49]
    v_pk_add_f32 v[50:51], v[116:117], v[4:5] neg_lo:[0,1] neg_hi:[0,1]
    v_pk_fma_f32 v[48:49], v[50:51], v[50:51], v[48:49]
    v_pk_add_f32 v[50:51], v[118:119], v[4:5] neg_lo:[0,1] neg_hi:[0,1]
    v_pk_fma_f32 v[48:49], v[50:51], v[50:51], v[48:49]
    v_pk_add_f32 v[50:51], v[120:121], v[4:5] neg_lo:[0,1] neg_hi:[0,1]
    v_pk_fma_f32 v[48:49], v[50:51], v[50:51], v[48:49]
    v_pk_add_f32 v[50:51], v[122:123], v[4:5] neg_lo:[0,1] neg_hi:[0,1]
    v_pk_fma_f32 v[48:49], v[50:51], v[50:51], v[48:49]
    v_pk_add_f32 v[50:51], v[124:125], v[4:5] neg_lo:[0,1] neg_hi:[0,1]
    v_pk_fma_f32 v[48:49], v[50:51], v[50:51], v[48:49]
    v_pk_add_f32 v[50:51], v[126:127], v[4:5] neg_lo:[0,1] neg_hi:[0,1]
    v_pk_fma_f32 v[48:49], v[50:51], v[50:51], v[48:49]
    v_pk_add_f32 v[50:51], v[128:129], v[4:5] neg_lo:[0,1] neg_hi:[0,1]
    v_pk_fma_f32 v[48:49], v[50:51], v[50:51], v[48:49]
    v_pk_add_f32 v[50:51], v[130:131], v[4:5] neg_lo:[0,1] neg_hi:[0,1]
    v_pk_fma_f32 v[48:49], v[50:51], v[50:51], v[48:49]
    v_pk_add_f32 v[50:51], v[132:133], v[4:5] neg_lo:[0,1] neg_hi:[0,1]
    v_pk_fma_f32 v[48:49], v[50:51], v[50:51], v[48:49]
    v_pk_add_f32 v[50:51], v[134:135], v[4:5] neg_lo:[0,1] neg_hi:[0,1]
    v_pk_fma_f32 v[48:49], v[50:51], v[50:51], v[48:49]
    v_add_f32 v6, v48, v49
    s_nop 1
    v_add_f32_dpp v6, v6, v6 row_ror:8 row_mask:0xf bank_mask:0xf
    v_mov_b32 v7, v6
    s_nop 1
    v_permlane16_swap_b32 v6, v7
    v_add_f32 v6, v6, v7
    v_mov_b32 v7, v6
    s_nop 1
    v_permlane32_swap_b32 v6, v7
    v_add_f32 v6, v6, v7
    v_mul_f32 v6, 0x3acccccd, v6
    v_cvt_pk_bf16_f32 v6, v6, v6
    v_and_b32 v6, 0xffff0000, v6
    v_add_f32 v6, 0x3727c5ac, v6
    v_cvt_pk_bf16_f32 v6, v6, v6
    v_and_b32 v6, 0xffff0000, v6
    v_sqrt_f32 v6, v6
    s_nop 0
    v_cvt_pk_bf16_f32 v6, v6, v6
    v_and_b32 v6, 0xffff0000, v6
    v_rcp_f32 v6, v6
    s_nop 0
    v_mov_b32 v7, v6
    v_cvt_pk_bf16_f32 v4, v4, v4
    v_and_b32 v4, 0xffff0000, v4
    v_mov_b32 v5, v4
    v_pk_add_f32 v[56:57], v[56:57], v[4:5] neg_lo:[0,1] neg_hi:[0,1]
    v_cvt_pk_bf16_f32 v8, v56, v57
    v_lshlrev_b32 v56, 16, v8
    v_and_b32 v57, 0xffff0000, v8
    v_pk_mul_f32 v[56:57], v[56:57], v[6:7]
    v_cvt_pk_bf16_f32 v8, v56, v57
    v_pk_add_f32 v[58:59], v[58:59], v[4:5] neg_lo:[0,1] neg_hi:[0,1]
    v_cvt_pk_bf16_f32 v9, v58, v59
    v_lshlrev_b32 v58, 16, v9
    v_and_b32 v59, 0xffff0000, v9
    v_pk_mul_f32 v[58:59], v[58:59], v[6:7]
    v_cvt_pk_bf16_f32 v9, v58, v59
    v_pk_add_f32 v[60:61], v[60:61], v[4:5] neg_lo:[0,1] neg_hi:[0,1]
    v_cvt_pk_bf16_f32 v10, v60, v61
    v_lshlrev_b32 v60, 16, v10
    v_and_b32 v61, 0xffff0000, v10
    v_pk_mul_f32 v[60:61], v[60:61], v[6:7]
    v_cvt_pk_bf16_f32 v10, v60, v61
    v_pk_add_f32 v[62:63], v[62:63], v[4:5] neg_lo:[0,1] neg_hi:[0,1]
    v_cvt_pk_bf16_f32 v11, v62, v63
    v_lshlrev_b32 v62, 16, v11
    v_and_b32 v63, 0xffff0000, v11
    v_pk_mul_f32 v[62:63], v[62:63], v[6:7]
    v_cvt_pk_bf16_f32 v11, v62, v63
    buffer_store_dwordx4 v[8:11], v2, s[4:7], s29 offen offset:0 sc1
    v_pk_add_f32 v[64:65], v[64:65], v[4:5] neg_lo:[0,1] neg_hi:[0,1]
    v_cvt_pk_bf16_f32 v12, v64, v65
    v_lshlrev_b32 v64, 16, v12
    v_and_b32 v65, 0xffff0000, v12
    v_pk_mul_f32 v[64:65], v[64:65], v[6:7]
    v_cvt_pk_bf16_f32 v12, v64, v65
    v_pk_add_f32 v[66:67], v[66:67], v[4:5] neg_lo:[0,1] neg_hi:[0,1]
    v_cvt_pk_bf16_f32 v13, v66, v67
    v_lshlrev_b32 v66, 16, v13
    v_and_b32 v67, 0xffff0000, v13
    v_pk_mul_f32 v[66:67], v[66:67], v[6:7]
    v_cvt_pk_bf16_f32 v13, v66, v67
    v_pk_add_f32 v[68:69], v[68:69], v[4:5] neg_lo:[0,1] neg_hi:[0,1]
    v_cvt_pk_bf16_f32 v14, v68, v69
    v_lshlrev_b32 v68, 16, v14
    v_and_b32 v69, 0xffff0000, v14
    v_pk_mul_f32 v[68:69], v[68:69], v[6:7]
    v_cvt_pk_bf16_f32 v14, v68, v69
    v_pk_add_f32 v[70:71], v[70:71], v[4:5] neg_lo:[0,1] neg_hi:[0,1]
    v_cvt_pk_bf16_f32 v15, v70, v71
    v_lshlrev_b32 v70, 16, v15
    v_and_b32 v71, 0xffff0000, v15
    v_pk_mul_f32 v[70:71], v[70:71], v[6:7]
    v_cvt_pk_bf16_f32 v15, v70, v71
    buffer_store_dwordx4 v[12:15], v2, s[4:7], s29 offen offset:2048 sc1
    v_pk_add_f32 v[72:73], v[72:73], v[4:5] neg_lo:[0,1] neg_hi:[0,1]
    v_cvt_pk_bf16_f32 v16, v72, v73
    v_lshlrev_b32 v72, 16, v16
    v_and_b32 v73, 0xffff0000, v16
    v_pk_mul_f32 v[72:73], v[72:73], v[6:7]
    v_cvt_pk_bf16_f32 v16, v72, v73
    v_pk_add_f32 v[74:75], v[74:75], v[4:5] neg_lo:[0,1] neg_hi:[0,1]
    v_cvt_pk_bf16_f32 v17, v74, v75
    v_lshlrev_b32 v74, 16, v17
    v_and_b32 v75, 0xffff0000, v17
    v_pk_mul_f32 v[74:75], v[74:75], v[6:7]
    v_cvt_pk_bf16_f32 v17, v74, v75
    v_pk_add_f32 v[76:77], v[76:77], v[4:5] neg_lo:[0,1] neg_hi:[0,1]
    v_cvt_pk_bf16_f32 v18, v76, v77
    v_lshlrev_b32 v76, 16, v18
    v_and_b32 v77, 0xffff0000, v18
    v_pk_mul_f32 v[76:77], v[76:77], v[6:7]
    v_cvt_pk_bf16_f32 v18, v76, v77
    v_pk_add_f32 v[78:79], v[78:79], v[4:5] neg_lo:[0,1] neg_hi:[0,1]
    v_cvt_pk_bf16_f32 v19, v78, v79
    v_lshlrev_b32 v78, 16, v19
    v_and_b32 v79, 0xffff0000, v19
    v_pk_mul_f32 v[78:79], v[78:79], v[6:7]
    v_cvt_pk_bf16_f32 v19, v78, v79
    s_add_u32 s29, s29, 4096
    buffer_store_dwordx4 v[16:19], v2, s[4:7], s29 offen offset:0 sc1
    v_pk_add_f32 v[80:81], v[80:81], v[4:5] neg_lo:[0,1] neg_hi:[0,1]
    v_cvt_pk_bf16_f32 v20, v80, v81
    v_lshlrev_b32 v80, 16, v20
    v_and_b32 v81, 0xffff0000, v20
    v_pk_mul_f32 v[80:81], v[80:81], v[6:7]
    v_cvt_pk_bf16_f32 v20, v80, v81
    v_pk_add_f32 v[82:83], v[82:83], v[4:5] neg_lo:[0,1] neg_hi:[0,1]
    v_cvt_pk_bf16_f32 v21, v82, v83
    v_lshlrev_b32 v82, 16, v21
    v_and_b32 v83, 0xffff0000, v21
    v_pk_mul_f32 v[82:83], v[82:83], v[6:7]
    v_cvt_pk_bf16_f32 v21, v82, v83
    v_pk_add_f32 v[84:85], v[84:85], v[4:5] neg_lo:[0,1] neg_hi:[0,1]
    v_cvt_pk_bf16_f32 v22, v84, v85
    v_lshlrev_b32 v84, 16, v22
    v_and_b32 v85, 0xffff0000, v22
    v_pk_mul_f32 v[84:85], v[84:85], v[6:7]
    v_cvt_pk_bf16_f32 v22, v84, v85
    v_pk_add_f32 v[86:87], v[86:87], v[4:5] neg_lo:[0,1] neg_hi:[0,1]
    v_cvt_pk_bf16_f32 v23, v86, v87
    v_lshlrev_b32 v86, 16, v23
    v_and_b32 v87, 0xffff0000, v23
    v_pk_mul_f32 v[86:87], v[86:87], v[6:7]
    v_cvt_pk_bf16_f32 v23, v86, v87
    buffer_store_dwordx4 v[20:23], v2, s[4:7], s29 offen offset:2048 sc1
    v_pk_add_f32 v[88:89], v[88:89], v[4:5] neg_lo:[0,1] neg_hi:[0,1]
    v_cvt_pk_bf16_f32 v24, v88, v89
    v_lshlrev_b32 v88, 16, v24
    v_and_b32 v89, 0xffff0000, v24
    v_pk_mul_f32 v[88:89], v[88:89], v[6:7]
    v_cvt_pk_bf16_f32 v24, v88, v89
    v_pk_add_f32 v[90:91], v[90:91], v[4:5] neg_lo:[0,1] neg_hi:[0,1]
    v_cvt_pk_bf16_f32 v25, v90, v91
    v_lshlrev_b32 v90, 16, v25
    v_and_b32 v91, 0xffff0000, v25
    v_pk_mul_f32 v[90:91], v[90:91], v[6:7]
    v_cvt_pk_bf16_f32 v25, v90, v91
    v_pk_add_f32 v[92:93], v[92:93], v[4:5] neg_lo:[0,1] neg_hi:[0,1]
    v_cvt_pk_bf16_f32 v26, v92, v93
    v_lshlrev_b32 v92, 16, v26
    v_and_b32 v93, 0xffff0000, v26
    v_pk_mul_f32 v[92:93], v[92:93], v[6:7]
    v_cvt_pk_bf16_f32 v26, v92, v93
    v_pk_add_f32 v[94:95], v[94:95], v[4:5] neg_lo:[0,1] neg_hi:[0,1]
    v_cvt_pk_bf16_f32 v27, v94, v95
    v_lshlrev_b32 v94, 16, v27
    v_and_b32 v95, 0xffff0000, v27
    v_pk_mul_f32 v[94:95], v[94:95], v[6:7]
    v_cvt_pk_bf16_f32 v27, v94, v95
    s_add_u32 s29, s29, 4096
    buffer_store_dwordx4 v[24:27], v2, s[4:7], s29 offen offset:0 sc1
    v_pk_add_f32 v[96:97], v[96:97], v[4:5] neg_lo:[0,1] neg_hi:[0,1]
    v_cvt_pk_bf16_f32 v28, v96, v97
    v_lshlrev_b32 v96, 16, v28
    v_and_b32 v97, 0xffff0000, v28
    v_pk_mul_f32 v[96:97], v[96:97], v[6:7]
    v_cvt_pk_bf16_f32 v28, v96, v97
    v_pk_add_f32 v[98:99], v[98:99], v[4:5] neg_lo:[0,1] neg_hi:[0,1]
    v_cvt_pk_bf16_f32 v29, v98, v99
    v_lshlrev_b32 v98, 16, v29
    v_and_b32 v99, 0xffff0000, v29
    v_pk_mul_f32 v[98:99], v[98:99], v[6:7]
    v_cvt_pk_bf16_f32 v29, v98, v99
    v_pk_add_f32 v[100:101], v[100:101], v[4:5] neg_lo:[0,1] neg_hi:[0,1]
    v_cvt_pk_bf16_f32 v30, v100, v101
    v_lshlrev_b32 v100, 16, v30
    v_and_b32 v101, 0xffff0000, v30
    v_pk_mul_f32 v[100:101], v[100:101], v[6:7]
    v_cvt_pk_bf16_f32 v30, v100, v101
    v_pk_add_f32 v[102:103], v[102:103], v[4:5] neg_lo:[0,1] neg_hi:[0,1]
    v_cvt_pk_bf16_f32 v31, v102, v103
    v_lshlrev_b32 v102, 16, v31
    v_and_b32 v103, 0xffff0000, v31
    v_pk_mul_f32 v[102:103], v[102:103], v[6:7]
    v_cvt_pk_bf16_f32 v31, v102, v103
    buffer_store_dwordx4 v[28:31], v2, s[4:7], s29 offen offset:2048 sc1
    v_pk_add_f32 v[104:105], v[104:105], v[4:5] neg_lo:[0,1] neg_hi:[0,1]
    v_cvt_pk_bf16_f32 v32, v104, v105
    v_lshlrev_b32 v104, 16, v32
    v_and_b32 v105, 0xffff0000, v32
    v_pk_mul_f32 v[104:105], v[104:105], v[6:7]
    v_cvt_pk_bf16_f32 v32, v104, v105
    v_pk_add_f32 v[106:107], v[106:107], v[4:5] neg_lo:[0,1] neg_hi:[0,1]
    v_cvt_pk_bf16_f32 v33, v106, v107
    v_lshlrev_b32 v106, 16, v33
    v_and_b32 v107, 0xffff0000, v33
    v_pk_mul_f32 v[106:107], v[106:107], v[6:7]
    v_cvt_pk_bf16_f32 v33, v106, v107
    v_pk_add_f32 v[108:109], v[108:109], v[4:5] neg_lo:[0,1] neg_hi:[0,1]
    v_cvt_pk_bf16_f32 v34, v108, v109
    v_lshlrev_b32 v108, 16, v34
    v_and_b32 v109, 0xffff0000, v34
    v_pk_mul_f32 v[108:109], v[108:109], v[6:7]
    v_cvt_pk_bf16_f32 v34, v108, v109
    v_pk_add_f32 v[110:111], v[110:111], v[4:5] neg_lo:[0,1] neg_hi:[0,1]
    v_cvt_pk_bf16_f32 v35, v110, v111
    v_lshlrev_b32 v110, 16, v35
    v_and_b32 v111, 0xffff0000, v35
    v_pk_mul_f32 v[110:111], v[110:111], v[6:7]
    v_cvt_pk_bf16_f32 v35, v110, v111
    s_add_u32 s29, s29, 4096
    buffer_store_dwordx4 v[32:35], v2, s[4:7], s29 offen offset:0 sc1
    v_pk_add_f32 v[112:113], v[112:113], v[4:5] neg_lo:[0,1] neg_hi:[0,1]
    v_cvt_pk_bf16_f32 v36, v112, v113
    v_lshlrev_b32 v112, 16, v36
    v_and_b32 v113, 0xffff0000, v36
    v_pk_mul_f32 v[112:113], v[112:113], v[6:7]
    v_cvt_pk_bf16_f32 v36, v112, v113
    v_pk_add_f32 v[114:115], v[114:115], v[4:5] neg_lo:[0,1] neg_hi:[0,1]
    v_cvt_pk_bf16_f32 v37, v114, v115
    v_lshlrev_b32 v114, 16, v37
    v_and_b32 v115, 0xffff0000, v37
    v_pk_mul_f32 v[114:115], v[114:115], v[6:7]
    v_cvt_pk_bf16_f32 v37, v114, v115
    v_pk_add_f32 v[116:117], v[116:117], v[4:5] neg_lo:[0,1] neg_hi:[0,1]
    v_cvt_pk_bf16_f32 v38, v116, v117
    v_lshlrev_b32 v116, 16, v38
    v_and_b32 v117, 0xffff0000, v38
    v_pk_mul_f32 v[116:117], v[116:117], v[6:7]
    v_cvt_pk_bf16_f32 v38, v116, v117
    v_pk_add_f32 v[118:119], v[118:119], v[4:5] neg_lo:[0,1] neg_hi:[0,1]
    v_cvt_pk_bf16_f32 v39, v118, v119
    v_lshlrev_b32 v118, 16, v39
    v_and_b32 v119, 0xffff0000, v39
    v_pk_mul_f32 v[118:119], v[118:119], v[6:7]
    v_cvt_pk_bf16_f32 v39, v118, v119
    buffer_store_dwordx4 v[36:39], v2, s[4:7], s29 offen offset:2048 sc1
    v_pk_add_f32 v[120:121], v[120:121], v[4:5] neg_lo:[0,1] neg_hi:[0,1]
    v_cvt_pk_bf16_f32 v40, v120, v121
    v_lshlrev_b32 v120, 16, v40
    v_and_b32 v121, 0xffff0000, v40
    v_pk_mul_f32 v[120:121], v[120:121], v[6:7]
    v_cvt_pk_bf16_f32 v40, v120, v121
    v_pk_add_f32 v[122:123], v[122:123], v[4:5] neg_lo:[0,1] neg_hi:[0,1]
    v_cvt_pk_bf16_f32 v41, v122, v123
    v_lshlrev_b32 v122, 16, v41
    v_and_b32 v123, 0xffff0000, v41
    v_pk_mul_f32 v[122:123], v[122:123], v[6:7]
    v_cvt_pk_bf16_f32 v41, v122, v123
    v_pk_add_f32 v[124:125], v[124:125], v[4:5] neg_lo:[0,1] neg_hi:[0,1]
    v_cvt_pk_bf16_f32 v42, v124, v125
    v_lshlrev_b32 v124, 16, v42
    v_and_b32 v125, 0xffff0000, v42
    v_pk_mul_f32 v[124:125], v[124:125], v[6:7]
    v_cvt_pk_bf16_f32 v42, v124, v125
    v_pk_add_f32 v[126:127], v[126:127], v[4:5] neg_lo:[0,1] neg_hi:[0,1]
    v_cvt_pk_bf16_f32 v43, v126, v127
    v_lshlrev_b32 v126, 16, v43
    v_and_b32 v127, 0xffff0000, v43
    v_pk_mul_f32 v[126:127], v[126:127], v[6:7]
    v_cvt_pk_bf16_f32 v43, v126, v127
    s_add_u32 s29, s29, 4096
    buffer_store_dwordx4 v[40:43], v2, s[4:7], s29 offen offset:0 sc1
    v_pk_add_f32 v[128:129], v[128:129], v[4:5] neg_lo:[0,1] neg_hi:[0,1]
    v_cvt_pk_bf16_f32 v44, v128, v129
    v_lshlrev_b32 v128, 16, v44
    v_and_b32 v129, 0xffff0000, v44
    v_pk_mul_f32 v[128:129], v[128:129], v[6:7]
    v_cvt_pk_bf16_f32 v44, v128, v129
    v_pk_add_f32 v[130:131], v[130:131], v[4:5] neg_lo:[0,1] neg_hi:[0,1]
    v_cvt_pk_bf16_f32 v45, v130, v131
    v_lshlrev_b32 v130, 16, v45
    v_and_b32 v131, 0xffff0000, v45
    v_pk_mul_f32 v[130:131], v[130:131], v[6:7]
    v_cvt_pk_bf16_f32 v45, v130, v131
    v_pk_add_f32 v[132:133], v[132:133], v[4:5] neg_lo:[0,1] neg_hi:[0,1]
    v_cvt_pk_bf16_f32 v46, v132, v133
    v_lshlrev_b32 v132, 16, v46
    v_and_b32 v133, 0xffff0000, v46
    v_pk_mul_f32 v[132:133], v[132:133], v[6:7]
    v_cvt_pk_bf16_f32 v46, v132, v133
    v_pk_add_f32 v[134:135], v[134:135], v[4:5] neg_lo:[0,1] neg_hi:[0,1]
    v_cvt_pk_bf16_f32 v47, v134, v135
    v_lshlrev_b32 v134, 16, v47
    v_and_b32 v135, 0xffff0000, v47
    v_pk_mul_f32 v[134:135], v[134:135], v[6:7]
    v_cvt_pk_bf16_f32 v47, v134, v135
    buffer_store_dwordx4 v[44:47], v2, s[4:7], s29 offen offset:2048 sc1
LO_noln:
    s_mov_b32 s8, s54
    s_mov_b32 s9, s55
    s_mov_b32 s10, 1966080
    s_mov_b32 s11, 0x20000
    s_waitcnt vmcnt(0)
    s_barrier
    s_cmp_lg_u32 s24, 0
    s_cbranch_scc1 Larr_57
    s_and_b32 s28, s2, 1
    s_lshl_b32 s28, s28, 6
    v_mov_b32 v200, 1
    s_mov_b64 exec, 1
    buffer_atomic_add v200, off, s[16:19], s28 sc1
    s_mov_b64 exec, -1
Larr_57:
    s_mov_b32 s32, 0
    buffer_load_dwordx2 v[200:201], off, s[16:19], 0 offset:128 sc1
    s_waitcnt vmcnt(0)
Lws_58:
    v_readfirstlane_b32 s28, v200
    v_readfirstlane_b32 s34, v201
    s_nop 0
    s_min_u32 s28, s28, s34
    s_cmp_eq_u32 s28, 0
    s_cbranch_scc1 Lretry_59
    s_and_b32 s62, s34, 24576
    s_xor_b32 s63, s62, 16384
    s_add_u32 s62, s62, s33
    s_add_u32 s63, s63, s33
    s_and_b32 s34, s34, 8192
    s_add_u32 s33, s33, s34
    s_and_b32 s28, s25, 15
    s_lshl_b32 s28, s28, 9
    s_add_u32 s28, s28, 163610624
    v_mov_b32 v201, s28
    s_mov_b32 s66, 2
    s_mov_b32 s32, 0
    buffer_load_dword v200, v201, s[4:7], 0 offen sc1
    s_waitcnt vmcnt(0)
Lwf_60:
    v_cmp_gt_u32 vcc, s66, v200
    s_cbranch_vccnz Lretry_62
Lwfd_61:
    s_and_b32 s71, s25, 7
    s_lshr_b32 s26, s25, 3
    s_mov_b32 s12, s36
    s_mov_b32 s13, s37
    s_mov_b32 s14, 2621440
    s_mov_b32 s15, 0x20000
    s_mov_b32 s20, s56
    s_mov_b32 s21, s57
    s_mov_b32 s22, 2621440
    s_mov_b32 s23, 0x20000
    v_add_u32 v2, 0, v1
    v_mul_u32_u24 v3, 6554, v2
    v_lshrrev_b32 v3, 16, v3
    v_mul_u32_u24 v4, 10, v3
    v_sub_u32 v2, v2, v4
    v_mul_u32_u24 v3, 1280, v3
    v_lshl_add_u32 v4, v2, 4, v3
    v_add_u32 v2, 64, v1
    v_mul_u32_u24 v3, 6554, v2
    v_lshrrev_b32 v3, 16, v3
    v_mul_u32_u24 v5, 10, v3
    v_sub_u32 v2, v2, v5
    v_mul_u32_u24 v3, 1280, v3
    v_lshl_add_u32 v5, v2, 4, v3
    v_add_u32 v2, 128, v1
    v_mul_u32_u24 v3, 6554, v2
    v_lshrrev_b32 v3, 16, v3
    v_mul_u32_u24 v6, 10, v3
    v_sub_u32 v2, v2, v6
    v_mul_u32_u24 v3, 1280, v3
    v_lshl_add_u32 v6, v2, 4, v3
    v_add_u32 v2, 192, v1
    v_mul_u32_u24 v3, 6554, v2
    v_lshrrev_b32 v3, 16, v3
    v_mul_u32_u24 v7, 10, v3
    v_sub_u32 v2, v2, v7
    v_mul_u32_u24 v3, 1280, v3
    v_lshl_add_u32 v7, v2, 4, v3
    v_add_u32 v2, 256, v1
    v_mul_u32_u24 v3, 6554, v2
    v_lshrrev_b32 v3, 16, v3
    v_mul_u32_u24 v8, 10, v3
    v_sub_u32 v2, v2, v8
    v_mul_u32_u24 v3, 1280, v3
    v_lshl_add_u32 v8, v2, 4, v3
    v_and_b32 v10, 3, v1
    v_lshlrev_b32 v10, 3, v10
    v_bfe_u32 v11, v1, 5, 1
    v_mul_u32_u24 v11, 1280, v11
    v_add_u32 v10, v10, v11
    v_bfe_u32 v11, v1, 4, 1
    v_mul_u32_u24 v11, 640, v11
    v_add_u32 v10, v10, v11
    v_bfe_u32 v11, v1, 3, 1
    v_mul_u32_u24 v11, 320, v11
    v_add_u32 v10, v10, v11
    v_bfe_u32 v11, v1, 2, 1
    v_mul_u32_u24 v11, 160, v11
    v_add_u32 v10, v10, v11
    s_mul_i32 s28, s24, 5120
    v_add_u32 v10, s28, v10
    v_add_u32 v11, 49152, v10
    v_add_u32 v12, 98304, v10
    s_mul_i32 s64, s24, 491520
    s_mul_i32 s28, s71, 160
    s_add_u32 s64, s64, s28
    s_mul_i32 s29, s24, 5120
    s_add_u32 s28, s64, 0
    s_add_u32 m0, s29, 0
    s_nop 0
    buffer_load_dwordx4 v4, s[8:11], s28 offen lds
    s_add_u32 m0, s29, 1024
    s_nop 0
    buffer_load_dwordx4 v5, s[8:11], s28 offen lds
    s_add_u32 m0, s29, 2048
    s_nop 0
    buffer_load_dwordx4 v6, s[8:11], s28 offen lds
    s_add_u32 m0, s29, 3072
    s_nop 0
    buffer_load_dwordx4 v7, s[8:11], s28 offen lds
    s_add_u32 m0, s29, 4096
    s_nop 0
    buffer_load_dwordx4 v8, s[8:11], s28 offen lds
    s_mul_i32 s29, s24, 5120
    s_add_u32 s28, s64, 40960
    s_add_u32 m0, s29, 24576
    s_nop 0
    buffer_load_dwordx4 v4, s[8:11], s28 offen lds
    s_add_u32 m0, s29, 25600
    s_nop 0
    buffer_load_dwordx4 v5, s[8:11], s28 offen lds
    s_add_u32 m0, s29, 26624
    s_nop 0
    buffer_load_dwordx4 v6, s[8:11], s28 offen lds
    s_add_u32 m0, s29, 27648
    s_nop 0
    buffer_load_dwordx4 v7, s[8:11], s28 offen lds
    s_add_u32 m0, s29, 28672
    s_nop 0
    buffer_load_dwordx4 v8, s[8:11], s28 offen lds
    s_mul_i32 s29, s24, 5120
    s_add_u32 s28, s64, 81920
    s_add_u32 m0, s29, 49152
    s_nop 0
    buffer_load_dwordx4 v4, s[8:11], s28 offen lds
    s_add_u32 m0, s29, 50176
    s_nop 0
    buffer_load_dwordx4 v5, s[8:11], s28 offen lds
    s_add_u32 m0, s29, 51200
    s_nop 0
    buffer_load_dwordx4 v6, s[8:11], s28 offen lds
    s_add_u32 m0, s29, 52224
    s_nop 0
    buffer_load_dwordx4 v7, s[8:11], s28 offen lds
    s_add_u32 m0, s29, 53248
    s_nop 0
    buffer_load_dwordx4 v8, s[8:11], s28 offen lds
    s_mul_i32 s29, s24, 5120
    s_add_u32 s28, s64, 122880
    s_add_u32 m0, s29, 73728
    s_nop 0
    buffer_load_dwordx4 v4, s[8:11], s28 offen lds
    s_add_u32 m0, s29, 74752
    s_nop 0
    buffer_load_dwordx4 v5, s[8:11], s28 offen lds
    s_add_u32 m0, s29, 75776
    s_nop 0
    buffer_load_dwordx4 v6, s[8:11], s28 offen lds
    s_add_u32 m0, s29, 76800
    s_nop 0
    buffer_load_dwordx4 v7, s[8:11], s28 offen lds
    s_add_u32 m0, s29, 77824
    s_nop 0
    buffer_load_dwordx4 v8, s[8:11], s28 offen lds
    s_mul_i32 s29, s24, 5120
    s_add_u32 s28, s64, 163840
    s_add_u32 m0, s29, 98304
    s_nop 0
    buffer_load_dwordx4 v4, s[8:11], s28 offen lds
    s_add_u32 m0, s29, 99328
    s_nop 0
    buffer_load_dwordx4 v5, s[8:11], s28 offen lds
    s_add_u32 m0, s29, 100352
    s_nop 0
    buffer_load_dwordx4 v6, s[8:11], s28 offen lds
    s_add_u32 m0, s29, 101376
    s_nop 0
    buffer_load_dwordx4 v7, s[8:11], s28 offen lds
    s_add_u32 m0, s29, 102400
    s_nop 0
    buffer_load_dwordx4 v8, s[8:11], s28 offen lds
    s_mul_i32 s29, s24, 5120
    s_add_u32 s28, s64, 204800
    s_add_u32 m0, s29, 122880
    s_nop 0
    buffer_load_dwordx4 v4, s[8:11], s28 offen lds
    s_add_u32 m0, s29, 123904
    s_nop 0
    buffer_load_dwordx4 v5, s[8:11], s28 offen lds
    s_add_u32 m0, s29, 124928
    s_nop 0
    buffer_load_dwordx4 v6, s[8:11], s28 offen lds
    s_add_u32 m0, s29, 125952
    s_nop 0
    buffer_load_dwordx4 v7, s[8:11], s28 offen lds
    s_add_u32 m0, s29, 126976
    s_nop 0
    buffer_load_dwordx4 v8, s[8:11], s28 offen lds
    s_waitcnt vmcnt(25)
    s_waitcnt lgkmcnt(0)
    s_barrier
    ds_read_b64_tr_b16 a[0:1], v10 offset:0
    ds_read_b64_tr_b16 a[2:3], v10 offset:2560
    ds_read_b64_tr_b16 a[4:5], v10 offset:32
    ds_read_b64_tr_b16 a[6:7], v10 offset:2592
    ds_read_b64_tr_b16 a[8:9], v10 offset:64
    ds_read_b64_tr_b16 a[10:11], v10 offset:2624
    ds_read_b64_tr_b16 a[12:13], v10 offset:96
    ds_read_b64_tr_b16 a[14:15], v10 offset:2656
    ds_read_b64_tr_b16 a[16:17], v10 offset:128
    ds_read_b64_tr_b16 a[18:19], v10 offset:2688
    s_waitcnt vmcnt(20)
    s_waitcnt lgkmcnt(0)
    s_barrier
    ds_read_b64_tr_b16 a[20:21], v10 offset:24576
    ds_read_b64_tr_b16 a[22:23], v10 offset:27136
    ds_read_b64_tr_b16 a[24:25], v10 offset:24608
    ds_read_b64_tr_b16 a[26:27], v10 offset:27168
    ds_read_b64_tr_b16 a[28:29], v10 offset:24640
    ds_read_b64_tr_b16 a[30:31], v10 offset:27200
    ds_read_b64_tr_b16 a[32:33], v10 offset:24672
    ds_read_b64_tr_b16 a[34:35], v10 offset:27232
    ds_read_b64_tr_b16 a[36:37], v10 offset:24704
    ds_read_b64_tr_b16 a[38:39], v10 offset:27264
    s_mul_i32 s29, s24, 5120
    s_add_u32 s28, s64, 245760
    s_add_u32 m0, s29, 0
    s_nop 0
    buffer_load_dwordx4 v4, s[8:11], s28 offen lds
    s_add_u32 m0, s29, 1024
    s_nop 0
    buffer_load_dwordx4 v5, s[8:11], s28 offen lds
    s_add_u32 m0, s29, 2048
    s_nop 0
    buffer_load_dwordx4 v6, s[8:11], s28 offen lds
    s_add_u32 m0, s29, 3072
    s_nop 0
    buffer_load_dwordx4 v7, s[8:11], s28 offen lds
    s_add_u32 m0, s29, 4096
    s_nop 0
    buffer_load_dwordx4 v8, s[8:11], s28 offen lds
    s_waitcnt vmcnt(20)
    s_waitcnt lgkmcnt(0)
    s_barrier
    ds_read_b64_tr_b16 a[40:41], v11 offset:0
    ds_read_b64_tr_b16 a[42:43], v11 offset:2560
    ds_read_b64_tr_b16 a[44:45], v11 offset:32
    ds_read_b64_tr_b16 a[46:47], v11 offset:2592
    ds_read_b64_tr_b16 a[48:49], v11 offset:64
    ds_read_b64_tr_b16 a[50:51], v11 offset:2624
    ds_read_b64_tr_b16 a[52:53], v11 offset:96
    ds_read_b64_tr_b16 a[54:55], v11 offset:2656
    ds_read_b64_tr_b16 a[56:57], v11 offset:128
    ds_read_b64_tr_b16 a[58:59], v11 offset:2688
    s_mul_i32 s29, s24, 5120
    s_add_u32 s28, s64, 286720
    s_add_u32 m0, s29, 24576
    s_nop 0
    buffer_load_dwordx4 v4, s[8:11], s28 offen lds
    s_add_u32 m0, s29, 25600
    s_nop 0
    buffer_load_dwordx4 v5, s[8:11], s28 offen lds
    s_add_u32 m0, s29, 26624
    s_nop 0
    buffer_load_dwordx4 v6, s[8:11], s28 offen lds
    s_add_u32 m0, s29, 27648
    s_nop 0
    buffer_load_dwordx4 v7, s[8:11], s28 offen lds
    s_add_u32 m0, s29, 28672
    s_nop 0
    buffer_load_dwordx4 v8, s[8:11], s28 offen lds
    s_waitcnt vmcnt(20)
    s_waitcnt lgkmcnt(0)
    s_barrier
    ds_read_b64_tr_b16 a[60:61], v11 offset:24576
    ds_read_b64_tr_b16 a[62:63], v11 offset:27136
    ds_read_b64_tr_b16 a[64:65], v11 offset:24608
    ds_read_b64_tr_b16 a[66:67], v11 offset:27168
    ds_read_b64_tr_b16 a[68:69], v11 offset:24640
    ds_read_b64_tr_b16 a[70:71], v11 offset:27200
    ds_read_b64_tr_b16 a[72:73], v11 offset:24672
    ds_read_b64_tr_b16 a[74:75], v11 offset:27232
    ds_read_b64_tr_b16 a[76:77], v11 offset:24704
    ds_read_b64_tr_b16 a[78:79], v11 offset:27264
    s_mul_i32 s29, s24, 5120
    s_add_u32 s28, s64, 327680
    s_add_u32 m0, s29, 49152
    s_nop 0
    buffer_load_dwordx4 v4, s[8:11], s28 offen lds
    s_add_u32 m0, s29, 50176
    s_nop 0
    buffer_load_dwordx4 v5, s[8:11], s28 offen lds
    s_add_u32 m0, s29, 51200
    s_nop 0
    buffer_load_dwordx4 v6, s[8:11], s28 offen lds
    s_add_u32 m0, s29, 52224
    s_nop 0
    buffer_load_dwordx4 v7, s[8:11], s28 offen lds
    s_add_u32 m0, s29, 53248
    s_nop 0
    buffer_load_dwordx4 v8, s[8:11], s28 offen lds
    s_waitcnt vmcnt(20)
    s_waitcnt lgkmcnt(0)
    s_barrier
    ds_read_b64_tr_b16 a[80:81], v12 offset:0
    ds_read_b64_tr_b16 a[82:83], v12 offset:2560
    ds_read_b64_tr_b16 a[84:85], v12 offset:32
    ds_read_b64_tr_b16 a[86:87], v12 offset:2592
    ds_read_b64_tr_b16 a[88:89], v12 offset:64
    ds_read_b64_tr_b16 a[90:91], v12 offset:2624
    ds_read_b64_tr_b16 a[92:93], v12 offset:96
    ds_read_b64_tr_b16 a[94:95], v12 offset:2656
    ds_read_b64_tr_b16 a[96:97], v12 offset:128
    ds_read_b64_tr_b16 a[98:99], v12 offset:2688
    s_mul_i32 s29, s24, 5120
    s_add_u32 s28, s64, 368640
    s_add_u32 m0, s29, 73728
    s_nop 0
    buffer_load_dwordx4 v4, s[8:11], s28 offen lds
    s_add_u32 m0, s29, 74752
    s_nop 0
    buffer_load_dwordx4 v5, s[8:11], s28 offen lds
    s_add_u32 m0, s29, 75776
    s_nop 0
    buffer_load_dwordx4 v6, s[8:11], s28 offen lds
    s_add_u32 m0, s29, 76800
    s_nop 0
    buffer_load_dwordx4 v7, s[8:11], s28 offen lds
    s_add_u32 m0, s29, 77824
    s_nop 0
    buffer_load_dwordx4 v8, s[8:11], s28 offen lds
    s_waitcnt vmcnt(20)
    s_waitcnt lgkmcnt(0)
    s_barrier
    ds_read_b64_tr_b16 a[100:101], v12 offset:24576
    ds_read_b64_tr_b16 a[102:103], v12 offset:27136
    ds_read_b64_tr_b16 a[104:105], v12 offset:24608
    ds_read_b64_tr_b16 a[106:107], v12 offset:27168
    ds_read_b64_tr_b16 a[108:109], v12 offset:24640
    ds_read_b64_tr_b16 a[110:111], v12 offset:27200
    ds_read_b64_tr_b16 a[112:113], v12 offset:24672
    ds_read_b64_tr_b16 a[114:115], v12 offset:27232
    ds_read_b64_tr_b16 a[116:117], v12 offset:24704
    ds_read_b64_tr_b16 a[118:119], v12 offset:27264
    s_mul_i32 s29, s24, 5120
    s_add_u32 s28, s64, 409600
    s_add_u32 m0, s29, 98304
    s_nop 0
    buffer_load_dwordx4 v4, s[8:11], s28 offen lds
    s_add_u32 m0, s29, 99328
    s_nop 0
    buffer_load_dwordx4 v5, s[8:11], s28 offen lds
    s_add_u32 m0, s29, 100352
    s_nop 0
    buffer_load_dwordx4 v6, s[8:11], s28 offen lds
    s_add_u32 m0, s29, 101376
    s_nop 0
    buffer_load_dwordx4 v7, s[8:11], s28 offen lds
    s_add_u32 m0, s29, 102400
    s_nop 0
    buffer_load_dwordx4 v8, s[8:11], s28 offen lds
    s_waitcnt vmcnt(20)
    s_waitcnt lgkmcnt(0)
    s_barrier
    ds_read_b64_tr_b16 a[120:121], v10 offset:0
    ds_read_b64_tr_b16 a[122:123], v10 offset:2560
    ds_read_b64_tr_b16 a[124:125], v10 offset:32
    ds_read_b64_tr_b16 a[126:127], v10 offset:2592
    ds_read_b64_tr_b16 a[128:129], v10 offset:64
    ds_read_b64_tr_b16 a[130:131], v10 offset:2624
    ds_read_b64_tr_b16 a[132:133], v10 offset:96
    ds_read_b64_tr_b16 a[134:135], v10 offset:2656
    ds_read_b64_tr_b16 a[136:137], v10 offset:128
    ds_read_b64_tr_b16 a[138:139], v10 offset:2688
    s_mul_i32 s29, s24, 5120
    s_add_u32 s28, s64, 450560
    s_add_u32 m0, s29, 122880
    s_nop 0
    buffer_load_dwordx4 v4, s[8:11], s28 offen lds
    s_add_u32 m0, s29, 123904
    s_nop 0
    buffer_load_dwordx4 v5, s[8:11], s28 offen lds
    s_add_u32 m0, s29, 124928
    s_nop 0
    buffer_load_dwordx4 v6, s[8:11], s28 offen lds
    s_add_u32 m0, s29, 125952
    s_nop 0
    buffer_load_dwordx4 v7, s[8:11], s28 offen lds
    s_add_u32 m0, s29, 126976
    s_nop 0
    buffer_load_dwordx4 v8, s[8:11], s28 offen lds
    s_waitcnt vmcnt(20)
    s_waitcnt lgkmcnt(0)
    s_barrier
    ds_read_b64_tr_b16 a[140:141], v10 offset:24576
    ds_read_b64_tr_b16 a[142:143], v10 offset:27136
    ds_read_b64_tr_b16 a[144:145], v10 offset:24608
    ds_read_b64_tr_b16 a[146:147], v10 offset:27168
    ds_read_b64_tr_b16 a[148:149], v10 offset:24640
    ds_read_b64_tr_b16 a[150:151], v10 offset:27200
    ds_read_b64_tr_b16 a[152:153], v10 offset:24672
    ds_read_b64_tr_b16 a[154:155], v10 offset:27232
    ds_read_b64_tr_b16 a[156:157], v10 offset:24704
    ds_read_b64_tr_b16 a[158:159], v10 offset:27264
    s_waitcnt vmcnt(15)
    s_waitcnt lgkmcnt(0)
    s_barrier
    ds_read_b64_tr_b16 a[160:161], v11 offset:0
    ds_read_b64_tr_b16 a[162:163], v11 offset:2560
    ds_read_b64_tr_b16 a[164:165], v11 offset:32
    ds_read_b64_tr_b16 a[166:167], v11 offset:2592
    ds_read_b64_tr_b16 a[168:169], v11 offset:64
    ds_read_b64_tr_b16 a[170:171], v11 offset:2624
    ds_read_b64_tr_b16 a[172:173], v11 offset:96
    ds_read_b64_tr_b16 a[174:175], v11 offset:2656
    ds_read_b64_tr_b16 a[176:177], v11 offset:128
    ds_read_b64_tr_b16 a[178:179], v11 offset:2688
    s_waitcnt vmcnt(10)
    s_waitcnt lgkmcnt(0)
    s_barrier
    ds_read_b64_tr_b16 a[180:181], v11 offset:24576
    ds_read_b64_tr_b16 a[182:183], v11 offset:27136
    ds_read_b64_tr_b16 a[184:185], v11 offset:24608
    ds_read_b64_tr_b16 a[186:187], v11 offset:27168
    ds_read_b64_tr_b16 a[188:189], v11 offset:24640
    ds_read_b64_tr_b16 a[190:191], v11 offset:27200
    ds_read_b64_tr_b16 a[192:193], v11 offset:24672
    ds_read_b64_tr_b16 a[194:195], v11 offset:27232
    ds_read_b64_tr_b16 a[196:197], v11 offset:24704
    ds_read_b64_tr_b16 a[198:199], v11 offset:27264
    s_waitcnt vmcnt(5)
    s_waitcnt lgkmcnt(0)
    s_barrier
    ds_read_b64_tr_b16 a[200:201], v12 offset:0
    ds_read_b64_tr_b16 a[202:203], v12 offset:2560
    ds_read_b64_tr_b16 a[204:205], v12 offset:32
    ds_read_b64_tr_b16 a[206:207], v12 offset:2592
    ds_read_b64_tr_b16 a[208:209], v12 offset:64
    ds_read_b64_tr_b16 a[210:211], v12 offset:2624
    ds_read_b64_tr_b16 a[212:213], v12 offset:96
    ds_read_b64_tr_b16 a[214:215], v12 offset:2656
    ds_read_b64_tr_b16 a[216:217], v12 offset:128
    ds_read_b64_tr_b16 a[218:219], v12 offset:2688
    s_waitcnt vmcnt(0)
    s_waitcnt lgkmcnt(0)
    s_barrier
    ds_read_b64_tr_b16 a[220:221], v12 offset:24576
    ds_read_b64_tr_b16 a[222:223], v12 offset:27136
    ds_read_b64_tr_b16 a[224:225], v12 offset:24608
    ds_read_b64_tr_b16 a[226:227], v12 offset:27168
    ds_read_b64_tr_b16 a[228:229], v12 offset:24640
    ds_read_b64_tr_b16 a[230:231], v12 offset:27200
    ds_read_b64_tr_b16 a[232:233], v12 offset:24672
    ds_read_b64_tr_b16 a[234:235], v12 offset:27232
    ds_read_b64_tr_b16 a[236:237], v12 offset:24704
    ds_read_b64_tr_b16 a[238:239], v12 offset:27264
    s_waitcnt vmcnt(0) lgkmcnt(0)
    s_barrier
    v_lshlrev_b32 v13, 4, v1
    s_mul_i32 s28, s24, 24
    v_min_u32 v14, 23, v1
    v_add_u32 v14, s28, v14
    v_lshrrev_b32 v14, 2, v14
    v_lshlrev_b32 v14, 7, v14
    v_add_u32 v14, 163627008, v14
    v_and_b32 v15, 31, v1
    v_lshlrev_b32 v15, 7, v15
    s_lshl_b32 s28, s24, 12
    s_add_u32 s28, s28, 163610624
    v_add_u32 v15, s28, v15
    v_cmp_gt_u32 vcc, 32, v1
    s_nop 1
    v_cndmask_b32 v14, v15, v14, vcc
    v_add_u32 v15, 20480, v15
    s_mul_i32 s28, s24, 10240
    v_add_u32 v16, s28, v13
    v_and_b32 v17, 15, v1
    v_mul_u32_u24 v17, 1280, v17
    v_lshrrev_b32 v2, 4, v1
    v_lshl_add_u32 v17, v2, 3, v17
    s_mul_i32 s28, s71, 160
    v_add_u32 v17, s28, v17
    s_lshl_b32 s29, s24, 10
    v_add_u32 v4, s29, v13
    s_and_b32 s28, s24, 1
    s_lshl_b32 s28, s28, 10
    s_add_u32 s28, s28, 8192
    v_add_u32 v5, s28, v13
LO_fill:
    s_add_u32 s66, s26, 1
    s_mov_b32 s32, 0
    buffer_load_dword v2, v14, s[4:7], 0 offen sc1
    s_waitcnt vmcnt(0)
Lwf_63:
    v_cmp_gt_u32 vcc, s66, v2
    s_cbranch_vccnz Lretry_65
Lwfd_64:
    s_mul_i32 s96, s26, 98304
    s_mul_i32 s28, s24, 24576
    s_add_u32 s96, s96, s28
    s_add_u32 s96, s96, 54525952
    s_mul_i32 s97, s26, 1310720
    s_mul_i32 s28, s71, 163840
    s_add_u32 s97, s97, s28
    s_lshl_b32 s28, s24, 13
    s_add_u32 s97, s97, s28
    s_add_u32 s97, s97, 60817408
    s_add_u32 s28, s96, 0
    buffer_load_dwordx4 v[60:63], v13, s[4:7], s28 offen sc1
    s_add_u32 s28, s96, 1024
    buffer_load_dwordx4 v[64:67], v13, s[4:7], s28 offen sc1
    s_add_u32 s28, s96, 2048
    buffer_load_dwordx4 v[68:71], v13, s[4:7], s28 offen sc1
    s_add_u32 s28, s96, 3072
    buffer_load_dwordx4 v[72:75], v13, s[4:7], s28 offen sc1
    s_add_u32 s28, s97, 3072
    buffer_load_dwordx4 v[176:179], v13, s[4:7], s28 offen sc1
    s_add_u32 s28, s97, 35840
    buffer_load_dwordx4 v[180:183], v13, s[4:7], s28 offen sc1
    s_add_u32 s28, s97, 68608
    buffer_load_dwordx4 v[184:187], v13, s[4:7], s28 offen sc1
    s_add_u32 s28, s97, 101376
    buffer_load_dwordx4 v[188:191], v13, s[4:7], s28 offen sc1
    s_add_u32 s28, s97, 134144
    buffer_load_dwordx4 v[192:195], v13, s[4:7], s28 offen sc1
    s_add_u32 s28, s96, 4096
    buffer_load_dwordx4 v[76:79], v13, s[4:7], s28 offen sc1
    s_add_u32 s28, s96, 5120
    buffer_load_dwordx4 v[80:83], v13, s[4:7], s28 offen sc1
    s_add_u32 s28, s97, 4096
    buffer_load_dwordx4 v[196:199], v13, s[4:7], s28 offen sc1
    s_add_u32 s28, s97, 36864
    buffer_load_dwordx4 v[200:203], v13, s[4:7], s28 offen sc1
    s_add_u32 s28, s97, 69632
    buffer_load_dwordx4 v[204:207], v13, s[4:7], s28 offen sc1
    s_add_u32 s28, s97, 102400
    buffer_load_dwordx4 v[208:211], v13, s[4:7], s28 offen sc1
    s_add_u32 s28, s97, 135168
    buffer_load_dwordx4 v[212:215], v13, s[4:7], s28 offen sc1
    s_add_u32 s28, s96, 6144
    buffer_load_dwordx4 v[84:87], v13, s[4:7], s28 offen sc1
    s_add_u32 s28, s96, 7168
    buffer_load_dwordx4 v[88:91], v13, s[4:7], s28 offen sc1
    s_add_u32 s28, s97, 5120
    buffer_load_dwordx4 v[216:219], v13, s[4:7], s28 offen sc1
    s_add_u32 s28, s97, 37888
    buffer_load_dwordx4 v[220:223], v13, s[4:7], s28 offen sc1
    s_add_u32 s28, s97, 70656
    buffer_load_dwordx4 v[224:227], v13, s[4:7], s28 offen sc1
    s_add_u32 s28, s97, 103424
    buffer_load_dwordx4 v[228:231], v13, s[4:7], s28 offen sc1
    s_add_u32 s28, s97, 136192
    buffer_load_dwordx4 v[232:235], v13, s[4:7], s28 offen sc1
    s_add_u32 s28, s96, 8192
    buffer_load_dwordx4 v[92:95], v13, s[4:7], s28 offen sc1
    s_add_u32 s28, s96, 9216
    buffer_load_dwordx4 v[96:99], v13, s[4:7], s28 offen sc1
    s_add_u32 s28, s97, 6144
    buffer_load_dwordx4 v[236:239], v13, s[4:7], s28 offen sc1
    s_add_u32 s28, s97, 38912
    buffer_load_dwordx4 v[240:243], v13, s[4:7], s28 offen sc1
    s_add_u32 s28, s97, 71680
    buffer_load_dwordx4 v[244:247], v13, s[4:7], s28 offen sc1
    s_add_u32 s28, s97, 104448
    buffer_load_dwordx4 v[248:251], v13, s[4:7], s28 offen sc1
    s_add_u32 s28, s97, 137216
    buffer_load_dwordx4 v[252:255], v13, s[4:7], s28 offen sc1
    s_add_u32 s28, s96, 10240
    buffer_load_dwordx4 v[100:103], v13, s[4:7], s28 offen sc1
    s_add_u32 s28, s96, 11264
    buffer_load_dwordx4 v[104:107], v13, s[4:7], s28 offen sc1
    s_add_u32 s28, s96, 12288
    buffer_load_dwordx4 v[108:111], v13, s[4:7], s28 offen sc1
    s_add_u32 s28, s96, 13312
    buffer_load_dwordx4 v[112:115], v13, s[4:7], s28 offen sc1
    s_mov_b32 s69, 536870912
    buffer_store_dword v2, off, s[20:23], s69
    buffer_store_dword v2, off, s[20:23], s69
    buffer_store_dword v2, off, s[20:23], s69
LO_top:
    buffer_load_dword v2, v14, s[4:7], 0 offen sc1
    buffer_load_dword v3, v15, s[4:7], 0 offen sc1
    s_mov_b32 s64, s97
    s_add_u32 s65, s26, 2
    s_bfe_u32 s29, s65, 0x10001
    s_lshl_b32 s29, s29, 13
    s_lshl_b32 s65, s65, 20
    s_sub_u32 s65, s65, s34
    s_add_u32 s65, s65, s33
    s_xor_b32 s29, s29, s34
    s_add_u32 s65, s65, s29
    s_mul_i32 s28, s71, 81920
    s_add_u32 s65, s65, s28
    s_lshl_b32 s28, s24, 11
    s_add_u32 s65, s65, s28
    s_lshl_b32 s67, s26, 16
    s_lshl_b32 s28, s24, 14
    s_add_u32 s67, s67, s28
    s_add_u32 s67, s67, 144703488
    s_lshl_b32 s68, s26, 14
    s_lshl_b32 s28, s24, 12
    s_add_u32 s68, s68, s28
    s_add_u32 s68, s68, 148897792
    s_mul_i32 s69, s26, 40960
    s_and_b32 s28, s24, 1
    s_mul_i32 s29, s28, 20480
    s_add_u32 s69, s69, s29
    s_add_u32 s70, s69, 128
    s_lshr_b32 s29, s24, 1
    s_lshl_b32 s29, s29, 5
    s_add_u32 s69, s69, s29
    s_add_u32 s66, s26, 1
    s_waitcnt vmcnt(37)
    v_swap_b32 v62, v64
    v_swap_b32 v63, v65
    s_nop 1
    v_mfma_f32_16x16x32_bf16 v[20:23], a[0:3], v[60:63], 0
    s_add_u32 s28, s64, 0
    buffer_load_dwordx4 v[116:119], v13, s[4:7], s28 offen sc1
    v_mfma_f32_16x16x32_bf16 v[24:27], a[0:3], v[64:67], 0
    v_mfma_f32_16x16x32_bf16 v[28:31], a[4:7], v[60:63], 0
    s_add_u32 s28, s64, 32768
    buffer_load_dwordx4 v[120:123], v13, s[4:7], s28 offen sc1
    v_mfma_f32_16x16x32_bf16 v[32:35], a[4:7], v[64:67], 0
    v_mfma_f32_16x16x32_bf16 v[36:39], a[8:11], v[60:63], 0
    s_add_u32 s28, s64, 65536
    buffer_load_dwordx4 v[124:127], v13, s[4:7], s28 offen sc1
    v_mfma_f32_16x16x32_bf16 v[40:43], a[8:11], v[64:67], 0
    v_mfma_f32_16x16x32_bf16 v[44:47], a[12:15], v[60:63], 0
    s_add_u32 s28, s64, 98304
    buffer_load_dwordx4 v[128:131], v13, s[4:7], s28 offen sc1
    v_mfma_f32_16x16x32_bf16 v[48:51], a[12:15], v[64:67], 0
    v_mfma_f32_16x16x32_bf16 v[52:55], a[16:19], v[60:63], 0
    s_add_u32 s28, s64, 131072
    buffer_load_dwordx4 v[132:135], v13, s[4:7], s28 offen sc1
    v_mfma_f32_16x16x32_bf16 v[56:59], a[16:19], v[64:67], 0
    s_waitcnt vmcnt(40)
    v_swap_b32 v70, v72
    v_swap_b32 v71, v73
    s_nop 1
    v_mfma_f32_16x16x32_bf16 v[20:23], a[20:23], v[68:71], v[20:23]
    s_add_u32 s28, s96, 14336
    buffer_load_dwordx4 v[60:63], v13, s[4:7], s28 offen sc1
    v_mfma_f32_16x16x32_bf16 v[24:27], a[20:23], v[72:75], v[24:27]
    v_mfma_f32_16x16x32_bf16 v[28:31], a[24:27], v[68:71], v[28:31]
    s_add_u32 s28, s96, 15360
    buffer_load_dwordx4 v[64:67], v13, s[4:7], s28 offen sc1
    v_mfma_f32_16x16x32_bf16 v[32:35], a[24:27], v[72:75], v[32:35]
    v_mfma_f32_16x16x32_bf16 v[36:39], a[28:31], v[68:71], v[36:39]
    s_add_u32 s28, s64, 1024
    buffer_load_dwordx4 v[136:139], v13, s[4:7], s28 offen sc1
    v_mfma_f32_16x16x32_bf16 v[40:43], a[28:31], v[72:75], v[40:43]
    v_mfma_f32_16x16x32_bf16 v[44:47], a[32:35], v[68:71], v[44:47]
    s_add_u32 s28, s64, 33792
    buffer_load_dwordx4 v[140:143], v13, s[4:7], s28 offen sc1
    v_mfma_f32_16x16x32_bf16 v[48:51], a[32:35], v[72:75], v[48:51]
    v_mfma_f32_16x16x32_bf16 v[52:55], a[36:39], v[68:71], v[52:55]
    s_add_u32 s28, s64, 66560
    buffer_load_dwordx4 v[144:147], v13, s[4:7], s28 offen sc1
    v_mfma_f32_16x16x32_bf16 v[56:59], a[36:39], v[72:75], v[56:59]
    s_waitcnt vmcnt(38)
    v_swap_b32 v78, v80
    v_swap_b32 v79, v81
    s_nop 1
    v_mfma_f32_16x16x32_bf16 v[20:23], a[40:43], v[76:79], v[20:23]
    s_add_u32 s28, s64, 99328
    buffer_load_dwordx4 v[148:151], v13, s[4:7], s28 offen sc1
    v_mfma_f32_16x16x32_bf16 v[24:27], a[40:43], v[80:83], v[24:27]
    v_mfma_f32_16x16x32_bf16 v[28:31], a[44:47], v[76:79], v[28:31]
    s_add_u32 s28, s64, 132096
    buffer_load_dwordx4 v[152:155], v13, s[4:7], s28 offen sc1
    v_mfma_f32_16x16x32_bf16 v[32:35], a[44:47], v[80:83], v[32:35]
    v_mfma_f32_16x16x32_bf16 v[36:39], a[48:51], v[76:79], v[36:39]
    s_add_u32 s28, s96, 16384
    buffer_load_dwordx4 v[68:71], v13, s[4:7], s28 offen sc1
    v_mfma_f32_16x16x32_bf16 v[40:43], a[48:51], v[80:83], v[40:43]
    v_mfma_f32_16x16x32_bf16 v[44:47], a[52:55], v[76:79], v[44:47]
    s_add_u32 s28, s96, 17408
    buffer_load_dwordx4 v[72:75], v13, s[4:7], s28 offen sc1
    v_mfma_f32_16x16x32_bf16 v[48:51], a[52:55], v[80:83], v[48:51]
    v_mfma_f32_16x16x32_bf16 v[52:55], a[56:59], v[76:79], v[52:55]
    v_mfma_f32_16x16x32_bf16 v[56:59], a[56:59], v[80:83], v[56:59]
    s_waitcnt vmcnt(35)
    v_swap_b32 v86, v88
    v_swap_b32 v87, v89
    s_nop 1
    v_mfma_f32_16x16x32_bf16 v[20:23], a[60:63], v[84:87], v[20:23]
    s_add_u32 s28, s96, 18432
    buffer_load_dwordx4 v[76:79], v13, s[4:7], s28 offen sc1
    v_mfma_f32_16x16x32_bf16 v[24:27], a[60:63], v[88:91], v[24:27]
    v_mfma_f32_16x16x32_bf16 v[28:31], a[64:67], v[84:87], v[28:31]
    s_add_u32 s28, s96, 19456
    buffer_load_dwordx4 v[80:83], v13, s[4:7], s28 offen sc1
    v_mfma_f32_16x16x32_bf16 v[32:35], a[64:67], v[88:91], v[32:35]
    v_mfma_f32_16x16x32_bf16 v[36:39], a[68:71], v[84:87], v[36:39]
    s_add_u32 s28, s64, 2048
    buffer_load_dwordx4 v[156:159], v13, s[4:7], s28 offen sc1
    v_mfma_f32_16x16x32_bf16 v[40:43], a[68:71], v[88:91], v[40:43]
    v_mfma_f32_16x16x32_bf16 v[44:47], a[72:75], v[84:87], v[44:47]
    s_add_u32 s28, s64, 34816
    buffer_load_dwordx4 v[160:163], v13, s[4:7], s28 offen sc1
    v_mfma_f32_16x16x32_bf16 v[48:51], a[72:75], v[88:91], v[48:51]
    v_mfma_f32_16x16x32_bf16 v[52:55], a[76:79], v[84:87], v[52:55]
    s_add_u32 s28, s64, 67584
    buffer_load_dwordx4 v[164:167], v13, s[4:7], s28 offen sc1
    v_mfma_f32_16x16x32_bf16 v[56:59], a[76:79], v[88:91], v[56:59]
    s_waitcnt vmcnt(33)
    v_swap_b32 v94, v96
    v_swap_b32 v95, v97
    s_nop 1
    v_mfma_f32_16x16x32_bf16 v[20:23], a[80:83], v[92:95], v[20:23]
    s_add_u32 s28, s64, 100352
    buffer_load_dwordx4 v[168:171], v13, s[4:7], s28 offen sc1
    v_mfma_f32_16x16x32_bf16 v[24:27], a[80:83], v[96:99], v[24:27]
    v_mfma_f32_16x16x32_bf16 v[28:31], a[84:87], v[92:95], v[28:31]
    s_add_u32 s28, s64, 133120
    buffer_load_dwordx4 v[172:175], v13, s[4:7], s28 offen sc1
    v_mfma_f32_16x16x32_bf16 v[32:35], a[84:87], v[96:99], v[32:35]
    v_mfma_f32_16x16x32_bf16 v[36:39], a[88:91], v[92:95], v[36:39]
    s_add_u32 s28, s96, 20480
    buffer_load_dwordx4 v[84:87], v13, s[4:7], s28 offen sc1
    v_mfma_f32_16x16x32_bf16 v[40:43], a[88:91], v[96:99], v[40:43]
    v_mfma_f32_16x16x32_bf16 v[44:47], a[92:95], v[92:95], v[44:47]
    s_add_u32 s28, s96, 21504
    buffer_load_dwordx4 v[88:91], v13, s[4:7], s28 offen sc1
    v_mfma_f32_16x16x32_bf16 v[48:51], a[92:95], v[96:99], v[48:51]
    v_mfma_f32_16x16x32_bf16 v[52:55], a[96:99], v[92:95], v[52:55]
    v_mfma_f32_16x16x32_bf16 v[56:59], a[96:99], v[96:99], v[56:59]
    s_waitcnt vmcnt(30)
    v_swap_b32 v102, v104
    v_swap_b32 v103, v105
    s_nop 1
    v_mfma_f32_16x16x32_bf16 v[20:23], a[100:103], v[100:103], v[20:23]
    s_add_u32 s28, s96, 22528
    buffer_load_dwordx4 v[92:95], v13, s[4:7], s28 offen sc1
    v_mfma_f32_16x16x32_bf16 v[24:27], a[100:103], v[104:107], v[24:27]
    v_mfma_f32_16x16x32_bf16 v[28:31], a[104:107], v[100:103], v[28:31]
    s_add_u32 s28, s96, 23552
    buffer_load_dwordx4 v[96:99], v13, s[4:7], s28 offen sc1
    v_mfma_f32_16x16x32_bf16 v[32:35], a[104:107], v[104:107], v[32:35]
    v_mfma_f32_16x16x32_bf16 v[36:39], a[108:111], v[100:103], v[36:39]
    v_mfma_f32_16x16x32_bf16 v[40:43], a[108:111], v[104:107], v[40:43]
    v_mfma_f32_16x16x32_bf16 v[44:47], a[112:115], v[100:103], v[44:47]
    v_mfma_f32_16x16x32_bf16 v[48:51], a[112:115], v[104:107], v[48:51]
    v_mfma_f32_16x16x32_bf16 v[52:55], a[116:119], v[100:103], v[52:55]
    v_mfma_f32_16x16x32_bf16 v[56:59], a[116:119], v[104:107], v[56:59]
    s_waitcnt vmcnt(25)
    v_cmp_gt_u32 vcc, s66, v3
    s_nop 0
    s_cmp_eq_u64 vcc, 0
    s_cselect_b32 s98, s67, 536870912
    s_cselect_b32 s99, s68, 536870912
    s_waitcnt vmcnt(30)
    v_swap_b32 v110, v112
    v_swap_b32 v111, v113
    s_nop 1
    v_mfma_f32_16x16x32_bf16 v[20:23], a[120:123], v[108:111], v[20:23]
    s_add_u32 s28, s99, 0
    buffer_load_dwordx4 a[240:243], v13, s[4:7], s28 offen sc1
    v_mfma_f32_16x16x32_bf16 v[24:27], a[120:123], v[112:115], v[24:27]
    v_mfma_f32_16x16x32_bf16 v[28:31], a[124:127], v[108:111], v[28:31]
    s_add_u32 s28, s99, 1024
    buffer_load_dwordx4 a[244:247], v13, s[4:7], s28 offen sc1
    v_mfma_f32_16x16x32_bf16 v[32:35], a[124:127], v[112:115], v[32:35]
    v_mfma_f32_16x16x32_bf16 v[36:39], a[128:131], v[108:111], v[36:39]
    s_add_u32 s28, s99, 2048
    buffer_load_dwordx4 a[248:251], v13, s[4:7], s28 offen sc1
    v_mfma_f32_16x16x32_bf16 v[40:43], a[128:131], v[112:115], v[40:43]
    v_mfma_f32_16x16x32_bf16 v[44:47], a[132:135], v[108:111], v[44:47]
    s_add_u32 s28, s99, 3072
    buffer_load_dwordx4 a[252:255], v13, s[4:7], s28 offen sc1
    v_mfma_f32_16x16x32_bf16 v[48:51], a[132:135], v[112:115], v[48:51]
    v_mfma_f32_16x16x32_bf16 v[52:55], a[136:139], v[108:111], v[52:55]
    s_add_u32 s28, s98, 0
    buffer_load_dwordx4 v[100:103], v13, s[4:7], s28 offen sc1
    v_mfma_f32_16x16x32_bf16 v[56:59], a[136:139], v[112:115], v[56:59]
    s_waitcnt vmcnt(23)
    v_swap_b32 v62, v64
    v_swap_b32 v63, v65
    s_nop 1
    v_mfma_f32_16x16x32_bf16 v[20:23], a[140:143], v[60:63], v[20:23]
    s_add_u32 s28, s98, 1024
    buffer_load_dwordx4 v[104:107], v13, s[4:7], s28 offen sc1
    v_mfma_f32_16x16x32_bf16 v[24:27], a[140:143], v[64:67], v[24:27]
    v_mfma_f32_16x16x32_bf16 v[28:31], a[144:147], v[60:63], v[28:31]
    s_add_u32 s28, s98, 2048
    buffer_load_dwordx4 v[108:111], v13, s[4:7], s28 offen sc1
    v_mfma_f32_16x16x32_bf16 v[32:35], a[144:147], v[64:67], v[32:35]
    v_mfma_f32_16x16x32_bf16 v[36:39], a[148:151], v[60:63], v[36:39]
    s_add_u32 s28, s98, 3072
    buffer_load_dwordx4 v[112:115], v13, s[4:7], s28 offen sc1
    v_mfma_f32_16x16x32_bf16 v[40:43], a[148:151], v[64:67], v[40:43]
    v_mfma_f32_16x16x32_bf16 v[44:47], a[152:155], v[60:63], v[44:47]
    v_mfma_f32_16x16x32_bf16 v[48:51], a[152:155], v[64:67], v[48:51]
    v_mfma_f32_16x16x32_bf16 v[52:55], a[156:159], v[60:63], v[52:55]
    v_mfma_f32_16x16x32_bf16 v[56:59], a[156:159], v[64:67], v[56:59]
    s_waitcnt vmcnt(19)
    v_swap_b32 v70, v72
    v_swap_b32 v71, v73
    s_nop 1
    v_mfma_f32_16x16x32_bf16 v[20:23], a[160:163], v[68:71], v[20:23]
    s_add_u32 s28, s98, 4096
    buffer_load_dwordx4 v[60:63], v13, s[4:7], s28 offen sc1
    v_mfma_f32_16x16x32_bf16 v[24:27], a[160:163], v[72:75], v[24:27]
    v_mfma_f32_16x16x32_bf16 v[28:31], a[164:167], v[68:71], v[28:31]
    s_add_u32 s28, s98, 5120
    buffer_load_dwordx4 v[64:67], v13, s[4:7], s28 offen sc1
    v_mfma_f32_16x16x32_bf16 v[32:35], a[164:167], v[72:75], v[32:35]
    v_mfma_f32_16x16x32_bf16 v[36:39], a[168:171], v[68:71], v[36:39]
    v_mfma_f32_16x16x32_bf16 v[40:43], a[168:171], v[72:75], v[40:43]
    v_mfma_f32_16x16x32_bf16 v[44:47], a[172:175], v[68:71], v[44:47]
    v_mfma_f32_16x16x32_bf16 v[48:51], a[172:175], v[72:75], v[48:51]
    v_mfma_f32_16x16x32_bf16 v[52:55], a[176:179], v[68:71], v[52:55]
    v_mfma_f32_16x16x32_bf16 v[56:59], a[176:179], v[72:75], v[56:59]
    s_waitcnt vmcnt(19)
    v_swap_b32 v78, v80
    v_swap_b32 v79, v81
    s_nop 1
    v_mfma_f32_16x16x32_bf16 v[20:23], a[180:183], v[76:79], v[20:23]
    s_add_u32 s28, s98, 6144
    buffer_load_dwordx4 v[68:71], v13, s[4:7], s28 offen sc1
    v_mfma_f32_16x16x32_bf16 v[24:27], a[180:183], v[80:83], v[24:27]
    v_mfma_f32_16x16x32_bf16 v[28:31], a[184:187], v[76:79], v[28:31]
    s_add_u32 s28, s98, 7168
    buffer_load_dwordx4 v[72:75], v13, s[4:7], s28 offen sc1
    v_mfma_f32_16x16x32_bf16 v[32:35], a[184:187], v[80:83], v[32:35]
    v_mfma_f32_16x16x32_bf16 v[36:39], a[188:191], v[76:79], v[36:39]
    v_mfma_f32_16x16x32_bf16 v[40:43], a[188:191], v[80:83], v[40:43]
    v_mfma_f32_16x16x32_bf16 v[44:47], a[192:195], v[76:79], v[44:47]
    v_mfma_f32_16x16x32_bf16 v[48:51], a[192:195], v[80:83], v[48:51]
    v_mfma_f32_16x16x32_bf16 v[52:55], a[196:199], v[76:79], v[52:55]
    v_mfma_f32_16x16x32_bf16 v[56:59], a[196:199], v[80:83], v[56:59]
    s_waitcnt vmcnt(14)
    v_swap_b32 v86, v88
    v_swap_b32 v87, v89
    s_nop 1
    v_mfma_f32_16x16x32_bf16 v[20:23], a[200:203], v[84:87], v[20:23]
    s_add_u32 s28, s98, 8192
    buffer_load_dwordx4 v[76:79], v13, s[4:7], s28 offen sc1
    v_mfma_f32_16x16x32_bf16 v[24:27], a[200:203], v[88:91], v[24:27]
    v_mfma_f32_16x16x32_bf16 v[28:31], a[204:207], v[84:87], v[28:31]
    s_add_u32 s28, s98, 9216
    buffer_load_dwordx4 v[80:83], v13, s[4:7], s28 offen sc1
    v_mfma_f32_16x16x32_bf16 v[32:35], a[204:207], v[88:91], v[32:35]
    v_mfma_f32_16x16x32_bf16 v[36:39], a[208:211], v[84:87], v[36:39]
    v_mfma_f32_16x16x32_bf16 v[40:43], a[208:211], v[88:91], v[40:43]
    v_mfma_f32_16x16x32_bf16 v[44:47], a[212:215], v[84:87], v[44:47]
    v_mfma_f32_16x16x32_bf16 v[48:51], a[212:215], v[88:91], v[48:51]
    v_mfma_f32_16x16x32_bf16 v[52:55], a[216:219], v[84:87], v[52:55]
    v_mfma_f32_16x16x32_bf16 v[56:59], a[216:219], v[88:91], v[56:59]
    s_waitcnt vmcnt(14)
    v_swap_b32 v94, v96
    v_swap_b32 v95, v97
    s_nop 1
    v_mfma_f32_16x16x32_bf16 v[20:23], a[220:223], v[92:95], v[20:23]
    s_add_u32 s28, s98, 10240
    buffer_load_dwordx4 v[84:87], v13, s[4:7], s28 offen sc1
    v_mfma_f32_16x16x32_bf16 v[24:27], a[220:223], v[96:99], v[24:27]
    v_mfma_f32_16x16x32_bf16 v[28:31], a[224:227], v[92:95], v[28:31]
    s_add_u32 s28, s98, 11264
    buffer_load_dwordx4 v[88:91], v13, s[4:7], s28 offen sc1
    v_mfma_f32_16x16x32_bf16 v[32:35], a[224:227], v[96:99], v[32:35]
    v_mfma_f32_16x16x32_bf16 v[36:39], a[228:231], v[92:95], v[36:39]
    v_mfma_f32_16x16x32_bf16 v[40:43], a[228:231], v[96:99], v[40:43]
    v_mfma_f32_16x16x32_bf16 v[44:47], a[232:235], v[92:95], v[44:47]
    v_mfma_f32_16x16x32_bf16 v[48:51], a[232:235], v[96:99], v[48:51]
    v_mfma_f32_16x16x32_bf16 v[52:55], a[236:239], v[92:95], v[52:55]
    v_mfma_f32_16x16x32_bf16 v[56:59], a[236:239], v[96:99], v[56:59]
    s_add_u32 s28, s98, 12288
    buffer_load_dwordx4 v[92:95], v13, s[4:7], s28 offen sc1
    s_add_u32 s28, s98, 13312
    buffer_load_dwordx4 v[96:99], v13, s[4:7], s28 offen sc1
    s_cmp_ge_u32 s26, 60
    s_cbranch_scc1 LO_last
    s_cmp_eq_u32 s98, s67
    s_cbranch_scc0 LO_poll
LO_go:
    s_add_u32 s30, s26, 4
    s_mul_i32 s96, s30, 98304
    s_mul_i32 s28, s24, 24576
    s_add_u32 s96, s96, s28
    s_add_u32 s96, s96, 54525952
    s_mul_i32 s97, s30, 1310720
    s_mul_i32 s28, s71, 163840
    s_add_u32 s97, s97, s28
    s_lshl_b32 s28, s24, 13
    s_add_u32 s97, s97, s28
    s_add_u32 s97, s97, 60817408
    s_add_u32 s30, s30, 1
    s_cmp_le_u32 s30, 64
    s_cselect_b32 s30, s30, -1
    v_cmp_gt_u32 vcc, s30, v2
    s_nop 0
    s_cmp_eq_u64 vcc, 0
    s_cselect_b32 s96, s96, 536870912
    s_cselect_b32 s97, s97, 536870912
    s_waitcnt vmcnt(12)
    v_mfma_f32_16x16x32_bf16 v[20:23], v[116:119], v[100:103], v[20:23]
    buffer_load_dwordx2 v[6:7], v17, s[12:15], s69 offen offset:0
    v_mfma_f32_16x16x32_bf16 v[24:27], v[116:119], v[104:107], v[24:27]
    v_mfma_f32_16x16x32_bf16 v[28:31], v[120:123], v[100:103], v[28:31]
    buffer_load_dwordx2 v[8:9], v17, s[12:15], s69 offen offset:64
    v_mfma_f32_16x16x32_bf16 v[32:35], v[120:123], v[104:107], v[32:35]
    v_mfma_f32_16x16x32_bf16 v[36:39], v[124:127], v[100:103], v[36:39]
    buffer_load_dwordx2 v[10:11], v17, s[12:15], s70 offen offset:0
    v_mfma_f32_16x16x32_bf16 v[40:43], v[124:127], v[104:107], v[40:43]
    v_mfma_f32_16x16x32_bf16 v[44:47], v[128:131], v[100:103], v[44:47]
    v_mfma_f32_16x16x32_bf16 v[48:51], v[128:131], v[104:107], v[48:51]
    v_mfma_f32_16x16x32_bf16 v[52:55], v[132:135], v[100:103], v[52:55]
    v_mfma_f32_16x16x32_bf16 v[56:59], v[132:135], v[104:107], v[56:59]
    s_waitcnt vmcnt(13)
    v_mfma_f32_16x16x32_bf16 v[20:23], v[136:139], v[108:111], v[20:23]
    s_add_u32 s28, s98, 14336
    buffer_load_dwordx4 v[100:103], v13, s[4:7], s28 offen sc1
    v_mfma_f32_16x16x32_bf16 v[24:27], v[136:139], v[112:115], v[24:27]
    v_mfma_f32_16x16x32_bf16 v[28:31], v[140:143], v[108:111], v[28:31]
    s_add_u32 s28, s98, 15360
    buffer_load_dwordx4 v[104:107], v13, s[4:7], s28 offen sc1
    v_mfma_f32_16x16x32_bf16 v[32:35], v[140:143], v[112:115], v[32:35]
    v_mfma_f32_16x16x32_bf16 v[36:39], v[144:147], v[108:111], v[36:39]
    s_add_u32 s28, s64, 7168
    buffer_load_dwordx4 v[116:119], v13, s[4:7], s28 offen sc1
    v_mfma_f32_16x16x32_bf16 v[40:43], v[144:147], v[112:115], v[40:43]
    v_mfma_f32_16x16x32_bf16 v[44:47], v[148:151], v[108:111], v[44:47]
    s_add_u32 s28, s64, 39936
    buffer_load_dwordx4 v[120:123], v13, s[4:7], s28 offen sc1
    v_mfma_f32_16x16x32_bf16 v[48:51], v[148:151], v[112:115], v[48:51]
    v_mfma_f32_16x16x32_bf16 v[52:55], v[152:155], v[108:111], v[52:55]
    s_add_u32 s28, s64, 72704
    buffer_load_dwordx4 v[124:127], v13, s[4:7], s28 offen sc1
    v_mfma_f32_16x16x32_bf16 v[56:59], v[152:155], v[112:115], v[56:59]
    s_waitcnt vmcnt(16)
    v_mfma_f32_16x16x32_bf16 v[20:23], v[156:159], v[60:63], v[20:23]
    s_add_u32 s28, s64, 105472
    buffer_load_dwordx4 v[128:131], v13, s[4:7], s28 offen sc1
    v_mfma_f32_16x16x32_bf16 v[24:27], v[156:159], v[64:67], v[24:27]
    v_mfma_f32_16x16x32_bf16 v[28:31], v[160:163], v[60:63], v[28:31]
    s_add_u32 s28, s64, 138240
    buffer_load_dwordx4 v[132:135], v13, s[4:7], s28 offen sc1
    v_mfma_f32_16x16x32_bf16 v[32:35], v[160:163], v[64:67], v[32:35]
    v_mfma_f32_16x16x32_bf16 v[36:39], v[164:167], v[60:63], v[36:39]
    s_add_u32 s28, s65, 0
    buffer_load_dwordx4 v[136:139], v13, s[4:7], s28 offen sc1
    v_mfma_f32_16x16x32_bf16 v[40:43], v[164:167], v[64:67], v[40:43]
    v_mfma_f32_16x16x32_bf16 v[44:47], v[168:171], v[60:63], v[44:47]
    s_add_u32 s28, s65, 16384
    buffer_load_dwordx4 v[140:143], v13, s[4:7], s28 offen sc1
    v_mfma_f32_16x16x32_bf16 v[48:51], v[168:171], v[64:67], v[48:51]
    v_mfma_f32_16x16x32_bf16 v[52:55], v[172:175], v[60:63], v[52:55]
    s_add_u32 s28, s65, 32768
    buffer_load_dwordx4 v[144:147], v13, s[4:7], s28 offen sc1
    v_mfma_f32_16x16x32_bf16 v[56:59], v[172:175], v[64:67], v[56:59]
    s_waitcnt vmcnt(19)
    v_mfma_f32_16x16x32_bf16 v[20:23], v[176:179], v[68:71], v[20:23]
    s_add_u32 s28, s65, 49152
    buffer_load_dwordx4 v[148:151], v13, s[4:7], s28 offen sc1
    v_mfma_f32_16x16x32_bf16 v[24:27], v[176:179], v[72:75], v[24:27]
    v_mfma_f32_16x16x32_bf16 v[28:31], v[180:183], v[68:71], v[28:31]
    s_add_u32 s28, s65, 65536
    buffer_load_dwordx4 v[152:155], v13, s[4:7], s28 offen sc1
    v_mfma_f32_16x16x32_bf16 v[32:35], v[180:183], v[72:75], v[32:35]
    v_mfma_f32_16x16x32_bf16 v[36:39], v[184:187], v[68:71], v[36:39]
    s_add_u32 s28, s65, 1024
    buffer_load_dwordx4 v[156:159], v13, s[4:7], s28 offen sc1
    v_mfma_f32_16x16x32_bf16 v[40:43], v[184:187], v[72:75], v[40:43]
    v_mfma_f32_16x16x32_bf16 v[44:47], v[188:191], v[68:71], v[44:47]
    s_add_u32 s28, s65, 17408
    buffer_load_dwordx4 v[160:163], v13, s[4:7], s28 offen sc1
    v_mfma_f32_16x16x32_bf16 v[48:51], v[188:191], v[72:75], v[48:51]
    v_mfma_f32_16x16x32_bf16 v[52:55], v[192:195], v[68:71], v[52:55]
    s_add_u32 s28, s65, 33792
    buffer_load_dwordx4 v[164:167], v13, s[4:7], s28 offen sc1
    v_mfma_f32_16x16x32_bf16 v[56:59], v[192:195], v[72:75], v[56:59]
    s_waitcnt vmcnt(22)
    v_mfma_f32_16x16x32_bf16 v[20:23], v[196:199], v[76:79], v[20:23]
    s_add_u32 s28, s65, 50176
    buffer_load_dwordx4 v[168:171], v13, s[4:7], s28 offen sc1
    v_mfma_f32_16x16x32_bf16 v[24:27], v[196:199], v[80:83], v[24:27]
    s_add_u32 s28, s65, 66560
    buffer_load_dwordx4 v[172:175], v13, s[4:7], s28 offen sc1
    v_mfma_f32_16x16x32_bf16 v[28:31], v[200:203], v[76:79], v[28:31]
    s_add_u32 s28, s96, 0
    buffer_load_dwordx4 v[60:63], v13, s[4:7], s28 offen sc1
    v_mfma_f32_16x16x32_bf16 v[32:35], v[200:203], v[80:83], v[32:35]
    v_mfma_f32_16x16x32_bf16 v[36:39], v[204:207], v[76:79], v[36:39]
    s_add_u32 s28, s96, 1024
    buffer_load_dwordx4 v[64:67], v13, s[4:7], s28 offen sc1
    v_mfma_f32_16x16x32_bf16 v[40:43], v[204:207], v[80:83], v[40:43]
    v_mfma_f32_16x16x32_bf16 v[44:47], v[208:211], v[76:79], v[44:47]
    s_add_u32 s28, s96, 2048
    buffer_load_dwordx4 v[68:71], v13, s[4:7], s28 offen sc1
    v_mfma_f32_16x16x32_bf16 v[48:51], v[208:211], v[80:83], v[48:51]
    v_mfma_f32_16x16x32_bf16 v[52:55], v[212:215], v[76:79], v[52:55]
    s_add_u32 s28, s96, 3072
    buffer_load_dwordx4 v[72:75], v13, s[4:7], s28 offen sc1
    v_mfma_f32_16x16x32_bf16 v[56:59], v[212:215], v[80:83], v[56:59]
    s_waitcnt vmcnt(26)
    v_mfma_f32_16x16x32_bf16 v[20:23], v[216:219], v[84:87], v[20:23]
    s_add_u32 s28, s97, 3072
    buffer_load_dwordx4 v[176:179], v13, s[4:7], s28 offen sc1
    v_mfma_f32_16x16x32_bf16 v[24:27], v[216:219], v[88:91], v[24:27]
    s_add_u32 s28, s97, 35840
    buffer_load_dwordx4 v[180:183], v13, s[4:7], s28 offen sc1
    v_mfma_f32_16x16x32_bf16 v[28:31], v[220:223], v[84:87], v[28:31]
    s_add_u32 s28, s97, 68608
    buffer_load_dwordx4 v[184:187], v13, s[4:7], s28 offen sc1
    v_mfma_f32_16x16x32_bf16 v[32:35], v[220:223], v[88:91], v[32:35]
    s_add_u32 s28, s97, 101376
    buffer_load_dwordx4 v[188:191], v13, s[4:7], s28 offen sc1
    v_mfma_f32_16x16x32_bf16 v[36:39], v[224:227], v[84:87], v[36:39]
    s_add_u32 s28, s97, 134144
    buffer_load_dwordx4 v[192:195], v13, s[4:7], s28 offen sc1
    v_mfma_f32_16x16x32_bf16 v[40:43], v[224:227], v[88:91], v[40:43]
    v_mfma_f32_16x16x32_bf16 v[44:47], v[228:231], v[84:87], v[44:47]
    s_add_u32 s28, s96, 4096
    buffer_load_dwordx4 v[76:79], v13, s[4:7], s28 offen sc1
    v_mfma_f32_16x16x32_bf16 v[48:51], v[228:231], v[88:91], v[48:51]
    v_mfma_f32_16x16x32_bf16 v[52:55], v[232:235], v[84:87], v[52:55]
    s_add_u32 s28, s96, 5120
    buffer_load_dwordx4 v[80:83], v13, s[4:7], s28 offen sc1
    v_mfma_f32_16x16x32_bf16 v[56:59], v[232:235], v[88:91], v[56:59]
    s_waitcnt vmcnt(31)
    v_mfma_f32_16x16x32_bf16 v[20:23], v[236:239], v[92:95], v[20:23]
    s_add_u32 s28, s97, 4096
    buffer_load_dwordx4 v[196:199], v13, s[4:7], s28 offen sc1
    v_mfma_f32_16x16x32_bf16 v[24:27], v[236:239], v[96:99], v[24:27]
    s_add_u32 s28, s97, 36864
    buffer_load_dwordx4 v[200:203], v13, s[4:7], s28 offen sc1
    v_mfma_f32_16x16x32_bf16 v[28:31], v[240:243], v[92:95], v[28:31]
    s_add_u32 s28, s97, 69632
    buffer_load_dwordx4 v[204:207], v13, s[4:7], s28 offen sc1
    v_mfma_f32_16x16x32_bf16 v[32:35], v[240:243], v[96:99], v[32:35]
    s_add_u32 s28, s97, 102400
    buffer_load_dwordx4 v[208:211], v13, s[4:7], s28 offen sc1
    v_mfma_f32_16x16x32_bf16 v[36:39], v[244:247], v[92:95], v[36:39]
    s_add_u32 s28, s97, 135168
    buffer_load_dwordx4 v[212:215], v13, s[4:7], s28 offen sc1
    v_mfma_f32_16x16x32_bf16 v[40:43], v[244:247], v[96:99], v[40:43]
    v_mfma_f32_16x16x32_bf16 v[44:47], v[248:251], v[92:95], v[44:47]
    s_add_u32 s28, s96, 6144
    buffer_load_dwordx4 v[84:87], v13, s[4:7], s28 offen sc1
    v_mfma_f32_16x16x32_bf16 v[48:51], v[248:251], v[96:99], v[48:51]
    v_mfma_f32_16x16x32_bf16 v[52:55], v[252:255], v[92:95], v[52:55]
    s_add_u32 s28, s96, 7168
    buffer_load_dwordx4 v[88:91], v13, s[4:7], s28 offen sc1
    v_mfma_f32_16x16x32_bf16 v[56:59], v[252:255], v[96:99], v[56:59]
    s_waitcnt vmcnt(28)
    v_mfma_f32_16x16x32_bf16 v[20:23], v[116:119], v[100:103], v[20:23]
    s_add_u32 s28, s97, 5120
    buffer_load_dwordx4 v[216:219], v13, s[4:7], s28 offen sc1
    v_mfma_f32_16x16x32_bf16 v[24:27], v[116:119], v[104:107], v[24:27]
    s_add_u32 s28, s97, 37888
    buffer_load_dwordx4 v[220:223], v13, s[4:7], s28 offen sc1
    v_mfma_f32_16x16x32_bf16 v[28:31], v[120:123], v[100:103], v[28:31]
    s_add_u32 s28, s97, 70656
    buffer_load_dwordx4 v[224:227], v13, s[4:7], s28 offen sc1
    v_mfma_f32_16x16x32_bf16 v[32:35], v[120:123], v[104:107], v[32:35]
    s_add_u32 s28, s97, 103424
    buffer_load_dwordx4 v[228:231], v13, s[4:7], s28 offen sc1
    v_mfma_f32_16x16x32_bf16 v[36:39], v[124:127], v[100:103], v[36:39]
    s_add_u32 s28, s97, 136192
    buffer_load_dwordx4 v[232:235], v13, s[4:7], s28 offen sc1
    v_mfma_f32_16x16x32_bf16 v[40:43], v[124:127], v[104:107], v[40:43]
    v_mfma_f32_16x16x32_bf16 v[44:47], v[128:131], v[100:103], v[44:47]
    s_add_u32 s28, s96, 8192
    buffer_load_dwordx4 v[92:95], v13, s[4:7], s28 offen sc1
    v_mfma_f32_16x16x32_bf16 v[48:51], v[128:131], v[104:107], v[48:51]
    v_mfma_f32_16x16x32_bf16 v[52:55], v[132:135], v[100:103], v[52:55]
    s_add_u32 s28, s96, 9216
    buffer_load_dwordx4 v[96:99], v13, s[4:7], s28 offen sc1
    v_mfma_f32_16x16x32_bf16 v[56:59], v[132:135], v[104:107], v[56:59]
    s_waitcnt vmcnt(30)
    s_mov_b32 s32, 0
LO_z_66:
    v_max3_u32 v12, v136, v138, v140
    v_max3_u32 v12, v12, v142, v144
    v_max3_u32 v12, v12, v146, v148
    v_max3_u32 v12, v12, v150, v152
    v_max_u32 v12, v12, v154
    v_cmp_eq_u32 vcc, -1, v12
    s_cbranch_vccnz Lretry_67
    v_mfma_f32_16x16x32_bf16 v[20:23], v[136:139], a[240:243], v[20:23]
    s_add_u32 s28, s97, 6144
    buffer_load_dwordx4 v[236:239], v13, s[4:7], s28 offen sc1
    v_mfma_f32_16x16x32_bf16 v[24:27], v[136:139], a[244:247], v[24:27]
    v_mfma_f32_16x16x32_bf16 v[28:31], v[140:143], a[240:243], v[28:31]
    s_add_u32 s28, s97, 38912
    buffer_load_dwordx4 v[240:243], v13, s[4:7], s28 offen sc1
    v_mfma_f32_16x16x32_bf16 v[32:35], v[140:143], a[244:247], v[32:35]
    v_mfma_f32_16x16x32_bf16 v[36:39], v[144:147], a[240:243], v[36:39]
    s_add_u32 s28, s97, 71680
    buffer_load_dwordx4 v[244:247], v13, s[4:7], s28 offen sc1
    v_mfma_f32_16x16x32_bf16 v[40:43], v[144:147], a[244:247], v[40:43]
    v_mfma_f32_16x16x32_bf16 v[44:47], v[148:151], a[240:243], v[44:47]
    s_add_u32 s28, s97, 104448
    buffer_load_dwordx4 v[248:251], v13, s[4:7], s28 offen sc1
    v_mfma_f32_16x16x32_bf16 v[48:51], v[148:151], a[244:247], v[48:51]
    v_mfma_f32_16x16x32_bf16 v[52:55], v[152:155], a[240:243], v[52:55]
    s_add_u32 s28, s97, 137216
    buffer_load_dwordx4 v[252:255], v13, s[4:7], s28 offen sc1
    v_mfma_f32_16x16x32_bf16 v[56:59], v[152:155], a[244:247], v[56:59]
    s_waitcnt vmcnt(30)
    s_mov_b32 s32, 0
LO_z_68:
    v_max3_u32 v12, v156, v158, v160
    v_max3_u32 v12, v12, v162, v164
    v_max3_u32 v12, v12, v166, v168
    v_max3_u32 v12, v12, v170, v172
    v_max_u32 v12, v12, v174
    v_cmp_eq_u32 vcc, -1, v12
    s_cbranch_vccnz Lretry_69
    v_mfma_f32_16x16x32_bf16 v[20:23], v[156:159], a[248:251], v[20:23]
    s_add_u32 s28, s96, 10240
    buffer_load_dwordx4 v[100:103], v13, s[4:7], s28 offen sc1
    v_mfma_f32_16x16x32_bf16 v[24:27], v[156:159], a[252:255], v[24:27]
    v_mfma_f32_16x16x32_bf16 v[28:31], v[160:163], a[248:251], v[28:31]
    s_add_u32 s28, s96, 11264
    buffer_load_dwordx4 v[104:107], v13, s[4:7], s28 offen sc1
    v_mfma_f32_16x16x32_bf16 v[32:35], v[160:163], a[252:255], v[32:35]
    v_mfma_f32_16x16x32_bf16 v[36:39], v[164:167], a[248:251], v[36:39]
    s_add_u32 s28, s96, 12288
    buffer_load_dwordx4 v[108:111], v13, s[4:7], s28 offen sc1
    v_mfma_f32_16x16x32_bf16 v[40:43], v[164:167], a[252:255], v[40:43]
    v_mfma_f32_16x16x32_bf16 v[44:47], v[168:171], a[248:251], v[44:47]
    s_add_u32 s28, s96, 13312
    buffer_load_dwordx4 v[112:115], v13, s[4:7], s28 offen sc1
    v_mfma_f32_16x16x32_bf16 v[48:51], v[168:171], a[252:255], v[48:51]
    v_mfma_f32_16x16x32_bf16 v[52:55], v[172:175], a[248:251], v[52:55]
    v_mfma_f32_16x16x32_bf16 v[56:59], v[172:175], a[252:255], v[56:59]
LO_red:
    s_barrier
    ds_write_b128 v16, v[20:23] offset:0
    ds_write_b128 v16, v[24:27] offset:1024
    ds_write_b128 v16, v[28:31] offset:2048
    ds_write_b128 v16, v[32:35] offset:3072
    ds_write_b128 v16, v[36:39] offset:4096
    ds_write_b128 v16, v[40:43] offset:5120
    ds_write_b128 v16, v[44:47] offset:6144
    ds_write_b128 v16, v[48:51] offset:7168
    ds_write_b128 v16, v[52:55] offset:8192
    ds_write_b128 v16, v[56:59] offset:9216
    s_waitcnt lgkmcnt(0)
    s_barrier
    ds_read_b128 v[116:119], v4 offset:0
    ds_read_b128 v[120:123], v4 offset:10240
    ds_read_b128 v[124:127], v4 offset:20480
    ds_read_b128 v[128:131], v4 offset:30720
    ds_read_b128 v[132:135], v4 offset:4096
    ds_read_b128 v[136:139], v4 offset:14336
    ds_read_b128 v[140:143], v4 offset:24576
    ds_read_b128 v[144:147], v4 offset:34816
    ds_read_b128 v[148:151], v5 offset:0
    ds_read_b128 v[152:155], v5 offset:10240
    ds_read_b128 v[156:159], v5 offset:20480
    ds_read_b128 v[160:163], v5 offset:30720
    s_waitcnt lgkmcnt(8)
    v_pk_add_f32 v[116:117], v[116:117], v[120:121]
    v_pk_add_f32 v[124:125], v[124:125], v[128:129]
    v_lshlrev_b32 v120, 16, v6
    v_and_b32 v121, 0xffff0000, v6
    v_pk_add_f32 v[116:117], v[116:117], v[124:125]
    v_pk_add_f32 v[116:117], v[116:117], v[120:121]
    v_cvt_pk_bf16_f32 v6, v116, v117
    v_pk_add_f32 v[118:119], v[118:119], v[122:123]
    v_pk_add_f32 v[126:127], v[126:127], v[130:131]
    v_lshlrev_b32 v120, 16, v7
    v_and_b32 v121, 0xffff0000, v7
    v_pk_add_f32 v[118:119], v[118:119], v[126:127]
    v_pk_add_f32 v[118:119], v[118:119], v[120:121]
    v_cvt_pk_bf16_f32 v7, v118, v119
    buffer_store_dwordx2 v[6:7], v17, s[20:23], s69 offen offset:0
    s_waitcnt lgkmcnt(4)
    v_pk_add_f32 v[132:133], v[132:133], v[136:137]
    v_pk_add_f32 v[140:141], v[140:141], v[144:145]
    v_lshlrev_b32 v136, 16, v8
    v_and_b32 v137, 0xffff0000, v8
    v_pk_add_f32 v[132:133], v[132:133], v[140:141]
    v_pk_add_f32 v[132:133], v[132:133], v[136:137]
    v_cvt_pk_bf16_f32 v8, v132, v133
    v_pk_add_f32 v[134:135], v[134:135], v[138:139]
    v_pk_add_f32 v[142:143], v[142:143], v[146:147]
    v_lshlrev_b32 v136, 16, v9
    v_and_b32 v137, 0xffff0000, v9
    v_pk_add_f32 v[134:135], v[134:135], v[142:143]
    v_pk_add_f32 v[134:135], v[134:135], v[136:137]
    v_cvt_pk_bf16_f32 v9, v134, v135
    buffer_store_dwordx2 v[8:9], v17, s[20:23], s69 offen offset:64
    s_waitcnt lgkmcnt(0)
    v_pk_add_f32 v[148:149], v[148:149], v[152:153]
    v_pk_add_f32 v[156:157], v[156:157], v[160:161]
    v_lshlrev_b32 v152, 16, v10
    v_and_b32 v153, 0xffff0000, v10
    v_pk_add_f32 v[148:149], v[148:149], v[156:157]
    v_pk_add_f32 v[148:149], v[148:149], v[152:153]
    v_cvt_pk_bf16_f32 v10, v148, v149
    v_pk_add_f32 v[150:151], v[150:151], v[154:155]
    v_pk_add_f32 v[158:159], v[158:159], v[162:163]
    v_lshlrev_b32 v152, 16, v11
    v_and_b32 v153, 0xffff0000, v11
    v_pk_add_f32 v[150:151], v[150:151], v[158:159]
    v_pk_add_f32 v[150:151], v[150:151], v[152:153]
    v_cvt_pk_bf16_f32 v11, v150, v151
    buffer_store_dwordx2 v[10:11], v17, s[20:23], s70 offen offset:0
    s_add_u32 s26, s26, 4
    s_cmp_ge_u32 s26, 64
    s_cbranch_scc1 LO_end
    s_cmp_lg_u32 s97, 536870912
    s_cbranch_scc1 LO_top
    s_branch LO_fill
LO_end:
    s_endpgm
LO_poll:
    s_mov_b32 s32, 0
    buffer_load_dword v3, v15, s[4:7], 0 offen sc1
    s_waitcnt vmcnt(0)
Lwf_70:
    v_cmp_gt_u32 vcc, s66, v3
    s_cbranch_vccnz Lretry_72
Lwfd_71:
    s_mov_b32 s98, s67
    s_mov_b32 s99, s68
    s_add_u32 s28, s99, 0
    buffer_load_dwordx4 a[240:243], v13, s[4:7], s28 offen sc1
    s_add_u32 s28, s99, 1024
    buffer_load_dwordx4 a[244:247], v13, s[4:7], s28 offen sc1
    s_add_u32 s28, s99, 2048
    buffer_load_dwordx4 a[248:251], v13, s[4:7], s28 offen sc1
    s_add_u32 s28, s99, 3072
    buffer_load_dwordx4 a[252:255], v13, s[4:7], s28 offen sc1
    s_add_u32 s28, s98, 0
    buffer_load_dwordx4 v[100:103], v13, s[4:7], s28 offen sc1
    s_add_u32 s28, s98, 1024
    buffer_load_dwordx4 v[104:107], v13, s[4:7], s28 offen sc1
    s_add_u32 s28, s98, 2048
    buffer_load_dwordx4 v[108:111], v13, s[4:7], s28 offen sc1
    s_add_u32 s28, s98, 3072
    buffer_load_dwordx4 v[112:115], v13, s[4:7], s28 offen sc1
    s_add_u32 s28, s98, 4096
    buffer_load_dwordx4 v[60:63], v13, s[4:7], s28 offen sc1
    s_add_u32 s28, s98, 5120
    buffer_load_dwordx4 v[64:67], v13, s[4:7], s28 offen sc1
    s_add_u32 s28, s98, 6144
    buffer_load_dwordx4 v[68:71], v13, s[4:7], s28 offen sc1
    s_add_u32 s28, s98, 7168
    buffer_load_dwordx4 v[72:75], v13, s[4:7], s28 offen sc1
    s_add_u32 s28, s98, 8192
    buffer_load_dwordx4 v[76:79], v13, s[4:7], s28 offen sc1
    s_add_u32 s28, s98, 9216
    buffer_load_dwordx4 v[80:83], v13, s[4:7], s28 offen sc1
    s_add_u32 s28, s98, 10240
    buffer_load_dwordx4 v[84:87], v13, s[4:7], s28 offen sc1
    s_add_u32 s28, s98, 11264
    buffer_load_dwordx4 v[88:91], v13, s[4:7], s28 offen sc1
    s_add_u32 s28, s98, 12288
    buffer_load_dwordx4 v[92:95], v13, s[4:7], s28 offen sc1
    s_add_u32 s28, s98, 13312
    buffer_load_dwordx4 v[96:99], v13, s[4:7], s28 offen sc1
    s_branch LO_go
LO_last:
    s_add_u32 s28, s64, 7168
    buffer_load_dwordx4 a[0:3], v13, s[4:7], s28 offen sc1
    s_add_u32 s28, s64, 39936
    buffer_load_dwordx4 a[4:7], v13, s[4:7], s28 offen sc1
    s_add_u32 s28, s64, 72704
    buffer_load_dwordx4 a[8:11], v13, s[4:7], s28 offen sc1
    s_add_u32 s28, s64, 105472
    buffer_load_dwordx4 a[12:15], v13, s[4:7], s28 offen sc1
    s_add_u32 s28, s64, 138240
    buffer_load_dwordx4 a[16:19], v13, s[4:7], s28 offen sc1
    buffer_load_dwordx2 v[6:7], v17, s[12:15], s69 offen offset:0
    buffer_load_dwordx2 v[8:9], v17, s[12:15], s69 offen offset:64
    buffer_load_dwordx2 v[10:11], v17, s[12:15], s70 offen offset:0
    s_mov_b32 s32, 0
LO_lz:
    s_add_u32 s28, s65, 0
    buffer_load_dwordx4 v[60:63], v13, s[4:7], s28 offen sc1
    s_add_u32 s28, s65, 16384
    buffer_load_dwordx4 v[64:67], v13, s[4:7], s28 offen sc1
    s_add_u32 s28, s65, 32768
    buffer_load_dwordx4 v[68:71], v13, s[4:7], s28 offen sc1
    s_add_u32 s28, s65, 49152
    buffer_load_dwordx4 v[72:75], v13, s[4:7], s28 offen sc1
    s_add_u32 s28, s65, 65536
    buffer_load_dwordx4 v[76:79], v13, s[4:7], s28 offen sc1
    s_add_u32 s28, s65, 1024
    buffer_load_dwordx4 v[80:83], v13, s[4:7], s28 offen sc1
    s_add_u32 s28, s65, 17408
    buffer_load_dwordx4 v[84:87], v13, s[4:7], s28 offen sc1
    s_add_u32 s28, s65, 33792
    buffer_load_dwordx4 v[88:91], v13, s[4:7], s28 offen sc1
    s_add_u32 s28, s65, 50176
    buffer_load_dwordx4 v[92:95], v13, s[4:7], s28 offen sc1
    s_add_u32 s28, s65, 66560
    buffer_load_dwordx4 v[96:99], v13, s[4:7], s28 offen sc1
    s_waitcnt vmcnt(0)
    v_max_u32 v12, v60, v62
    v_max3_u32 v12, v12, v64, v66
    v_max3_u32 v12, v12, v68, v70
    v_max3_u32 v12, v12, v72, v74
    v_max3_u32 v12, v12, v76, v78
    v_max3_u32 v12, v12, v80, v82
    v_max3_u32 v12, v12, v84, v86
    v_max3_u32 v12, v12, v88, v90
    v_max3_u32 v12, v12, v92, v94
    v_max3_u32 v12, v12, v96, v98
    v_cmp_eq_u32 vcc, -1, v12
    s_cbranch_vccnz Lretry_73
    s_mov_b32 s32, 0
    buffer_load_dword v3, v15, s[4:7], 0 offen sc1
    s_waitcnt vmcnt(0)
Lwf_74:
    v_cmp_gt_u32 vcc, s66, v3
    s_cbranch_vccnz Lretry_76
Lwfd_75:
    s_add_u32 s28, s67, 0
    buffer_load_dwordx4 a[32:35], v13, s[4:7], s28 offen sc1
    s_add_u32 s28, s67, 1024
    buffer_load_dwordx4 a[36:39], v13, s[4:7], s28 offen sc1
    s_add_u32 s28, s67, 2048
    buffer_load_dwordx4 a[40:43], v13, s[4:7], s28 offen sc1
    s_add_u32 s28, s67, 3072
    buffer_load_dwordx4 a[44:47], v13, s[4:7], s28 offen sc1
    s_add_u32 s28, s67, 4096
    buffer_load_dwordx4 a[48:51], v13, s[4:7], s28 offen sc1
    s_add_u32 s28, s67, 5120
    buffer_load_dwordx4 a[52:55], v13, s[4:7], s28 offen sc1
    s_add_u32 s28, s67, 6144
    buffer_load_dwordx4 a[56:59], v13, s[4:7], s28 offen sc1
    s_add_u32 s28, s67, 7168
    buffer_load_dwordx4 a[60:63], v13, s[4:7], s28 offen sc1
    s_add_u32 s28, s67, 8192
    buffer_load_dwordx4 a[64:67], v13, s[4:7], s28 offen sc1
    s_add_u32 s28, s67, 9216
    buffer_load_dwordx4 a[68:71], v13, s[4:7], s28 offen sc1
    s_add_u32 s28, s67, 10240
    buffer_load_dwordx4 a[72:75], v13, s[4:7], s28 offen sc1
    s_add_u32 s28, s67, 11264
    buffer_load_dwordx4 a[76:79], v13, s[4:7], s28 offen sc1
    s_add_u32 s28, s67, 12288
    buffer_load_dwordx4 a[80:83], v13, s[4:7], s28 offen sc1
    s_add_u32 s28, s67, 13312
    buffer_load_dwordx4 a[84:87], v13, s[4:7], s28 offen sc1
    s_add_u32 s28, s67, 14336
    buffer_load_dwordx4 a[88:91], v13, s[4:7], s28 offen sc1
    s_add_u32 s28, s67, 15360
    buffer_load_dwordx4 a[92:95], v13, s[4:7], s28 offen sc1
    s_add_u32 s28, s68, 0
    buffer_load_dwordx4 a[96:99], v13, s[4:7], s28 offen sc1
    s_add_u32 s28, s68, 1024
    buffer_load_dwordx4 a[100:103], v13, s[4:7], s28 offen sc1
    s_add_u32 s28, s68, 2048
    buffer_load_dwordx4 a[104:107], v13, s[4:7], s28 offen sc1
    s_add_u32 s28, s68, 3072
    buffer_load_dwordx4 a[108:111], v13, s[4:7], s28 offen sc1
    s_waitcnt vmcnt(18)
    v_mfma_f32_16x16x32_bf16 v[20:23], v[116:119], a[32:35], v[20:23]
    v_mfma_f32_16x16x32_bf16 v[24:27], v[116:119], a[36:39], v[24:27]
    v_mfma_f32_16x16x32_bf16 v[28:31], v[120:123], a[32:35], v[28:31]
    v_mfma_f32_16x16x32_bf16 v[32:35], v[120:123], a[36:39], v[32:35]
    v_mfma_f32_16x16x32_bf16 v[36:39], v[124:127], a[32:35], v[36:39]
    v_mfma_f32_16x16x32_bf16 v[40:43], v[124:127], a[36:39], v[40:43]
    v_mfma_f32_16x16x32_bf16 v[44:47], v[128:131], a[32:35], v[44:47]
    v_mfma_f32_16x16x32_bf16 v[48:51], v[128:131], a[36:39], v[48:51]
    v_mfma_f32_16x16x32_bf16 v[52:55], v[132:135], a[32:35], v[52:55]
    v_mfma_f32_16x16x32_bf16 v[56:59], v[132:135], a[36:39], v[56:59]
    s_waitcnt vmcnt(16)
    v_mfma_f32_16x16x32_bf16 v[20:23], v[136:139], a[40:43], v[20:23]
    v_mfma_f32_16x16x32_bf16 v[24:27], v[136:139], a[44:47], v[24:27]
    v_mfma_f32_16x16x32_bf16 v[28:31], v[140:143], a[40:43], v[28:31]
    v_mfma_f32_16x16x32_bf16 v[32:35], v[140:143], a[44:47], v[32:35]
    v_mfma_f32_16x16x32_bf16 v[36:39], v[144:147], a[40:43], v[36:39]
    v_mfma_f32_16x16x32_bf16 v[40:43], v[144:147], a[44:47], v[40:43]
    v_mfma_f32_16x16x32_bf16 v[44:47], v[148:151], a[40:43], v[44:47]
    v_mfma_f32_16x16x32_bf16 v[48:51], v[148:151], a[44:47], v[48:51]
    v_mfma_f32_16x16x32_bf16 v[52:55], v[152:155], a[40:43], v[52:55]
    v_mfma_f32_16x16x32_bf16 v[56:59], v[152:155], a[44:47], v[56:59]
    s_waitcnt vmcnt(14)
    v_mfma_f32_16x16x32_bf16 v[20:23], v[156:159], a[48:51], v[20:23]
    v_mfma_f32_16x16x32_bf16 v[24:27], v[156:159], a[52:55], v[24:27]
    v_mfma_f32_16x16x32_bf16 v[28:31], v[160:163], a[48:51], v[28:31]
    v_mfma_f32_16x16x32_bf16 v[32:35], v[160:163], a[52:55], v[32:35]
    v_mfma_f32_16x16x32_bf16 v[36:39], v[164:167], a[48:51], v[36:39]
    v_mfma_f32_16x16x32_bf16 v[40:43], v[164:167], a[52:55], v[40:43]
    v_mfma_f32_16x16x32_bf16 v[44:47], v[168:171], a[48:51], v[44:47]
    v_mfma_f32_16x16x32_bf16 v[48:51], v[168:171], a[52:55], v[48:51]
    v_mfma_f32_16x16x32_bf16 v[52:55], v[172:175], a[48:51], v[52:55]
    v_mfma_f32_16x16x32_bf16 v[56:59], v[172:175], a[52:55], v[56:59]
    s_waitcnt vmcnt(12)
    v_mfma_f32_16x16x32_bf16 v[20:23], v[176:179], a[56:59], v[20:23]
    v_mfma_f32_16x16x32_bf16 v[24:27], v[176:179], a[60:63], v[24:27]
    v_mfma_f32_16x16x32_bf16 v[28:31], v[180:183], a[56:59], v[28:31]
    v_mfma_f32_16x16x32_bf16 v[32:35], v[180:183], a[60:63], v[32:35]
    v_mfma_f32_16x16x32_bf16 v[36:39], v[184:187], a[56:59], v[36:39]
    v_mfma_f32_16x16x32_bf16 v[40:43], v[184:187], a[60:63], v[40:43]
    v_mfma_f32_16x16x32_bf16 v[44:47], v[188:191], a[56:59], v[44:47]
    v_mfma_f32_16x16x32_bf16 v[48:51], v[188:191], a[60:63], v[48:51]
    v_mfma_f32_16x16x32_bf16 v[52:55], v[192:195], a[56:59], v[52:55]
    v_mfma_f32_16x16x32_bf16 v[56:59], v[192:195], a[60:63], v[56:59]
    s_waitcnt vmcnt(10)
    v_mfma_f32_16x16x32_bf16 v[20:23], v[196:199], a[64:67], v[20:23]
    v_mfma_f32_16x16x32_bf16 v[24:27], v[196:199], a[68:71], v[24:27]
    v_mfma_f32_16x16x32_bf16 v[28:31], v[200:203], a[64:67], v[28:31]
    v_mfma_f32_16x16x32_bf16 v[32:35], v[200:203], a[68:71], v[32:35]
    v_mfma_f32_16x16x32_bf16 v[36:39], v[204:207], a[64:67], v[36:39]
    v_mfma_f32_16x16x32_bf16 v[40:43], v[204:207], a[68:71], v[40:43]
    v_mfma_f32_16x16x32_bf16 v[44:47], v[208:211], a[64:67], v[44:47]
    v_mfma_f32_16x16x32_bf16 v[48:51], v[208:211], a[68:71], v[48:51]
    v_mfma_f32_16x16x32_bf16 v[52:55], v[212:215], a[64:67], v[52:55]
    v_mfma_f32_16x16x32_bf16 v[56:59], v[212:215], a[68:71], v[56:59]
    s_waitcnt vmcnt(8)
    v_mfma_f32_16x16x32_bf16 v[20:23], v[216:219], a[72:75], v[20:23]
    v_mfma_f32_16x16x32_bf16 v[24:27], v[216:219], a[76:79], v[24:27]
    v_mfma_f32_16x16x32_bf16 v[28:31], v[220:223], a[72:75], v[28:31]
    v_mfma_f32_16x16x32_bf16 v[32:35], v[220:223], a[76:79], v[32:35]
    v_mfma_f32_16x16x32_bf16 v[36:39], v[224:227], a[72:75], v[36:39]
    v_mfma_f32_16x16x32_bf16 v[40:43], v[224:227], a[76:79], v[40:43]
    v_mfma_f32_16x16x32_bf16 v[44:47], v[228:231], a[72:75], v[44:47]
    v_mfma_f32_16x16x32_bf16 v[48:51], v[228:231], a[76:79], v[48:51]
    v_mfma_f32_16x16x32_bf16 v[52:55], v[232:235], a[72:75], v[52:55]
    v_mfma_f32_16x16x32_bf16 v[56:59], v[232:235], a[76:79], v[56:59]
    s_waitcnt vmcnt(6)
    v_mfma_f32_16x16x32_bf16 v[20:23], v[236:239], a[80:83], v[20:23]
    v_mfma_f32_16x16x32_bf16 v[24:27], v[236:239], a[84:87], v[24:27]
    v_mfma_f32_16x16x32_bf16 v[28:31], v[240:243], a[80:83], v[28:31]
    v_mfma_f32_16x16x32_bf16 v[32:35], v[240:243], a[84:87], v[32:35]
    v_mfma_f32_16x16x32_bf16 v[36:39], v[244:247], a[80:83], v[36:39]
    v_mfma_f32_16x16x32_bf16 v[40:43], v[244:247], a[84:87], v[40:43]
    v_mfma_f32_16x16x32_bf16 v[44:47], v[248:251], a[80:83], v[44:47]
    v_mfma_f32_16x16x32_bf16 v[48:51], v[248:251], a[84:87], v[48:51]
    v_mfma_f32_16x16x32_bf16 v[52:55], v[252:255], a[80:83], v[52:55]
    v_mfma_f32_16x16x32_bf16 v[56:59], v[252:255], a[84:87], v[56:59]
    s_waitcnt vmcnt(4)
    v_mfma_f32_16x16x32_bf16 v[20:23], a[0:3], a[88:91], v[20:23]
    v_mfma_f32_16x16x32_bf16 v[24:27], a[0:3], a[92:95], v[24:27]
    v_mfma_f32_16x16x32_bf16 v[28:31], a[4:7], a[88:91], v[28:31]
    v_mfma_f32_16x16x32_bf16 v[32:35], a[4:7], a[92:95], v[32:35]
    v_mfma_f32_16x16x32_bf16 v[36:39], a[8:11], a[88:91], v[36:39]
    v_mfma_f32_16x16x32_bf16 v[40:43], a[8:11], a[92:95], v[40:43]
    v_mfma_f32_16x16x32_bf16 v[44:47], a[12:15], a[88:91], v[44:47]
    v_mfma_f32_16x16x32_bf16 v[48:51], a[12:15], a[92:95], v[48:51]
    v_mfma_f32_16x16x32_bf16 v[52:55], a[16:19], a[88:91], v[52:55]
    v_mfma_f32_16x16x32_bf16 v[56:59], a[16:19], a[92:95], v[56:59]
    s_waitcnt vmcnt(2)
    v_mfma_f32_16x16x32_bf16 v[20:23], v[60:63], a[96:99], v[20:23]
    v_mfma_f32_16x16x32_bf16 v[24:27], v[60:63], a[100:103], v[24:27]
    v_mfma_f32_16x16x32_bf16 v[28:31], v[64:67], a[96:99], v[28:31]
    v_mfma_f32_16x16x32_bf16 v[32:35], v[64:67], a[100:103], v[32:35]
    v_mfma_f32_16x16x32_bf16 v[36:39], v[68:71], a[96:99], v[36:39]
    v_mfma_f32_16x16x32_bf16 v[40:43], v[68:71], a[100:103], v[40:43]
    v_mfma_f32_16x16x32_bf16 v[44:47], v[72:75], a[96:99], v[44:47]
    v_mfma_f32_16x16x32_bf16 v[48:51], v[72:75], a[100:103], v[48:51]
    v_mfma_f32_16x16x32_bf16 v[52:55], v[76:79], a[96:99], v[52:55]
    v_mfma_f32_16x16x32_bf16 v[56:59], v[76:79], a[100:103], v[56:59]
    s_waitcnt vmcnt(0)
    v_mfma_f32_16x16x32_bf16 v[20:23], v[80:83], a[104:107], v[20:23]
    v_mfma_f32_16x16x32_bf16 v[24:27], v[80:83], a[108:111], v[24:27]
    v_mfma_f32_16x16x32_bf16 v[28:31], v[84:87], a[104:107], v[28:31]
    v_mfma_f32_16x16x32_bf16 v[32:35], v[84:87], a[108:111], v[32:35]
    v_mfma_f32_16x16x32_bf16 v[36:39], v[88:91], a[104:107], v[36:39]
    v_mfma_f32_16x16x32_bf16 v[40:43], v[88:91], a[108:111], v[40:43]
    v_mfma_f32_16x16x32_bf16 v[44:47], v[92:95], a[104:107], v[44:47]
    v_mfma_f32_16x16x32_bf16 v[48:51], v[92:95], a[108:111], v[48:51]
    v_mfma_f32_16x16x32_bf16 v[52:55], v[96:99], a[104:107], v[52:55]
    v_mfma_f32_16x16x32_bf16 v[56:59], v[96:99], a[108:111], v[56:59]
    s_branch LO_red
Lretry_59:
    s_sleep 6
    buffer_load_dwordx2 v[200:201], off, s[16:19], 0 offset:128 sc1
    s_waitcnt vmcnt(0)
    s_add_u32 s32, s32, 1
    s_cmp_lt_u32 s32, 200000
    s_cbranch_scc1 Lws_58
    v_mov_b32 v2, 1
    v_mov_b32 v3, 4
    buffer_store_dword v2, v3, s[16:19], 0 offen sc1
    s_endpgm
Lretry_62:
    s_sleep 24
    buffer_load_dword v200, v201, s[4:7], 0 offen sc1
    s_waitcnt vmcnt(0)
    s_add_u32 s32, s32, 1
    s_cmp_lt_u32 s32, 200000
    s_cbranch_scc1 Lwf_60
    v_mov_b32 v2, 3
    v_mov_b32 v3, 4
    buffer_store_dword v2, v3, s[16:19], 0 offen sc1
    s_endpgm
Lretry_65:
    s_sleep 16
    buffer_load_dword v2, v14, s[4:7], 0 offen sc1
    s_waitcnt vmcnt(0)
    s_add_u32 s32, s32, 1
    s_cmp_lt_u32 s32, 200000
    s_cbranch_scc1 Lwf_63
    v_mov_b32 v2, 40
    v_mov_b32 v3, 4
    buffer_store_dword v2, v3, s[16:19], 0 offen sc1
    s_endpgm
Lretry_67:
    s_sleep 2
    s_add_u32 s28, s65, 0
    buffer_load_dwordx4 v[136:139], v13, s[4:7], s28 offen sc1
    s_add_u32 s28, s65, 16384
    buffer_load_dwordx4 v[140:143], v13, s[4:7], s28 offen sc1
    s_add_u32 s28, s65, 32768
    buffer_load_dwordx4 v[144:147], v13, s[4:7], s28 offen sc1
    s_add_u32 s28, s65, 49152
    buffer_load_dwordx4 v[148:151], v13, s[4:7], s28 offen sc1
    s_add_u32 s28, s65, 65536
    buffer_load_dwordx4 v[152:155], v13, s[4:7], s28 offen sc1
    s_waitcnt vmcnt(0)
    s_add_u32 s32, s32, 1
    s_cmp_lt_u32 s32, 200000
    s_cbranch_scc1 LO_z_66
    v_mov_b32 v2, 42
    v_mov_b32 v3, 4
    buffer_store_dword v2, v3, s[16:19], 0 offen sc1
    s_endpgm
Lretry_69:
    s_sleep 2
    s_add_u32 s28, s65, 1024
    buffer_load_dwordx4 v[156:159], v13, s[4:7], s28 offen sc1
    s_add_u32 s28, s65, 17408
    buffer_load_dwordx4 v[160:163], v13, s[4:7], s28 offen sc1
    s_add_u32 s28, s65, 33792
    buffer_load_dwordx4 v[164:167], v13, s[4:7], s28 offen sc1
    s_add_u32 s28, s65, 50176
    buffer_load_dwordx4 v[168:171], v13, s[4:7], s28 offen sc1
    s_add_u32 s28, s65, 66560
    buffer_load_dwordx4 v[172:175], v13, s[4:7], s28 offen sc1
    s_waitcnt vmcnt(0)
    s_add_u32 s32, s32, 1
    s_cmp_lt_u32 s32, 200000
    s_cbranch_scc1 LO_z_68
    v_mov_b32 v2, 42
    v_mov_b32 v3, 4
    buffer_store_dword v2, v3, s[16:19], 0 offen sc1
    s_endpgm
Lretry_72:
    s_sleep 16
    buffer_load_dword v3, v15, s[4:7], 0 offen sc1
    s_waitcnt vmcnt(0)
    s_add_u32 s32, s32, 1
    s_cmp_lt_u32 s32, 200000
    s_cbranch_scc1 Lwf_70
    v_mov_b32 v2, 41
    v_mov_b32 v3, 4
    buffer_store_dword v2, v3, s[16:19], 0 offen sc1
    s_endpgm
Lretry_73:
    s_sleep 10
    s_add_u32 s32, s32, 1
    s_cmp_lt_u32 s32, 200000
    s_cbranch_scc1 LO_lz
    v_mov_b32 v2, 44
    v_mov_b32 v3, 4
    buffer_store_dword v2, v3, s[16:19], 0 offen sc1
    s_endpgm
Lretry_76:
    s_sleep 1
    buffer_load_dword v3, v15, s[4:7], 0 offen sc1
    s_waitcnt vmcnt(0)
    s_add_u32 s32, s32, 1
    s_cmp_lt_u32 s32, 200000
    s_cbranch_scc1 Lwf_74
    v_mov_b32 v2, 45
    v_mov_b32 v3, 4
    buffer_store_dword v2, v3, s[16:19], 0 offen sc1
    s_endpgm
E_O:
.p2align 6
W_L:
R_L:
    s_waitcnt vmcnt(0)
    s_barrier
    s_cmp_lg_u32 s24, 0
    s_cbranch_scc1 Larr_77
    s_and_b32 s28, s2, 1
    s_lshl_b32 s28, s28, 6
    v_mov_b32 v2, 1
    s_mov_b64 exec, 1
    buffer_atomic_add v2, off, s[16:19], s28 sc1
    s_mov_b64 exec, -1
Larr_77:
    s_or_b32 s28, s25, s24
    s_cmp_lg_u32 s28, 0
    s_cbranch_scc1 Lcal_78
    s_add_u32 s28, s33, 393216
    v_mov_b32 v2, 0
    s_mov_b64 exec, 1
    s_mov_b32 s80, -1
    s_mov_b32 s81, -1
    s_mov_b32 s70, 0
Lcalp_79:
    s_add_u32 s29, s28, 0
    s_memtime s[76:77]
    s_waitcnt lgkmcnt(0)
    buffer_store_dword v2, off, s[4:7], s29 sc1
    s_waitcnt vmcnt(0)
    s_memtime s[78:79]
    s_waitcnt lgkmcnt(0)
    s_sub_u32 s78, s78, s76
    s_min_u32 s80, s80, s78
    s_add_u32 s29, s28, 8192
    s_memtime s[76:77]
    s_waitcnt lgkmcnt(0)
    buffer_store_dword v2, off, s[4:7], s29 sc1
    s_waitcnt vmcnt(0)
    s_memtime s[78:79]
    s_waitcnt lgkmcnt(0)
    s_sub_u32 s78, s78, s76
    s_min_u32 s81, s81, s78
    s_add_u32 s28, s28, 128
    s_add_u32 s70, s70, 1
    s_cmp_lt_u32 s70, 5
    s_cbranch_scc1 Lcalp_79
    s_cmp_lt_u32 s81, s80
    s_cselect_b32 s68, 8192, 0
    s_add_u32 s28, s28, s68
    s_mov_b32 s80, -1
    s_mov_b32 s81, -1
    s_mov_b32 s82, -1
    s_mov_b32 s83, -1
    s_mov_b32 s70, 0
Lcalp_80:
    s_add_u32 s29, s28, 0
    s_memtime s[76:77]
    s_waitcnt lgkmcnt(0)
    buffer_store_dword v2, off, s[4:7], s29 sc1
    s_waitcnt vmcnt(0)
    s_memtime s[78:79]
    s_waitcnt lgkmcnt(0)
    s_sub_u32 s78, s78, s76
    s_min_u32 s80, s80, s78
    s_add_u32 s29, s28, 4096
    s_memtime s[76:77]
    s_waitcnt lgkmcnt(0)
    buffer_store_dword v2, off, s[4:7], s29 sc1
    s_waitcnt vmcnt(0)
    s_memtime s[78:79]
    s_waitcnt lgkmcnt(0)
    s_sub_u32 s78, s78, s76
    s_min_u32 s81, s81, s78
    s_add_u32 s29, s28, 16384
    s_memtime s[76:77]
    s_waitcnt lgkmcnt(0)
    buffer_store_dword v2, off, s[4:7], s29 sc1
    s_waitcnt vmcnt(0)
    s_memtime s[78:79]
    s_waitcnt lgkmcnt(0)
    s_sub_u32 s78, s78, s76
    s_min_u32 s82, s82, s78
    s_add_u32 s29, s28, 20480
    s_memtime s[76:77]
    s_waitcnt lgkmcnt(0)
    buffer_store_dword v2, off, s[4:7], s29 sc1
    s_waitcnt vmcnt(0)
    s_memtime s[78:79]
    s_waitcnt lgkmcnt(0)
    s_sub_u32 s78, s78, s76
    s_min_u32 s83, s83, s78
    s_add_u32 s28, s28, 128
    s_add_u32 s70, s70, 1
    s_cmp_lt_u32 s70, 6
    s_cbranch_scc1 Lcalp_80
    s_add_u32 s80, s80, s81
    s_add_u32 s82, s82, s83
    s_cmp_lt_u32 s82, s80
    s_cselect_b32 s69, 16385, 1
    s_or_b32 s68, s68, s69
    v_mov_b32 v2, s68
    buffer_store_dword v2, off, s[16:19], 0 offset:132 sc1
    s_mov_b64 exec, -1
Lcal_78:
    s_cmp_lg_u32 s24, 0
    s_cbranch_scc1 Lcole_82
    s_cmp_lg_u32 s25, 1
    s_cbranch_scc1 Lcole_82
    s_mov_b32 s32, 0
Lcol_81:
    buffer_load_dword v2, off, s[16:19], 0 sc1
    buffer_load_dword v3, off, s[16:19], 0 offset:64 sc1
    s_waitcnt vmcnt(0)
    v_add_u32 v2, v2, v3
    s_nop 0
    v_readfirstlane_b32 s28, v2
    s_nop 0
    s_cmp_lt_u32 s28, 256
    s_cbranch_scc1 Lretry_83
    s_mov_b64 exec, 1
    buffer_store_dword v2, off, s[16:19], 0 offset:128 sc1
    s_mov_b64 exec, -1
Lcole_82:
    s_endpgm
Lretry_83:
    s_sleep 2
    s_add_u32 s32, s32, 1
    s_cmp_lt_u32 s32, 200000
    s_cbranch_scc1 Lcol_81
    v_mov_b32 v2, 5
    v_mov_b32 v3, 4
    buffer_store_dword v2, v3, s[16:19], 0 offen sc1
    s_endpgm
E_L:
L_end:
.section .rodata,"a"
.p2align 6
.amdhsa_kernel parallel_sum__memory_aug_recurrent_mem_tr__dense_activation_relu__prompt_kernel
  .amdhsa_next_free_vgpr 512
  .amdhsa_next_free_sgpr 102
  .amdhsa_accum_offset 256
  .amdhsa_group_segment_fixed_size 0
  .amdhsa_kernarg_size 104
  .amdhsa_user_sgpr_count 2
  .amdhsa_user_sgpr_kernarg_segment_ptr 1
  .amdhsa_system_sgpr_workgroup_id_x 1
  .amdhsa_float_denorm_mode_32 3
.end_amdhsa_kernel
```
